```python
import torch

def _softmax(x, axis=-1):
    return torch.softmax(x, dim=axis)
def _gelu(x):
    return torch.nn.functional.gelu(x, approximate="tanh")
def _silu(x):
    return torch.nn.functional.silu(x)
def _sigmoid(x):
    return torch.sigmoid(x)
def _layernorm(x, axis=-1, eps=1e-5):
    m = x.mean(dim=axis, keepdim=True)
    v = x.var(dim=axis, keepdim=True, unbiased=False)
    return (x - m) / torch.sqrt(v + eps)
def _scatter_add(tgt, idx, src, axis=0):
    return tgt.clone().index_add_(axis, idx, src)
def _segment_sum(src, seg, n):
    out = torch.zeros((n,) + src.shape[1:], dtype=src.dtype)
    return out.index_add_(0, seg, src)
def _pad(x, pw):
    flat = tuple(v for pair in reversed(pw) for v in pair)
    return torch.nn.functional.pad(x, flat)

kernel_name = 'recurrent_scan__linear_kernel_hedgehog__geglu_ffn__prompt'

def setup_inputs():

    _w = (lambda a: (lambda t: t.to(torch.bfloat16) if t.is_floating_point() else t)(torch.as_tensor(a)))
    def _A_setup():
        B, S, D, H = 1, 2048, 448, 16
        Dh = D // H
        return {
            "x": _w((lambda *s: torch.randn(*s, dtype=torch.bfloat16) * 0.05)(B, S, D)),
            "wqkv": _w((lambda *s: torch.randn(*s, dtype=torch.bfloat16) * 0.4)(D, 3 * D)),
            "w_phi": _w((lambda *s: torch.randn(*s, dtype=torch.bfloat16) * 0.4)(H, Dh, Dh) * (Dh ** -0.5)),
            "wo": _w((lambda *s: torch.randn(*s, dtype=torch.bfloat16) * 0.05)(D, D)),
        }
    _A_in = _A_setup()

    def _B_setup():
        B, S, D, F = 1, 2048, 448, 1792
        return {
            "x": _w((lambda *s: torch.randn(*s, dtype=torch.bfloat16) * 0.05)(B, S, D)),
            "w_gate": _w((lambda *s: torch.randn(*s, dtype=torch.bfloat16) * 0.05)(D, F)),
            "w_up": _w((lambda *s: torch.randn(*s, dtype=torch.bfloat16) * 0.05)(D, F)),
            "w_down": _w((lambda *s: torch.randn(*s, dtype=torch.bfloat16) * 0.05)(F, D)),
        }
    _B_in = _B_setup()

    return {
        "A_x": _A_in["x"],
        "A_wqkv": _A_in["wqkv"],
        "A_w_phi": _A_in["w_phi"],
        "A_wo": _A_in["wo"],
        "B_x": _B_in["x"],
        "B_w_gate": _B_in["w_gate"],
        "B_w_up": _B_in["w_up"],
        "B_w_down": _B_in["w_down"],
    }

def reference(A_x, A_wqkv, A_w_phi, A_wo, B_x, B_w_gate, B_w_up, B_w_down):
    def _A_ref(x, wqkv, w_phi, wo):
        B, S, D = x.shape
        H = 16; Dh = D // H
        qkv = (lambda x, *d: x.permute(*d))((x @ wqkv).reshape(B, S, 3, H, Dh), 2, 0, 3, 1, 4)
        q, k, v = qkv[0], qkv[1], qkv[2]
        pq = torch.einsum("bhsd,hdf->bhsf", q, w_phi)
        pk = torch.einsum("bhsd,hdf->bhsf", k, w_phi)
        phi_q = torch.concatenate([_softmax(pq, axis=-1), _softmax(-pq, axis=-1)], axis=-1)
        phi_k = torch.concatenate([_softmax(pk, axis=-1), _softmax(-pk, axis=-1)], axis=-1)
        kv = torch.einsum("bhsf,bhsd->bhfd", phi_k, v)
        z  = torch.einsum("bhsf->bhf", phi_k)
        num = torch.einsum("bhqf,bhfd->bhqd", phi_q, kv)
        den = torch.einsum("bhqf,bhf->bhq", phi_q, z)[..., None] + 1e-6
        o = num / den
        return (lambda x, *d: x.permute(*d))(o, 0, 2, 1, 3).reshape(B, S, D) @ wo

    def _B_ref(x, w_gate, w_up, w_down):
        return (_gelu(x @ w_gate) * (x @ w_up)) @ w_down

    x = A_x
    xn = _layernorm(x, axis=-1)
    s = _A_ref(xn, A_wqkv, A_w_phi, A_wo)
    g = _silu(_B_ref(xn, B_w_gate, B_w_up, B_w_down))
    return x + s * g
```

```asm
; @launch grid=(256,1,1) block=(512,1,1) lds=163840
.amdgcn_target "amdgcn-amd-amdhsa--gfx950"
.text
.globl recurrent_scan__linear_kernel_hedgehog__geglu_ffn__prompt_kernel
.p2align 8
.type recurrent_scan__linear_kernel_hedgehog__geglu_ffn__prompt_kernel,@function
recurrent_scan__linear_kernel_hedgehog__geglu_ffn__prompt_kernel:
  s_cmp_ge_u32 s2, 256
  s_cbranch_scc1 L_end
  s_load_dwordx16 s[48:63], s[0:1], 0
  s_load_dwordx4 s[64:67], s[0:1], 64
  s_load_dwordx2 s[68:69], s[0:1], 80
  v_lshrrev_b32 v1, 6, v0
  s_lshr_b32 s83, s2, 3
  v_readfirstlane_b32 s73, v1
  s_getpc_b64 s[84:85]
  s_mul_i32 s82, s83, 16
  v_add_u32 v2, s82, v0
  v_lshlrev_b32 v2, 7, v2
  v_min_u32 v2, L_end-recurrent_scan__linear_kernel_hedgehog__geglu_ffn__prompt_kernel-256, v2
  v_cmp_gt_u32 vcc, 16, v0
  s_and_saveexec_b64 s[44:45], vcc
  s_cbranch_execz L_notouch
  global_load_dword v51, v2, s[84:85]
L_notouch:
  s_mov_b64 exec, s[44:45]
  v_and_b32 v0, 63, v0
  s_and_b32 s71, s83, 15
  s_lshr_b32 s75, s73, 2
  v_lshlrev_b32 v7, 4, v0
  s_cmp_ge_u32 s83, 28
  s_cselect_b32 s82, 2, 0
  s_add_u32 s82, s82, s75
  s_cmp_eq_u32 s82, 1
  s_cbranch_scc1 L_p1
  s_cmp_eq_u32 s82, 2
  s_cbranch_scc1 L_p2
  s_cmp_eq_u32 s82, 3
  s_cbranch_scc1 L_p3
  s_and_b32 s82, s2, 7
  s_lshr_b32 s83, s2, 3
  s_mul_i32 s84, s83, 37
  s_lshr_b32 s84, s84, 8
  s_mul_i32 s85, s84, 7
  s_sub_u32 s77, s83, s85
  s_lshl_b32 s76, s82, 2
  s_add_u32 s76, s76, s84
  s_mul_i32 s84, s82, 28
  s_add_u32 s84, s84, s83
  s_cmp_ge_u32 s84, 112
  s_cselect_b32 s85, 112, 0
  s_cselect_b32 s70, 8, 0
  s_sub_u32 s84, s84, s85
  s_lshr_b32 s71, s84, 3
  s_and_b32 s84, s84, 7
  s_add_u32 s70, s70, s84
  s_mov_b32 s96, 0x76543210
  s_mov_b32 s97, 0xfedcba98
  s_lshl_b32 s82, s71, 2
  s_lshr_b64 s[96:97], s[96:97], s82
  s_and_b32 s72, s96, 15
  s_and_b32 s82, s71, 1
  s_mul_i32 s82, s82, 4
  s_and_b32 s84, s84, 7
  s_mul_i32 s84, s84, 1
  s_add_u32 s82, s82, s84
  s_mov_b32 s96, 0
  s_mul_i32 s85, s82, 37
  s_lshr_b32 s85, s85, 8
  s_mul_i32 s85, s85, 7
  s_sub_u32 s82, s82, s85
  s_mov_b32 s84, 0x06543210
  s_mov_b32 s85, 0x00654321
  s_lshl_b32 s82, s82, 2
  s_lshr_b64 s[84:85], s[84:85], s82
  s_mov_b32 s95, s84
  s_and_b32 s74, s73, 3
  s_lshr_b32 s75, s73, 2
  s_lshl_b32 s3, s74, 10
  s_lshl_b32 s94, s74, 11
  v_lshrrev_b32 v1, 3, v0
  v_and_b32 v2, 7, v0
  v_lshrrev_b32 v4, 1, v1
  v_xor_b32 v4, v4, v2
  s_lshl_b32 s83, s70, 3
  s_add_u32 s83, s83, s74
  s_lshl_b32 s83, s83, 4
  v_add_u32 v5, s83, v1
  v_mul_u32_u24 v5, 896, v5
  v_lshl_add_u32 v15, v4, 4, v5
  v_xor_b32 v4, 4, v4
  v_lshl_add_u32 v24, v4, 4, v5
  v_add_u32 v24, 6144, v24
  v_lshrrev_b32 v4, 2, v0
  s_lshl_b32 s82, s74, 4
  v_add_u32 v4, s82, v4
  v_mul_u32_u24 v4, 2688, v4
  s_mul_i32 s82, s72, 56
  s_and_b32 s99, s82, 8
  s_and_b32 s82, s82, 0xfff0
  s_add_u32 s82, s82, 896
  v_and_b32 v5, 3, v0
  v_lshlrev_b32 v5, 4, v5
  v_add3_u32 v14, v4, v5, s82
  s_mov_b32 s6, 1835008
  s_mov_b32 s7, 0x20000
  s_mov_b32 s10, 1204224
  s_mov_b32 s11, 0x20000
  s_mov_b32 s30, 25088
  s_mov_b32 s31, 0x20000
  s_mov_b32 s26, 401408
  s_mov_b32 s27, 0x20000
  s_mov_b32 s14, 1605632
  s_mov_b32 s15, 0x20000
  s_mov_b32 s18, 1605632
  s_mov_b32 s19, 0x20000
  s_mov_b32 s22, 1605632
  s_mov_b32 s23, 0x20000
  s_mov_b32 s34, 1835008
  s_mov_b32 s35, 0x20000
  s_mov_b32 s42, 256
  s_mov_b32 s43, 0x20000
  s_mov_b32 s38, 20971520
  s_mov_b32 s39, 0x20000
  s_waitcnt lgkmcnt(0)
  s_mov_b64 s[4:5], s[48:49]
  s_mov_b64 s[8:9], s[50:51]
  s_bfe_u32 s86, s95, 0x40000
  s_add_u32 m0, s94, 0
  s_lshl_b32 s86, s86, 7
  buffer_load_dwordx4 v15, s[4:7], s86 offen lds
  buffer_load_dwordx4 v24, s[4:7], s86 offen offset:1024 lds
  s_add_u32 m0, s94, 8192
  s_add_u32 s86, s86, 57344
  buffer_load_dwordx4 v15, s[4:7], s86 offen lds
  buffer_load_dwordx4 v24, s[4:7], s86 offen offset:1024 lds
  s_bfe_u32 s86, s95, 0x40000
  s_add_u32 m0, s3, 16384
  s_mul_i32 s86, s86, 172032
  buffer_load_dwordx4 v14, s[8:11], s86 offen lds
  s_add_u32 m0, s3, 19584
  s_nop 0
  buffer_load_dwordx4 v14, s[8:11], s86 offen offset:896 lds
  v_lshrrev_b32 v1, 4, v0
  v_and_b32 v2, 15, v0
  v_lshrrev_b32 v3, 5, v0
  v_and_b32 v4, 31, v0
  s_lshl_b32 s82, s75, 1
  s_add_u32 s82, s82, s74
  v_and_b32 v52, 1, v1
  v_lshlrev_b32 v5, 5, v52
  v_and_b32 v6, 3, v2
  v_lshl_add_u32 v5, v6, 3, v5
  v_cmp_eq_u32 vcc, v52, v2
  v_lshrrev_b32 v6, 2, v2
  v_lshl_add_u32 v6, v3, 3, v6
  v_mov_b32 v1, 0x3f803f80
  v_min_u32 v26, 48, v5
  v_lshl_add_u32 v26, v6, 6, v26
  s_lshl_b32 s83, s75, 12
  s_add_u32 s83, s83, s99
  v_add_u32 v26, s83, v26
  v_cndmask_b32 v52, 0, v1, vcc
  s_lshl_b32 s83, s74, 5
  v_add_u32 v4, s83, v4
  v_bfe_u32 v6, v4, 1, 3
  v_xor_b32 v6, v6, v3
  v_lshlrev_b32 v6, 4, v6
  v_lshl_add_u32 v6, v4, 7, v6
  s_add_u32 s83, s82, 0
  s_and_b32 s83, s83, 3
  s_lshl_b32 s84, s83, 5
  v_xor_b32 v20, s84, v6
  v_lshl_add_u32 v16, s83, 10, v26
  s_add_u32 s83, s82, 1
  s_and_b32 s83, s83, 3
  s_lshl_b32 s84, s83, 5
  v_xor_b32 v21, s84, v6
  v_lshl_add_u32 v17, s83, 10, v26
  s_add_u32 s83, s82, 2
  s_and_b32 s83, s83, 3
  s_lshl_b32 s84, s83, 5
  v_xor_b32 v22, s84, v6
  v_lshl_add_u32 v18, s83, 10, v26
  s_add_u32 s83, s82, 3
  s_and_b32 s83, s83, 3
  s_lshl_b32 s84, s83, 5
  v_xor_b32 v23, s84, v6
  v_lshl_add_u32 v19, s83, 10, v26
  v_mov_b32 v53, v52
  v_mov_b32 v54, v52
  v_mov_b32 v55, v52
  v_mov_b32 v1, 0
  v_mov_b32 v2, 0
  v_mov_b32 v3, 0
  v_mov_b32 v4, 0
  s_mov_b64 s[28:29], s[52:53]
  s_mov_b64 s[24:25], s[54:55]
  s_mov_b64 s[12:13], s[58:59]
  s_mov_b64 s[16:17], s[60:61]
  s_mov_b64 s[20:21], s[62:63]
  s_mov_b64 s[32:33], s[64:65]
  s_mov_b64 s[40:41], s[66:67]
  s_mov_b64 s[36:37], s[68:69]
  s_bfe_u32 s86, s95, 0x40004
  s_add_u32 m0, s94, 24576
  s_lshl_b32 s86, s86, 7
  buffer_load_dwordx4 v15, s[4:7], s86 offen lds
  buffer_load_dwordx4 v24, s[4:7], s86 offen offset:1024 lds
  s_add_u32 m0, s94, 32768
  s_add_u32 s86, s86, 57344
  buffer_load_dwordx4 v15, s[4:7], s86 offen lds
  buffer_load_dwordx4 v24, s[4:7], s86 offen offset:1024 lds
  s_bfe_u32 s86, s95, 0x40004
  s_add_u32 m0, s3, 40960
  s_mul_i32 s86, s86, 172032
  buffer_load_dwordx4 v14, s[8:11], s86 offen lds
  s_add_u32 m0, s3, 44160
  s_nop 0
  buffer_load_dwordx4 v14, s[8:11], s86 offen offset:896 lds
  v_bfe_u32 v65, v7, 4, 4
  v_bfe_u32 v66, v7, 9, 1
  v_bfe_u32 v67, v7, 4, 5
  v_bfe_u32 v68, v7, 8, 1
  v_lshlrev_b32 v68, 5, v68
  v_and_b32 v70, 3, v65
  v_lshl_add_u32 v68, v70, 3, v68
  s_lshl_b32 s83, s74, 5
  v_add_u32 v69, s83, v67
  v_min_u32 v70, 56, v68
  v_add_u32 v70, 0, v70
  v_and_b32 v71, 8, v65
  v_lshlrev_b32 v71, 3, v71
  v_xor_b32 v70, v70, v71
  v_lshrrev_b32 v72, 2, v65
  v_lshl_add_u32 v64, v66, 3, v72
  v_lshl_add_u32 v70, v64, 7, v70
  s_add_u32 s83, s74, 0
  s_and_b32 s83, s83, 3
  v_lshl_add_u32 v28, s83, 11, v70
  s_add_u32 s83, s74, 1
  s_and_b32 s83, s83, 3
  v_lshl_add_u32 v29, s83, 11, v70
  s_add_u32 s83, s74, 2
  s_and_b32 s83, s83, 3
  v_lshl_add_u32 v30, s83, 11, v70
  s_add_u32 s83, s74, 3
  s_and_b32 s83, s83, 3
  v_lshl_add_u32 v31, s83, 11, v70
  s_lshl_b32 s84, s74, 2
  s_add_u32 s84, s84, 155648
  v_add_u32 v70, s84, v7
  v_mov_b32 v10, 161792
  v_cmp_gt_u32 vcc, 256, v7
  v_lshlrev_b32 v9, 4, v67
  v_add_u32 v9, 155648, v9
  v_cndmask_b32 v10, v10, v70, vcc
  v_cmp_eq_u32 vcc, 0, v66
  v_mov_b32 v70, 1.0
  v_mov_b32 v49, 0
  v_cndmask_b32 v32, 0, v70, vcc
  v_mov_b32 v47, 0
  s_mov_b32 s100, -1
  s_mov_b32 s101, 0
  s_lshl_b32 s83, s70, 2
  s_add_u32 s83, s83, s74
  s_mul_i32 s83, s83, 144
  s_lshl_b32 s84, s71, 3
  s_add_u32 s83, s83, s84
  s_add_u32 s83, s83, 0
  s_lshl_b32 s83, s83, 10
  s_add_u32 s83, s83, 3145728
  v_add_u32 v11, s83, v7
  v_bfe_u32 v70, v67, 2, 1
  v_bfe_u32 v71, v67, 3, 1
  v_lshl_or_b32 v70, v71, 2, v70
  v_and_b32 v71, 2, v67
  v_or_b32 v70, v70, v71
  v_lshlrev_b32 v70, 4, v70
  v_lshl_add_u32 v70, v69, 7, v70
  v_lshl_add_u32 v70, v66, 3, v70
  v_add_u32 v8, 131072, v70
  s_and_b32 s82, s76, 3
  s_lshl_b32 s82, s82, 1
  s_add_u32 s82, s82, s77
  s_mul_i32 s85, s82, 37
  s_lshr_b32 s85, s85, 8
  s_mul_i32 s85, s85, 7
  s_sub_u32 s82, s82, s85
  s_mov_b32 s84, 0x06543210
  s_mov_b32 s85, 0x00654321
  s_lshl_b32 s82, s82, 2
  s_lshr_b64 s[84:85], s[84:85], s82
  s_mov_b32 s99, s84
  s_add_u32 s82, s76, s77
  s_and_b32 s82, s82, 3
  s_lshl_b32 s82, s82, 2
  s_lshr_b32 s98, 0x02103210, s82
  s_bfe_u32 s51, s99, 0x40000
  s_lshl_b32 s51, s51, 14
  s_bfe_u32 s52, s99, 0x40004
  s_lshl_b32 s52, s52, 14
  s_bfe_u32 s53, s99, 0x40008
  s_lshl_b32 s53, s53, 14
  s_bfe_u32 s54, s99, 0x4000c
  s_lshl_b32 s54, s54, 14
  s_bfe_u32 s55, s99, 0x40010
  s_lshl_b32 s55, s55, 14
  s_bfe_u32 s56, s99, 0x40014
  s_lshl_b32 s56, s56, 14
  s_bfe_u32 s57, s99, 0x40018
  s_lshl_b32 s57, s57, 14
  s_lshr_b32 s82, s74, 1
  s_and_b32 s83, s74, 1
  s_lshl_b32 s84, s76, 1
  s_add_u32 s84, s84, s82
  s_lshl_b32 s85, s84, 5
  v_add_u32 v70, s85, v67
  v_mul_u32_u24 v70, 896, v70
  s_lshl_b32 s85, s77, 1
  s_add_u32 s85, s85, s83
  s_lshl_b32 s85, s85, 6
  v_lshl_add_u32 v70, v66, 4, v70
  v_add_u32 v13, s85, v70
  s_mul_i32 s84, s84, 144
  s_lshl_b32 s85, s83, 1
  s_add_u32 s84, s84, s85
  s_lshl_b32 s85, s96, 2
  s_add_u32 s84, s84, s85
  s_lshl_b32 s84, s84, 10
  s_add_u32 s84, s84, 3145728
  v_add_u32 v12, s84, v7
  s_lshl_b32 s97, s96, 13
  s_sub_u32 s97, 4096, s97
  s_lshl_b32 s84, s74, 13
  v_add_u32 v50, s84, v7
  v_lshl_add_u32 v70, v66, 2, v72
  s_lshl_b32 s84, s83, 5
  v_add_u32 v70, s84, v70
  v_and_b32 v71, 8, v65
  v_lshlrev_b32 v71, 3, v71
  v_xor_b32 v71, v71, v68
  s_lshl_b32 s84, s83, 6
  v_xor_b32 v71, s84, v71
  v_lshl_add_u32 v0, v70, 7, v71
  s_waitcnt vmcnt(6)
  s_barrier
  ds_read_b128 v[144:147], v20 offset:0
  ds_read_b64_tr_b16 v[96:97], v16 offset:16384
  ds_read_b64_tr_b16 v[98:99], v16 offset:16640
  ds_read_b128 v[148:151], v21 offset:0
  ds_read_b64_tr_b16 v[100:101], v17 offset:16384
  ds_read_b64_tr_b16 v[102:103], v17 offset:16640
  ds_read_b128 v[152:155], v22 offset:0
  ds_read_b64_tr_b16 v[104:105], v18 offset:16384
  ds_read_b64_tr_b16 v[106:107], v18 offset:16640
  ds_read_b128 v[156:159], v23 offset:0
  ds_read_b64_tr_b16 v[108:109], v19 offset:16384
  ds_read_b64_tr_b16 v[110:111], v19 offset:16640
  s_waitcnt vmcnt(0) lgkmcnt(0)
  s_barrier
  v_mfma_f32_16x16x32_bf16 v[56:59], v[52:55], v[96:99], 0
  v_mfma_f32_32x32x16_bf16 v[112:127], v[96:99], v[144:147], 0
  ds_read_b128 v[160:163], v20 offset:24576
  ds_read_b64_tr_b16 v[80:81], v16 offset:40960
  ds_read_b64_tr_b16 v[82:83], v16 offset:41216
  v_mfma_f32_32x32x16_bf16 v[112:127], v[100:103], v[148:151], v[112:127]
  ds_read_b128 v[164:167], v21 offset:24576
  ds_read_b64_tr_b16 v[84:85], v17 offset:40960
  ds_read_b64_tr_b16 v[86:87], v17 offset:41216
  v_mfma_f32_32x32x16_bf16 v[112:127], v[104:107], v[152:155], v[112:127]
  ds_read_b128 v[168:171], v22 offset:24576
  ds_read_b64_tr_b16 v[88:89], v18 offset:40960
  ds_read_b64_tr_b16 v[90:91], v18 offset:41216
  v_mfma_f32_32x32x16_bf16 v[112:127], v[108:111], v[156:159], v[112:127]
  ds_read_b128 v[172:175], v23 offset:24576
  ds_read_b64_tr_b16 v[92:93], v19 offset:40960
  ds_read_b64_tr_b16 v[94:95], v19 offset:41216
  v_dot2c_f32_bf16 v1, 0x3f803f80, v144
  v_dot2c_f32_bf16 v3, v144, v144
  v_dot2c_f32_bf16 v2, 0x3f803f80, v145
  v_dot2c_f32_bf16 v4, v145, v145
  v_dot2c_f32_bf16 v1, 0x3f803f80, v146
  v_dot2c_f32_bf16 v3, v146, v146
  v_dot2c_f32_bf16 v2, 0x3f803f80, v147
  v_dot2c_f32_bf16 v4, v147, v147
  v_dot2c_f32_bf16 v1, 0x3f803f80, v148
  v_dot2c_f32_bf16 v3, v148, v148
  v_dot2c_f32_bf16 v2, 0x3f803f80, v149
  v_dot2c_f32_bf16 v4, v149, v149
  v_dot2c_f32_bf16 v1, 0x3f803f80, v150
  v_dot2c_f32_bf16 v3, v150, v150
  v_dot2c_f32_bf16 v2, 0x3f803f80, v151
  v_dot2c_f32_bf16 v4, v151, v151
  s_waitcnt lgkmcnt(0)
  s_barrier
  v_mfma_f32_16x16x32_bf16 v[56:59], v[52:55], v[80:83], v[56:59]
  v_mfma_f32_32x32x16_bf16 v[112:127], v[80:83], v[160:163], v[112:127]
  v_add_u32 v16, 0x10000, v16
  v_add_u32 v17, 0x10000, v17
  v_add_u32 v18, 0x10000, v18
  v_add_u32 v19, 0x10000, v19
  ds_read_b128 v[176:179], v20 offset:49152
  ds_read_b64_tr_b16 v[96:97], v16 offset:0
  ds_read_b64_tr_b16 v[98:99], v16 offset:256
  s_bfe_u32 s86, s95, 0x40010
  s_add_u32 m0, s94, 24576
  s_lshl_b32 s86, s86, 7
  buffer_load_dwordx4 v15, s[4:7], s86 offen lds
  buffer_load_dwordx4 v24, s[4:7], s86 offen offset:1024 lds
  v_mfma_f32_32x32x16_bf16 v[112:127], v[84:87], v[164:167], v[112:127]
  ds_read_b128 v[180:183], v21 offset:49152
  ds_read_b64_tr_b16 v[100:101], v17 offset:0
  ds_read_b64_tr_b16 v[102:103], v17 offset:256
  s_add_u32 m0, s94, 32768
  s_add_u32 s86, s86, 57344
  buffer_load_dwordx4 v15, s[4:7], s86 offen lds
  buffer_load_dwordx4 v24, s[4:7], s86 offen offset:1024 lds
  v_mfma_f32_32x32x16_bf16 v[112:127], v[88:91], v[168:171], v[112:127]
  ds_read_b128 v[184:187], v22 offset:49152
  ds_read_b64_tr_b16 v[104:105], v18 offset:0
  ds_read_b64_tr_b16 v[106:107], v18 offset:256
  s_bfe_u32 s86, s95, 0x40010
  s_add_u32 m0, s3, 40960
  s_mul_i32 s86, s86, 172032
  buffer_load_dwordx4 v14, s[8:11], s86 offen lds
  s_add_u32 m0, s3, 44160
  s_nop 0
  buffer_load_dwordx4 v14, s[8:11], s86 offen offset:896 lds
  v_mfma_f32_32x32x16_bf16 v[112:127], v[92:95], v[172:175], v[112:127]
  ds_read_b128 v[188:191], v23 offset:49152
  ds_read_b64_tr_b16 v[108:109], v19 offset:0
  ds_read_b64_tr_b16 v[110:111], v19 offset:256
  s_mul_i32 s82, s72, 1568
  s_lshl_b32 s83, s73, 8
  s_add_u32 s82, s82, s83
  s_add_u32 m0, s83, 159744
  v_lshrrev_b32 v74, 2, v7
  buffer_load_dword v74, s[28:31], s82 offen lds
  v_dot2c_f32_bf16 v1, 0x3f803f80, v160
  v_dot2c_f32_bf16 v3, v160, v160
  v_dot2c_f32_bf16 v2, 0x3f803f80, v161
  v_dot2c_f32_bf16 v4, v161, v161
  v_dot2c_f32_bf16 v1, 0x3f803f80, v162
  v_dot2c_f32_bf16 v3, v162, v162
  v_dot2c_f32_bf16 v2, 0x3f803f80, v163
  v_dot2c_f32_bf16 v4, v163, v163
  v_dot2c_f32_bf16 v1, 0x3f803f80, v164
  v_dot2c_f32_bf16 v3, v164, v164
  v_dot2c_f32_bf16 v2, 0x3f803f80, v165
  v_dot2c_f32_bf16 v4, v165, v165
  v_dot2c_f32_bf16 v1, 0x3f803f80, v166
  v_dot2c_f32_bf16 v3, v166, v166
  v_dot2c_f32_bf16 v2, 0x3f803f80, v167
  v_dot2c_f32_bf16 v4, v167, v167
  s_waitcnt lgkmcnt(0)
  s_barrier
  v_mfma_f32_16x16x32_bf16 v[56:59], v[52:55], v[96:99], v[56:59]
  v_mfma_f32_32x32x16_bf16 v[112:127], v[96:99], v[176:179], v[112:127]
  v_add_u32 v16, 0xffff4000, v16
  v_add_u32 v17, 0xffff4000, v17
  v_add_u32 v18, 0xffff4000, v18
  v_add_u32 v19, 0xffff4000, v19
  ds_read_b128 v[192:195], v20 offset:0
  ds_read_b64_tr_b16 v[80:81], v16 offset:0
  ds_read_b64_tr_b16 v[82:83], v16 offset:256
  v_mfma_f32_32x32x16_bf16 v[112:127], v[100:103], v[180:183], v[112:127]
  ds_read_b128 v[196:199], v21 offset:0
  ds_read_b64_tr_b16 v[84:85], v17 offset:0
  ds_read_b64_tr_b16 v[86:87], v17 offset:256
  v_mfma_f32_32x32x16_bf16 v[112:127], v[104:107], v[184:187], v[112:127]
  ds_read_b128 v[200:203], v22 offset:0
  ds_read_b64_tr_b16 v[88:89], v18 offset:0
  ds_read_b64_tr_b16 v[90:91], v18 offset:256
  v_mfma_f32_32x32x16_bf16 v[112:127], v[108:111], v[188:191], v[112:127]
  ds_read_b128 v[204:207], v23 offset:0
  ds_read_b64_tr_b16 v[92:93], v19 offset:0
  ds_read_b64_tr_b16 v[94:95], v19 offset:256
  v_dot2c_f32_bf16 v1, 0x3f803f80, v176
  v_dot2c_f32_bf16 v3, v176, v176
  v_dot2c_f32_bf16 v2, 0x3f803f80, v177
  v_dot2c_f32_bf16 v4, v177, v177
  v_dot2c_f32_bf16 v1, 0x3f803f80, v178
  v_dot2c_f32_bf16 v3, v178, v178
  v_dot2c_f32_bf16 v2, 0x3f803f80, v179
  v_dot2c_f32_bf16 v4, v179, v179
  v_dot2c_f32_bf16 v1, 0x3f803f80, v180
  v_dot2c_f32_bf16 v3, v180, v180
  v_dot2c_f32_bf16 v2, 0x3f803f80, v181
  v_dot2c_f32_bf16 v4, v181, v181
  v_dot2c_f32_bf16 v1, 0x3f803f80, v182
  v_dot2c_f32_bf16 v3, v182, v182
  v_dot2c_f32_bf16 v2, 0x3f803f80, v183
  v_dot2c_f32_bf16 v4, v183, v183
  s_waitcnt vmcnt(1) lgkmcnt(0)
  s_barrier
  v_mfma_f32_16x16x32_bf16 v[56:59], v[52:55], v[80:83], v[56:59]
  v_mfma_f32_32x32x16_bf16 v[112:127], v[80:83], v[192:195], v[112:127]
  ds_read_b128 v[208:211], v20 offset:24576
  ds_read_b64_tr_b16 v[96:97], v16 offset:24576
  ds_read_b64_tr_b16 v[98:99], v16 offset:24832
  s_bfe_u32 s86, s95, 0x40018
  s_add_u32 m0, s94, 0
  s_lshl_b32 s86, s86, 7
  buffer_load_dwordx4 v15, s[4:7], s86 offen lds
  buffer_load_dwordx4 v24, s[4:7], s86 offen offset:1024 lds
  v_mfma_f32_32x32x16_bf16 v[112:127], v[84:87], v[196:199], v[112:127]
  ds_read_b128 v[212:215], v21 offset:24576
  ds_read_b64_tr_b16 v[100:101], v17 offset:24576
  ds_read_b64_tr_b16 v[102:103], v17 offset:24832
  s_add_u32 m0, s94, 8192
  s_add_u32 s86, s86, 57344
  buffer_load_dwordx4 v15, s[4:7], s86 offen lds
  buffer_load_dwordx4 v24, s[4:7], s86 offen offset:1024 lds
  v_mfma_f32_32x32x16_bf16 v[112:127], v[88:91], v[200:203], v[112:127]
  ds_read_b128 v[216:219], v22 offset:24576
  ds_read_b64_tr_b16 v[104:105], v18 offset:24576
  ds_read_b64_tr_b16 v[106:107], v18 offset:24832
  s_bfe_u32 s86, s95, 0x40018
  s_add_u32 m0, s3, 16384
  s_mul_i32 s86, s86, 172032
  buffer_load_dwordx4 v14, s[8:11], s86 offen lds
  s_add_u32 m0, s3, 19584
  s_nop 0
  buffer_load_dwordx4 v14, s[8:11], s86 offen offset:896 lds
  v_mfma_f32_32x32x16_bf16 v[112:127], v[92:95], v[204:207], v[112:127]
  ds_read_b128 v[220:223], v23 offset:24576
  ds_read_b64_tr_b16 v[108:109], v19 offset:24576
  ds_read_b64_tr_b16 v[110:111], v19 offset:24832
  v_mov_b32 v5, 0
  buffer_load_dword v6, v5, s[40:43], 0 offen sc1
  v_dot2c_f32_bf16 v1, 0x3f803f80, v192
  v_dot2c_f32_bf16 v3, v192, v192
  v_dot2c_f32_bf16 v2, 0x3f803f80, v193
  v_dot2c_f32_bf16 v4, v193, v193
  v_dot2c_f32_bf16 v1, 0x3f803f80, v194
  v_dot2c_f32_bf16 v3, v194, v194
  v_dot2c_f32_bf16 v2, 0x3f803f80, v195
  v_dot2c_f32_bf16 v4, v195, v195
  v_dot2c_f32_bf16 v1, 0x3f803f80, v196
  v_dot2c_f32_bf16 v3, v196, v196
  v_dot2c_f32_bf16 v2, 0x3f803f80, v197
  v_dot2c_f32_bf16 v4, v197, v197
  v_dot2c_f32_bf16 v1, 0x3f803f80, v198
  v_dot2c_f32_bf16 v3, v198, v198
  v_dot2c_f32_bf16 v2, 0x3f803f80, v199
  v_dot2c_f32_bf16 v4, v199, v199
  s_waitcnt vmcnt(7) lgkmcnt(0)
  s_barrier
  v_mfma_f32_16x16x32_bf16 v[56:59], v[52:55], v[96:99], v[56:59]
  v_mfma_f32_32x32x16_bf16 v[112:127], v[96:99], v[208:211], v[112:127]
  ds_read_b128 v[224:227], v20 offset:49152
  ds_read_b64_tr_b16 v[80:81], v16 offset:49152
  ds_read_b64_tr_b16 v[82:83], v16 offset:49408
  v_mfma_f32_32x32x16_bf16 v[112:127], v[100:103], v[212:215], v[112:127]
  ds_read_b128 v[228:231], v21 offset:49152
  ds_read_b64_tr_b16 v[84:85], v17 offset:49152
  ds_read_b64_tr_b16 v[86:87], v17 offset:49408
  v_mfma_f32_32x32x16_bf16 v[112:127], v[104:107], v[216:219], v[112:127]
  ds_read_b128 v[232:235], v22 offset:49152
  ds_read_b64_tr_b16 v[88:89], v18 offset:49152
  ds_read_b64_tr_b16 v[90:91], v18 offset:49408
  v_mfma_f32_32x32x16_bf16 v[112:127], v[108:111], v[220:223], v[112:127]
  ds_read_b128 v[236:239], v23 offset:49152
  ds_read_b64_tr_b16 v[92:93], v19 offset:49152
  ds_read_b64_tr_b16 v[94:95], v19 offset:49408
  v_bfe_u32 v25, v7, 9, 1
  v_bfe_u32 v26, v7, 6, 2
  v_lshl_add_u32 v25, v25, 2, v26
  v_mul_u32_u24 v25, 56, v25
  v_bfe_u32 v26, v7, 8, 1
  v_lshlrev_b32 v26, 5, v26
  v_bfe_u32 v27, v7, 4, 2
  v_lshl_add_u32 v26, v27, 3, v26
  v_min_u32 v26, 48, v26
  v_add_u32 v25, v25, v26
  v_add_u32 v25, 159744, v25
  ds_read_b64_tr_b16 v[38:39], v25 offset:0
  ds_read_b64_tr_b16 v[40:41], v25 offset:448
  ds_read_b64_tr_b16 v[42:43], v25 offset:896
  ds_read_b64_tr_b16 v[44:45], v25 offset:1344
  v_dot2c_f32_bf16 v1, 0x3f803f80, v208
  v_dot2c_f32_bf16 v3, v208, v208
  v_dot2c_f32_bf16 v2, 0x3f803f80, v209
  v_dot2c_f32_bf16 v4, v209, v209
  v_dot2c_f32_bf16 v1, 0x3f803f80, v210
  v_dot2c_f32_bf16 v3, v210, v210
  v_dot2c_f32_bf16 v2, 0x3f803f80, v211
  v_dot2c_f32_bf16 v4, v211, v211
  v_dot2c_f32_bf16 v1, 0x3f803f80, v212
  v_dot2c_f32_bf16 v3, v212, v212
  v_dot2c_f32_bf16 v2, 0x3f803f80, v213
  v_dot2c_f32_bf16 v4, v213, v213
  v_dot2c_f32_bf16 v1, 0x3f803f80, v214
  v_dot2c_f32_bf16 v3, v214, v214
  v_dot2c_f32_bf16 v2, 0x3f803f80, v215
  v_dot2c_f32_bf16 v4, v215, v215
  s_waitcnt vmcnt(1) lgkmcnt(0)
  s_barrier
  v_mfma_f32_16x16x32_bf16 v[56:59], v[52:55], v[80:83], v[56:59]
  v_mfma_f32_32x32x16_bf16 v[112:127], v[80:83], v[224:227], v[112:127]
  ds_read_b128 v[240:243], v20 offset:0
  ds_read_b64_tr_b16 v[96:97], v16 offset:0
  ds_read_b64_tr_b16 v[98:99], v16 offset:256
  v_mfma_f32_32x32x16_bf16 v[112:127], v[84:87], v[228:231], v[112:127]
  ds_read_b128 v[244:247], v21 offset:0
  ds_read_b64_tr_b16 v[100:101], v17 offset:0
  ds_read_b64_tr_b16 v[102:103], v17 offset:256
  v_mfma_f32_32x32x16_bf16 v[112:127], v[88:91], v[232:235], v[112:127]
  ds_read_b128 v[248:251], v22 offset:0
  ds_read_b64_tr_b16 v[104:105], v18 offset:0
  ds_read_b64_tr_b16 v[106:107], v18 offset:256
  v_mfma_f32_32x32x16_bf16 v[112:127], v[92:95], v[236:239], v[112:127]
  ds_read_b128 v[252:255], v23 offset:0
  ds_read_b64_tr_b16 v[108:109], v19 offset:0
  ds_read_b64_tr_b16 v[110:111], v19 offset:256
  v_cndmask_b32 v44, 0, v44, s[100:101]
  v_cndmask_b32 v45, 0, v45, s[100:101]
  s_cmp_lg_u32 s74, 0
  s_cbranch_scc1 L_warm_1_0
  v_lshrrev_b32 v64, 4, v7
  s_mul_i32 s82, s2, 49
  v_min_u32 v64, 48, v64
  v_add_u32 v64, s82, v64
  v_lshlrev_b32 v64, 7, v64
  buffer_load_dword v51, v64, s[20:23], 0 offen
L_warm_1_0:
  s_cmp_lg_u32 s74, 1
  s_cbranch_scc1 L_warm_1_1
  v_lshrrev_b32 v64, 4, v7
  s_mul_i32 s82, s2, 13
  v_min_u32 v64, 12, v64
  v_add_u32 v64, s82, v64
  v_lshlrev_b32 v64, 7, v64
  buffer_load_dword v51, v64, s[24:27], 0 offen
L_warm_1_1:
  v_dot2c_f32_bf16 v1, 0x3f803f80, v224
  v_dot2c_f32_bf16 v3, v224, v224
  v_dot2c_f32_bf16 v2, 0x3f803f80, v225
  v_dot2c_f32_bf16 v4, v225, v225
  v_dot2c_f32_bf16 v1, 0x3f803f80, v226
  v_dot2c_f32_bf16 v3, v226, v226
  v_dot2c_f32_bf16 v2, 0x3f803f80, v227
  v_dot2c_f32_bf16 v4, v227, v227
  v_dot2c_f32_bf16 v1, 0x3f803f80, v228
  v_dot2c_f32_bf16 v3, v228, v228
  v_dot2c_f32_bf16 v2, 0x3f803f80, v229
  v_dot2c_f32_bf16 v4, v229, v229
  v_dot2c_f32_bf16 v1, 0x3f803f80, v230
  v_dot2c_f32_bf16 v3, v230, v230
  v_dot2c_f32_bf16 v2, 0x3f803f80, v231
  v_dot2c_f32_bf16 v4, v231, v231
  s_waitcnt lgkmcnt(0)
  s_barrier
  v_dot2c_f32_bf16 v1, 0x3f803f80, v240
  v_dot2c_f32_bf16 v3, v240, v240
  v_dot2c_f32_bf16 v2, 0x3f803f80, v241
  v_dot2c_f32_bf16 v4, v241, v241
  v_dot2c_f32_bf16 v1, 0x3f803f80, v242
  v_dot2c_f32_bf16 v3, v242, v242
  v_dot2c_f32_bf16 v2, 0x3f803f80, v243
  v_dot2c_f32_bf16 v4, v243, v243
  v_dot2c_f32_bf16 v1, 0x3f803f80, v244
  v_dot2c_f32_bf16 v3, v244, v244
  v_dot2c_f32_bf16 v2, 0x3f803f80, v245
  v_dot2c_f32_bf16 v4, v245, v245
  v_dot2c_f32_bf16 v1, 0x3f803f80, v246
  v_dot2c_f32_bf16 v3, v246, v246
  v_dot2c_f32_bf16 v2, 0x3f803f80, v247
  v_dot2c_f32_bf16 v4, v247, v247
  v_mfma_f32_16x16x32_bf16 v[56:59], v[52:55], v[96:99], v[56:59]
  v_mfma_f32_32x32x16_bf16 v[112:127], v[96:99], v[240:243], v[112:127]
  ds_read_b64_tr_b16 v[64:65], v28 offset:24576
  ds_read_b64_tr_b16 v[66:67], v28 offset:25088
  v_mfma_f32_32x32x16_bf16 v[112:127], v[100:103], v[244:247], v[112:127]
  ds_read_b64_tr_b16 v[68:69], v29 offset:24576
  ds_read_b64_tr_b16 v[70:71], v29 offset:25088
  v_add_f32 v2, v1, v2
  v_add_f32 v3, v3, v4
  v_bfe_u32 v16, v7, 4, 5
  v_mov_b32 v1, v2
  v_mov_b32 v4, v3
  s_lshl_b32 s82, s74, 8
  s_add_u32 s82, s82, 157696
  v_lshl_add_u32 v15, v16, 3, s82
  v_mfma_f32_32x32x16_bf16 v[112:127], v[104:107], v[248:251], v[112:127]
  ds_read_b64_tr_b16 v[72:73], v30 offset:24576
  ds_read_b64_tr_b16 v[74:75], v30 offset:25088
  v_permlane32_swap_b32 v2, v1
  v_permlane32_swap_b32 v3, v4
  ds_write2_b32 v10, v56, v57 offset0:128 offset1:192
  v_add_f32 v2, v2, v1
  v_add_f32 v3, v3, v4
  ds_write_b64 v15, v[2:3] offset:0
  v_mfma_f32_32x32x16_bf16 v[112:127], v[108:111], v[252:255], v[112:127]
  s_waitcnt lgkmcnt(4)
  v_mfma_f32_16x16x32_bf16 v[56:59], v[52:55], v[64:67], 0
  v_mfma_f32_32x32x16_bf16 v[80:95], v[64:67], v[144:147], 0
  ds_read_b64_tr_b16 v[76:77], v31 offset:24576
  ds_read_b64_tr_b16 v[78:79], v31 offset:25088
  v_mfma_f32_32x32x16_bf16 v[80:95], v[68:71], v[148:151], v[80:95]
  ds_read_b64_tr_b16 v[64:65], v28 offset:32768
  ds_read_b64_tr_b16 v[66:67], v28 offset:33280
  s_waitcnt lgkmcnt(4)
  s_barrier
  s_waitcnt vmcnt(0)
  v_cmp_eq_u32 vcc, 0, v6
  s_mov_b32 s87, 262144
  s_nop 1
  s_cbranch_vccz L_nonce_2_x
L_nonce_2:
  buffer_load_dword v6, v5, s[40:43], 0 offen sc1
  s_sub_u32 s87, s87, 1
  s_cbranch_scc1 L_nonce_2_y
  s_waitcnt vmcnt(0)
  v_cmp_eq_u32 vcc, 0, v6
  s_nop 4
  s_cbranch_vccnz L_nonce_2
L_nonce_2_y:
  s_waitcnt vmcnt(0)
  s_nop 4
L_nonce_2_x:
  v_readfirstlane_b32 s80, v6
  ds_read_b64 v[16:17], v15 offset:1024
  ds_read_b128 v[60:63], v9 offset:512
  s_waitcnt lgkmcnt(4)
  v_mfma_f32_32x32x16_bf16 v[80:95], v[72:75], v[152:155], v[80:95]
  ds_read_b64_tr_b16 v[68:69], v29 offset:32768
  ds_read_b64_tr_b16 v[70:71], v29 offset:33280
  v_mfma_f32_32x32x16_bf16 v[80:95], v[76:79], v[156:159], v[80:95]
  ds_read_b64_tr_b16 v[72:73], v30 offset:32768
  ds_read_b64_tr_b16 v[74:75], v30 offset:33280
  s_waitcnt lgkmcnt(2)
  v_mfma_f32_16x16x32_bf16 v[56:59], v[52:55], v[64:67], v[56:59]
  v_mfma_f32_32x32x16_bf16 v[80:95], v[64:67], v[160:163], v[80:95]
  ds_read_b64_tr_b16 v[76:77], v31 offset:32768
  ds_read_b64_tr_b16 v[78:79], v31 offset:33280
  v_add_f32 v2, v2, v16
  v_add_f32 v3, v3, v17
  v_mul_f32 v2, 0x3b124925, v2
  v_mul_f32 v3, 0x3b124925, v3
  v_mul_f32_e64 v16, -v2, v32
  v_fma_f32 v3, -v2, v2, v3
  v_cvt_pk_bf16_f32 v46, v16, v16
  v_max_f32 v3, 0, v3
  v_add_f32 v60, v60, v61
  v_add_f32 v62, v62, v63
  v_add_f32 v60, v60, v62
  v_cvt_pk_bf16_f32 v61, v60, v60
  v_lshlrev_b32 v61, 16, v61
  s_barrier
  v_mfma_f32_32x32x16_bf16 v[80:95], v[68:71], v[164:167], v[80:95]
  ds_read_b64_tr_b16 v[64:65], v28 offset:40960
  ds_read_b64_tr_b16 v[66:67], v28 offset:41472
  v_sub_f32 v62, v60, v61
  v_cvt_pk_bf16_f32 v48, v61, v62
  v_cvt_pk_bf16_f32 v3, v3, v3
  v_lshlrev_b32 v3, 16, v3
  v_mfma_f32_32x32x8_bf16 v[112:127], v[48:49], v[46:47], v[112:127]
  v_add_f32 v3, 0x3727c5ac, v3
  v_cvt_pk_bf16_f32 v3, v3, v3
  s_waitcnt lgkmcnt(2)
  v_mfma_f32_32x32x16_bf16 v[80:95], v[72:75], v[168:171], v[80:95]
  ds_read_b64_tr_b16 v[68:69], v29 offset:40960
  ds_read_b64_tr_b16 v[70:71], v29 offset:41472
  v_lshlrev_b32 v3, 16, v3
  v_sqrt_f32 v3, v3
  s_nop 0
  v_cvt_pk_bf16_f32 v3, v3, v3
  v_lshlrev_b32 v3, 16, v3
  v_rcp_f32 v34, v3
  v_mul_f32 v35, v3, v3
  v_mul_f32 v33, 0x3fb8aa3b, v34
  v_mfma_f32_32x32x16_bf16 v[80:95], v[76:79], v[172:175], v[80:95]
  ds_read_b64_tr_b16 v[72:73], v30 offset:40960
  ds_read_b64_tr_b16 v[74:75], v30 offset:41472
  v_mul_f32 v36, 0xc0135761, v34
  v_mul_f32 v2, v34, v34
  v_mul_f32 v2, v2, v36
  v_mul_f32 v37, 0x3d372713, v2
  v_cvt_pk_bf16_f32 v16, v112, v113
  v_cvt_pk_bf16_f32 v17, v114, v115
  v_cvt_pk_bf16_f32 v18, v116, v117
  v_cvt_pk_bf16_f32 v19, v118, v119
  s_waitcnt lgkmcnt(2)
  v_mfma_f32_16x16x32_bf16 v[56:59], v[52:55], v[64:67], v[56:59]
  v_mfma_f32_32x32x16_bf16 v[80:95], v[64:67], v[176:179], v[80:95]
  ds_read_b64_tr_b16 v[76:77], v31 offset:40960
  ds_read_b64_tr_b16 v[78:79], v31 offset:41472
  v_cvt_pk_bf16_f32 v20, v120, v121
  v_cvt_pk_bf16_f32 v21, v122, v123
  v_cvt_pk_bf16_f32 v22, v124, v125
  v_cvt_pk_bf16_f32 v23, v126, v127
  v_mfma_f32_32x32x16_bf16 v[128:143], v[38:41], v[16:19], 0
  s_nop 0
  v_mfma_f32_32x32x16_bf16 v[128:143], v[42:45], v[20:23], v[128:143]
  v_mfma_f32_32x32x16_bf16 v[80:95], v[68:71], v[180:183], v[80:95]
  ds_read_b64_tr_b16 v[64:65], v28 offset:49152
  ds_read_b64_tr_b16 v[66:67], v28 offset:49664
  s_waitcnt lgkmcnt(2)
  v_mfma_f32_32x32x16_bf16 v[80:95], v[72:75], v[184:187], v[80:95]
  ds_read_b64_tr_b16 v[68:69], v29 offset:49152
  ds_read_b64_tr_b16 v[70:71], v29 offset:49664
  v_mfma_f32_32x32x16_bf16 v[80:95], v[76:79], v[188:191], v[80:95]
  ds_read_b64_tr_b16 v[72:73], v30 offset:49152
  ds_read_b64_tr_b16 v[74:75], v30 offset:49664
  s_waitcnt lgkmcnt(2)
  v_mfma_f32_16x16x32_bf16 v[56:59], v[52:55], v[64:67], v[56:59]
  v_mfma_f32_32x32x16_bf16 v[80:95], v[64:67], v[192:195], v[80:95]
  ds_read_b64_tr_b16 v[76:77], v31 offset:49152
  ds_read_b64_tr_b16 v[78:79], v31 offset:49664
  v_max3_f32 v1, v128, v129, v130
  v_min3_f32 v2, v128, v129, v130
  v_max3_f32 v1, v1, v131, v132
  v_min3_f32 v2, v2, v131, v132
  v_max3_f32 v1, v1, v133, v134
  v_min3_f32 v2, v2, v133, v134
  v_max3_f32 v1, v1, v135, v136
  v_min3_f32 v2, v2, v135, v136
  v_max3_f32 v1, v1, v137, v138
  v_min3_f32 v2, v2, v137, v138
  v_max3_f32 v1, v1, v139, v140
  v_min3_f32 v2, v2, v139, v140
  v_max3_f32 v1, v1, v141, v142
  v_min3_f32 v2, v2, v141, v142
  v_mfma_f32_32x32x16_bf16 v[80:95], v[68:71], v[196:199], v[80:95]
  ds_read_b64_tr_b16 v[64:65], v28 offset:57344
  ds_read_b64_tr_b16 v[66:67], v28 offset:57856
  v_max_f32 v3, v1, v143
  v_min_f32 v4, v2, v143
  v_mov_b32 v1, v3
  v_mov_b32 v2, v4
  s_nop 0
  v_permlane32_swap_b32 v1, v3
  v_permlane32_swap_b32 v2, v4
  v_max_f32 v1, v1, v3
  v_min_f32 v2, v2, v4
  v_mul_f32_e64 v1, -v1, v33
  s_waitcnt lgkmcnt(2)
  v_mfma_f32_32x32x16_bf16 v[80:95], v[72:75], v[200:203], v[80:95]
  ds_read_b64_tr_b16 v[68:69], v29 offset:57344
  ds_read_b64_tr_b16 v[70:71], v29 offset:57856
  v_mul_f32 v2, v2, v33
  v_fma_f32 v112, v128, v33, v1
  v_fma_f32 v128, -v128, v33, v2
  v_fma_f32 v113, v129, v33, v1
  v_fma_f32 v129, -v129, v33, v2
  v_exp_f32 v112, v112
  v_exp_f32 v128, v128
  v_mfma_f32_32x32x16_bf16 v[80:95], v[76:79], v[204:207], v[80:95]
  ds_read_b64_tr_b16 v[72:73], v30 offset:57344
  ds_read_b64_tr_b16 v[74:75], v30 offset:57856
  v_fma_f32 v114, v130, v33, v1
  v_fma_f32 v130, -v130, v33, v2
  v_exp_f32 v113, v113
  v_exp_f32 v129, v129
  v_fma_f32 v115, v131, v33, v1
  v_fma_f32 v131, -v131, v33, v2
  v_exp_f32 v114, v114
  s_waitcnt lgkmcnt(2)
  v_mfma_f32_16x16x32_bf16 v[56:59], v[52:55], v[64:67], v[56:59]
  v_mfma_f32_32x32x16_bf16 v[80:95], v[64:67], v[208:211], v[80:95]
  ds_read_b64_tr_b16 v[76:77], v31 offset:57344
  ds_read_b64_tr_b16 v[78:79], v31 offset:57856
  v_exp_f32 v130, v130
  v_add_f32 v16, v112, v113
  v_add_f32 v17, v128, v129
  v_fma_f32 v116, v132, v33, v1
  v_fma_f32 v132, -v132, v33, v2
  v_exp_f32 v115, v115
  v_exp_f32 v131, v131
  v_mfma_f32_32x32x16_bf16 v[80:95], v[68:71], v[212:215], v[80:95]
  v_add_u32 v28, 0x10000, v28
  v_add_u32 v29, 0x10000, v29
  v_add_u32 v30, 0x10000, v30
  v_add_u32 v31, 0x10000, v31
  ds_read_b64_tr_b16 v[64:65], v28 offset:0
  ds_read_b64_tr_b16 v[66:67], v28 offset:512
  v_add_f32 v16, v16, v114
  v_add_f32 v17, v17, v130
  v_fma_f32 v117, v133, v33, v1
  v_fma_f32 v133, -v133, v33, v2
  v_exp_f32 v116, v116
  v_exp_f32 v132, v132
  s_waitcnt lgkmcnt(2)
  v_mfma_f32_32x32x16_bf16 v[80:95], v[72:75], v[216:219], v[80:95]
  ds_read_b64_tr_b16 v[68:69], v29 offset:0
  ds_read_b64_tr_b16 v[70:71], v29 offset:512
  v_add_f32 v16, v16, v115
  v_add_f32 v17, v17, v131
  v_fma_f32 v118, v134, v33, v1
  v_fma_f32 v134, -v134, v33, v2
  v_exp_f32 v117, v117
  v_exp_f32 v133, v133
  v_add_f32 v16, v16, v116
  v_mfma_f32_32x32x16_bf16 v[80:95], v[76:79], v[220:223], v[80:95]
  ds_read_b64_tr_b16 v[72:73], v30 offset:0
  ds_read_b64_tr_b16 v[74:75], v30 offset:512
  v_add_f32 v17, v17, v132
  v_fma_f32 v119, v135, v33, v1
  v_fma_f32 v135, -v135, v33, v2
  v_exp_f32 v118, v118
  v_exp_f32 v134, v134
  v_add_f32 v16, v16, v117
  v_add_f32 v17, v17, v133
  s_waitcnt lgkmcnt(2)
  v_mfma_f32_16x16x32_bf16 v[56:59], v[52:55], v[64:67], v[56:59]
  v_mfma_f32_32x32x16_bf16 v[80:95], v[64:67], v[224:227], v[80:95]
  ds_read_b64_tr_b16 v[76:77], v31 offset:0
  ds_read_b64_tr_b16 v[78:79], v31 offset:512
  v_fma_f32 v120, v136, v33, v1
  v_fma_f32 v136, -v136, v33, v2
  v_exp_f32 v119, v119
  v_exp_f32 v135, v135
  v_add_f32 v16, v16, v118
  v_add_f32 v17, v17, v134
  v_fma_f32 v121, v137, v33, v1
  v_mfma_f32_32x32x16_bf16 v[80:95], v[68:71], v[228:231], v[80:95]
  ds_read_b64_tr_b16 v[64:65], v28 offset:8192
  ds_read_b64_tr_b16 v[66:67], v28 offset:8704
  v_fma_f32 v137, -v137, v33, v2
  v_exp_f32 v120, v120
  v_exp_f32 v136, v136
  v_add_f32 v16, v16, v119
  v_add_f32 v17, v17, v135
  v_fma_f32 v122, v138, v33, v1
  v_fma_f32 v138, -v138, v33, v2
  s_waitcnt lgkmcnt(2)
  v_mfma_f32_32x32x16_bf16 v[80:95], v[72:75], v[232:235], v[80:95]
  ds_read_b64_tr_b16 v[68:69], v29 offset:8192
  ds_read_b64_tr_b16 v[70:71], v29 offset:8704
  v_exp_f32 v121, v121
  v_exp_f32 v137, v137
  v_add_f32 v16, v16, v120
  v_add_f32 v17, v17, v136
  v_fma_f32 v123, v139, v33, v1
  v_fma_f32 v139, -v139, v33, v2
  v_exp_f32 v122, v122
  v_mfma_f32_32x32x16_bf16 v[80:95], v[76:79], v[236:239], v[80:95]
  ds_read_b64_tr_b16 v[72:73], v30 offset:8192
  ds_read_b64_tr_b16 v[74:75], v30 offset:8704
  v_exp_f32 v138, v138
  v_add_f32 v16, v16, v121
  v_add_f32 v17, v17, v137
  v_fma_f32 v124, v140, v33, v1
  v_fma_f32 v140, -v140, v33, v2
  v_exp_f32 v123, v123
  v_exp_f32 v139, v139
  s_waitcnt lgkmcnt(2)
  v_mfma_f32_16x16x32_bf16 v[56:59], v[52:55], v[64:67], v[56:59]
  v_mfma_f32_32x32x16_bf16 v[80:95], v[64:67], v[240:243], v[80:95]
  ds_read_b64_tr_b16 v[76:77], v31 offset:8192
  ds_read_b64_tr_b16 v[78:79], v31 offset:8704
  v_add_f32 v16, v16, v122
  v_add_f32 v17, v17, v138
  v_fma_f32 v125, v141, v33, v1
  v_fma_f32 v141, -v141, v33, v2
  v_exp_f32 v124, v124
  v_exp_f32 v140, v140
  ds_write2_b32 v10, v56, v57 offset0:0 offset1:64
  s_waitcnt lgkmcnt(0)
  s_barrier
  v_mfma_f32_32x32x16_bf16 v[80:95], v[68:71], v[244:247], v[80:95]
  ds_read_b64_tr_b16 v[64:65], v28 offset:16384
  ds_read_b64_tr_b16 v[66:67], v28 offset:16896
  ds_read_b128 v[60:63], v9 offset:0
  v_mfma_f32_32x32x16_bf16 v[80:95], v[72:75], v[248:251], v[80:95]
  ds_read_b64_tr_b16 v[68:69], v29 offset:16384
  ds_read_b64_tr_b16 v[70:71], v29 offset:16896
  v_mfma_f32_32x32x16_bf16 v[80:95], v[76:79], v[252:255], v[80:95]
  ds_read_b64_tr_b16 v[72:73], v30 offset:16384
  ds_read_b64_tr_b16 v[74:75], v30 offset:16896
  s_waitcnt lgkmcnt(2)
  v_mfma_f32_16x16x32_bf16 v[56:59], v[52:55], v[64:67], 0
  v_mfma_f32_32x32x16_bf16 v[96:111], v[64:67], v[144:147], 0
  ds_read_b64_tr_b16 v[76:77], v31 offset:16384
  ds_read_b64_tr_b16 v[78:79], v31 offset:16896
  v_add_f32 v60, v60, v61
  v_add_f32 v62, v62, v63
  v_add_f32 v60, v60, v62
  v_cvt_pk_bf16_f32 v61, v60, v60
  v_lshlrev_b32 v61, 16, v61
  v_sub_f32 v62, v60, v61
  v_cvt_pk_bf16_f32 v48, v61, v62
  v_mfma_f32_32x32x16_bf16 v[96:111], v[68:71], v[148:151], v[96:111]
  ds_read_b64_tr_b16 v[64:65], v28 offset:24576
  ds_read_b64_tr_b16 v[66:67], v28 offset:25088
  v_mfma_f32_32x32x8_bf16 v[80:95], v[48:49], v[46:47], v[80:95]
  v_add_f32 v16, v16, v123
  v_add_f32 v17, v17, v139
  v_fma_f32 v126, v142, v33, v1
  v_fma_f32 v142, -v142, v33, v2
  v_exp_f32 v125, v125
  v_exp_f32 v141, v141
  v_fma_f32 v127, v143, v33, v1
  v_fma_f32 v143, -v143, v33, v2
  v_exp_f32 v126, v126
  v_exp_f32 v142, v142
  s_waitcnt lgkmcnt(2)
  v_mfma_f32_32x32x16_bf16 v[96:111], v[72:75], v[152:155], v[96:111]
  ds_read_b64_tr_b16 v[68:69], v29 offset:24576
  ds_read_b64_tr_b16 v[70:71], v29 offset:25088
  v_add_f32 v18, v124, v125
  v_add_f32 v19, v140, v141
  v_exp_f32 v127, v127
  v_exp_f32 v143, v143
  v_add_f32 v18, v18, v126
  v_add_f32 v19, v19, v142
  v_add_f32 v18, v18, v127
  v_add_f32 v19, v19, v143
  v_fma_f32 v16, v18, v32, v16
  v_fma_f32 v17, v19, v32, v17
  v_mfma_f32_32x32x16_bf16 v[96:111], v[76:79], v[156:159], v[96:111]
  ds_read_b64_tr_b16 v[72:73], v30 offset:24576
  ds_read_b64_tr_b16 v[74:75], v30 offset:25088
  v_mov_b32 v18, v16
  v_mov_b32 v19, v17
  v_xor_b32 v21, 16, v8
  v_permlane32_swap_b32 v16, v18
  v_permlane32_swap_b32 v17, v19
  v_add_f32 v16, v16, v18
  v_add_f32 v17, v17, v19
  v_rcp_f32 v16, v16
  v_rcp_f32 v17, v17
  v_xor_b32 v22, 32, v8
  s_waitcnt lgkmcnt(2)
  v_mfma_f32_16x16x32_bf16 v[56:59], v[52:55], v[64:67], v[56:59]
  v_mfma_f32_32x32x16_bf16 v[96:111], v[64:67], v[160:163], v[96:111]
  ds_read_b64_tr_b16 v[76:77], v31 offset:24576
  ds_read_b64_tr_b16 v[78:79], v31 offset:25088
  v_mul_f32 v18, v16, v32
  v_mul_f32 v19, v17, v32
  v_xor_b32 v23, 48, v8
  v_mul_f32 v112, v112, v16
  v_mul_f32 v113, v113, v16
  v_mul_f32 v114, v114, v16
  v_mul_f32 v115, v115, v16
  v_cvt_pk_bf16_f32 v112, v112, v113
  v_cvt_pk_bf16_f32 v113, v114, v115
  ds_write_b64 v8, v[112:113]
  v_mul_f32 v116, v116, v16
  v_mul_f32 v117, v117, v16
  v_mfma_f32_32x32x16_bf16 v[96:111], v[68:71], v[164:167], v[96:111]
  ds_read_b64_tr_b16 v[64:65], v28 offset:32768
  ds_read_b64_tr_b16 v[66:67], v28 offset:33280
  v_mul_f32 v118, v118, v16
  v_mul_f32 v119, v119, v16
  v_cvt_pk_bf16_f32 v116, v116, v117
  v_cvt_pk_bf16_f32 v117, v118, v119
  ds_write_b64 v21, v[116:117]
  v_mul_f32 v120, v120, v16
  v_mul_f32 v121, v121, v16
  v_mul_f32 v122, v122, v16
  v_mul_f32 v123, v123, v16
  v_cvt_pk_bf16_f32 v120, v120, v121
  v_cvt_pk_bf16_f32 v121, v122, v123
  ds_write_b64 v22, v[120:121]
  s_waitcnt lgkmcnt(5)
  v_mfma_f32_32x32x16_bf16 v[96:111], v[72:75], v[168:171], v[96:111]
  ds_read_b64_tr_b16 v[68:69], v29 offset:32768
  ds_read_b64_tr_b16 v[70:71], v29 offset:33280
  v_mul_f32 v124, v124, v18
  v_mul_f32 v125, v125, v18
  v_mul_f32 v126, v126, v18
  v_mul_f32 v127, v127, v18
  v_cvt_pk_bf16_f32 v124, v124, v125
  v_cvt_pk_bf16_f32 v125, v126, v127
  ds_write_b64 v23, v[124:125]
  v_mul_f32 v128, v128, v17
  v_mul_f32 v129, v129, v17
  v_mul_f32 v130, v130, v17
  v_mul_f32 v131, v131, v17
  v_xor_b32 v8, 64, v8
  v_mfma_f32_32x32x16_bf16 v[96:111], v[76:79], v[172:175], v[96:111]
  ds_read_b64_tr_b16 v[72:73], v30 offset:32768
  ds_read_b64_tr_b16 v[74:75], v30 offset:33280
  v_cvt_pk_bf16_f32 v128, v128, v129
  v_cvt_pk_bf16_f32 v129, v130, v131
  ds_write_b64 v8, v[128:129]
  v_mul_f32 v132, v132, v17
  v_mul_f32 v133, v133, v17
  v_mul_f32 v134, v134, v17
  v_mul_f32 v135, v135, v17
  v_xor_b32 v21, 64, v21
  v_cvt_pk_bf16_f32 v132, v132, v133
  v_cvt_pk_bf16_f32 v133, v134, v135
  ds_write_b64 v21, v[132:133]
  v_mul_f32 v136, v136, v17
  s_waitcnt lgkmcnt(5)
  v_mfma_f32_16x16x32_bf16 v[56:59], v[52:55], v[64:67], v[56:59]
  v_mfma_f32_32x32x16_bf16 v[96:111], v[64:67], v[176:179], v[96:111]
  ds_read_b64_tr_b16 v[76:77], v31 offset:32768
  ds_read_b64_tr_b16 v[78:79], v31 offset:33280
  v_mul_f32 v137, v137, v17
  v_mul_f32 v138, v138, v17
  v_mul_f32 v139, v139, v17
  v_xor_b32 v22, 64, v22
  v_cvt_pk_bf16_f32 v136, v136, v137
  v_cvt_pk_bf16_f32 v137, v138, v139
  ds_write_b64 v22, v[136:137]
  v_mul_f32 v140, v140, v19
  v_mul_f32 v141, v141, v19
  v_mul_f32 v142, v142, v19
  v_mul_f32 v143, v143, v19
  v_xor_b32 v23, 64, v23
  v_cvt_pk_bf16_f32 v140, v140, v141
  v_cvt_pk_bf16_f32 v141, v142, v143
  ds_write_b64 v23, v[140:141]
  s_waitcnt lgkmcnt(0)
  s_barrier
  v_mfma_f32_32x32x16_bf16 v[96:111], v[68:71], v[180:183], v[96:111]
  ds_read_b64_tr_b16 v[64:65], v28 offset:40960
  ds_read_b64_tr_b16 v[66:67], v28 offset:41472
  v_mul_f32 v24, v80, v80
  v_mul_f32 v25, v81, v81
  v_fma_f32 v24, v24, v37, v36
  v_fma_f32 v25, v25, v37, v36
  v_mul_f32 v24, v24, v80
  v_mfma_f32_32x32x16_bf16 v[96:111], v[72:75], v[184:187], v[96:111]
  ds_read_b64_tr_b16 v[68:69], v29 offset:40960
  ds_read_b64_tr_b16 v[70:71], v29 offset:41472
  v_mul_f32 v25, v25, v81
  v_exp_f32 v24, v24
  v_exp_f32 v25, v25
  v_fma_f32 v24, v24, v35, v35
  v_fma_f32 v25, v25, v35, v35
  v_mfma_f32_32x32x16_bf16 v[96:111], v[76:79], v[188:191], v[96:111]
  ds_read_b64_tr_b16 v[72:73], v30 offset:40960
  ds_read_b64_tr_b16 v[74:75], v30 offset:41472
  v_mul_f32 v26, v82, v82
  v_mul_f32 v27, v83, v83
  v_fma_f32 v26, v26, v37, v36
  v_fma_f32 v27, v27, v37, v36
  v_mul_f32 v26, v26, v82
  v_mul_f32 v27, v27, v83
  v_rcp_f32 v24, v24
  s_waitcnt lgkmcnt(2)
  v_mfma_f32_16x16x32_bf16 v[56:59], v[52:55], v[64:67], v[56:59]
  v_mfma_f32_32x32x16_bf16 v[96:111], v[64:67], v[192:195], v[96:111]
  ds_read_b64_tr_b16 v[76:77], v31 offset:40960
  ds_read_b64_tr_b16 v[78:79], v31 offset:41472
  v_rcp_f32 v25, v25
  v_exp_f32 v26, v26
  v_exp_f32 v27, v27
  v_mul_f32 v80, v80, v24
  v_mfma_f32_32x32x16_bf16 v[96:111], v[68:71], v[196:199], v[96:111]
  ds_read_b64_tr_b16 v[64:65], v28 offset:49152
  ds_read_b64_tr_b16 v[66:67], v28 offset:49664
  v_mul_f32 v81, v81, v25
  v_fma_f32 v26, v26, v35, v35
  v_fma_f32 v27, v27, v35, v35
  v_mul_f32 v24, v84, v84
  v_mul_f32 v25, v85, v85
  v_fma_f32 v24, v24, v37, v36
  v_fma_f32 v25, v25, v37, v36
  s_waitcnt lgkmcnt(2)
  v_mfma_f32_32x32x16_bf16 v[96:111], v[72:75], v[200:203], v[96:111]
  ds_read_b64_tr_b16 v[68:69], v29 offset:49152
  ds_read_b64_tr_b16 v[70:71], v29 offset:49664
  v_mul_f32 v24, v24, v84
  v_mul_f32 v25, v25, v85
  v_rcp_f32 v26, v26
  v_rcp_f32 v27, v27
  v_exp_f32 v24, v24
  v_mfma_f32_32x32x16_bf16 v[96:111], v[76:79], v[204:207], v[96:111]
  ds_read_b64_tr_b16 v[72:73], v30 offset:49152
  ds_read_b64_tr_b16 v[74:75], v30 offset:49664
  v_exp_f32 v25, v25
  v_mul_f32 v82, v82, v26
  v_mul_f32 v83, v83, v27
  v_fma_f32 v24, v24, v35, v35
  v_fma_f32 v25, v25, v35, v35
  v_mul_f32 v26, v86, v86
  s_waitcnt lgkmcnt(2)
  v_mfma_f32_16x16x32_bf16 v[56:59], v[52:55], v[64:67], v[56:59]
  v_mfma_f32_32x32x16_bf16 v[96:111], v[64:67], v[208:211], v[96:111]
  ds_read_b64_tr_b16 v[76:77], v31 offset:49152
  ds_read_b64_tr_b16 v[78:79], v31 offset:49664
  v_mul_f32 v27, v87, v87
  v_fma_f32 v26, v26, v37, v36
  v_fma_f32 v27, v27, v37, v36
  v_mul_f32 v26, v26, v86
  v_mul_f32 v27, v27, v87
  v_rcp_f32 v24, v24
  v_mfma_f32_32x32x16_bf16 v[96:111], v[68:71], v[212:215], v[96:111]
  ds_read_b64_tr_b16 v[64:65], v28 offset:57344
  ds_read_b64_tr_b16 v[66:67], v28 offset:57856
  v_rcp_f32 v25, v25
  v_exp_f32 v26, v26
  v_exp_f32 v27, v27
  v_mul_f32 v84, v84, v24
  s_waitcnt lgkmcnt(2)
  v_mfma_f32_32x32x16_bf16 v[96:111], v[72:75], v[216:219], v[96:111]
  ds_read_b64_tr_b16 v[68:69], v29 offset:57344
  ds_read_b64_tr_b16 v[70:71], v29 offset:57856
  v_mul_f32 v85, v85, v25
  v_fma_f32 v26, v26, v35, v35
  v_fma_f32 v27, v27, v35, v35
  v_mul_f32 v24, v88, v88
  v_mul_f32 v25, v89, v89
  v_fma_f32 v24, v24, v37, v36
  v_fma_f32 v25, v25, v37, v36
  v_mul_f32 v24, v24, v88
  v_mfma_f32_32x32x16_bf16 v[96:111], v[76:79], v[220:223], v[96:111]
  ds_read_b64_tr_b16 v[72:73], v30 offset:57344
  ds_read_b64_tr_b16 v[74:75], v30 offset:57856
  v_mul_f32 v25, v25, v89
  v_rcp_f32 v26, v26
  v_rcp_f32 v27, v27
  v_exp_f32 v24, v24
  s_waitcnt lgkmcnt(2)
  v_mfma_f32_16x16x32_bf16 v[56:59], v[52:55], v[64:67], v[56:59]
  v_mfma_f32_32x32x16_bf16 v[96:111], v[64:67], v[224:227], v[96:111]
  ds_read_b64_tr_b16 v[76:77], v31 offset:57344
  ds_read_b64_tr_b16 v[78:79], v31 offset:57856
  v_exp_f32 v25, v25
  v_mul_f32 v86, v86, v26
  v_mul_f32 v87, v87, v27
  v_fma_f32 v24, v24, v35, v35
  v_fma_f32 v25, v25, v35, v35
  v_mul_f32 v26, v90, v90
  v_mfma_f32_32x32x16_bf16 v[96:111], v[68:71], v[228:231], v[96:111]
  v_add_u32 v28, 0xffff0000, v28
  v_add_u32 v29, 0xffff0000, v29
  v_add_u32 v30, 0xffff0000, v30
  v_add_u32 v31, 0xffff0000, v31
  ds_read_b64_tr_b16 v[64:65], v28 offset:0
  ds_read_b64_tr_b16 v[66:67], v28 offset:512
  v_mul_f32 v27, v91, v91
  v_fma_f32 v26, v26, v37, v36
  v_fma_f32 v27, v27, v37, v36
  v_mul_f32 v26, v26, v90
  v_mul_f32 v27, v27, v91
  v_rcp_f32 v24, v24
  v_rcp_f32 v25, v25
  s_waitcnt lgkmcnt(2)
  v_mfma_f32_32x32x16_bf16 v[96:111], v[72:75], v[232:235], v[96:111]
  ds_read_b64_tr_b16 v[68:69], v29 offset:0
  ds_read_b64_tr_b16 v[70:71], v29 offset:512
  v_exp_f32 v26, v26
  v_exp_f32 v27, v27
  v_mul_f32 v88, v88, v24
  v_mul_f32 v89, v89, v25
  v_mfma_f32_32x32x16_bf16 v[96:111], v[76:79], v[236:239], v[96:111]
  ds_read_b64_tr_b16 v[72:73], v30 offset:0
  ds_read_b64_tr_b16 v[74:75], v30 offset:512
  v_fma_f32 v26, v26, v35, v35
  v_fma_f32 v27, v27, v35, v35
  v_mul_f32 v24, v92, v92
  v_mul_f32 v25, v93, v93
  v_fma_f32 v24, v24, v37, v36
  v_fma_f32 v25, v25, v37, v36
  v_mul_f32 v24, v24, v92
  s_waitcnt lgkmcnt(2)
  v_mfma_f32_16x16x32_bf16 v[56:59], v[52:55], v[64:67], v[56:59]
  v_mfma_f32_32x32x16_bf16 v[96:111], v[64:67], v[240:243], v[96:111]
  ds_read_b64_tr_b16 v[76:77], v31 offset:0
  ds_read_b64_tr_b16 v[78:79], v31 offset:512
  v_mul_f32 v25, v25, v93
  v_rcp_f32 v26, v26
  v_rcp_f32 v27, v27
  v_exp_f32 v24, v24
  s_nop 0
  ds_write2_b32 v10, v56, v57 offset0:128 offset1:192
  v_mfma_f32_32x32x16_bf16 v[96:111], v[68:71], v[244:247], v[96:111]
  ds_read_b64_tr_b16 v[64:65], v28 offset:8192
  ds_read_b64_tr_b16 v[66:67], v28 offset:8704
  v_exp_f32 v25, v25
  v_mul_f32 v90, v90, v26
  v_mul_f32 v91, v91, v27
  v_fma_f32 v24, v24, v35, v35
  v_fma_f32 v25, v25, v35, v35
  v_mul_f32 v26, v94, v94
  v_mul_f32 v27, v95, v95
  s_waitcnt lgkmcnt(3)
  v_mfma_f32_32x32x16_bf16 v[96:111], v[72:75], v[248:251], v[96:111]
  ds_read_b64_tr_b16 v[68:69], v29 offset:8192
  ds_read_b64_tr_b16 v[70:71], v29 offset:8704
  v_fma_f32 v26, v26, v37, v36
  v_fma_f32 v27, v27, v37, v36
  v_mul_f32 v26, v26, v94
  v_mul_f32 v27, v27, v95
  v_rcp_f32 v24, v24
  v_rcp_f32 v25, v25
  v_mfma_f32_32x32x16_bf16 v[96:111], v[76:79], v[252:255], v[96:111]
  ds_read_b64_tr_b16 v[72:73], v30 offset:8192
  ds_read_b64_tr_b16 v[74:75], v30 offset:8704
  v_exp_f32 v26, v26
  v_exp_f32 v27, v27
  v_mul_f32 v92, v92, v24
  v_mul_f32 v93, v93, v25
  s_waitcnt lgkmcnt(2)
  v_mfma_f32_16x16x32_bf16 v[56:59], v[52:55], v[64:67], 0
  v_mfma_f32_32x32x16_bf16 v[112:127], v[64:67], v[144:147], 0
  ds_read_b64_tr_b16 v[76:77], v31 offset:8192
  ds_read_b64_tr_b16 v[78:79], v31 offset:8704
  v_fma_f32 v26, v26, v35, v35
  v_fma_f32 v27, v27, v35, v35
  v_rcp_f32 v26, v26
  v_rcp_f32 v27, v27
  v_mul_f32 v94, v94, v26
  v_mul_f32 v95, v95, v27
  s_barrier
  v_mfma_f32_32x32x16_bf16 v[112:127], v[68:71], v[148:151], v[112:127]
  ds_read_b64_tr_b16 v[64:65], v28 offset:16384
  ds_read_b64_tr_b16 v[66:67], v28 offset:16896
  ds_read_b128 v[60:63], v9 offset:512
  s_waitcnt lgkmcnt(3)
  v_mfma_f32_32x32x16_bf16 v[112:127], v[72:75], v[152:155], v[112:127]
  ds_read_b64_tr_b16 v[68:69], v29 offset:16384
  ds_read_b64_tr_b16 v[70:71], v29 offset:16896
  v_mfma_f32_32x32x16_bf16 v[112:127], v[76:79], v[156:159], v[112:127]
  ds_read_b64_tr_b16 v[72:73], v30 offset:16384
  ds_read_b64_tr_b16 v[74:75], v30 offset:16896
  s_waitcnt lgkmcnt(2)
  v_mfma_f32_16x16x32_bf16 v[56:59], v[52:55], v[64:67], v[56:59]
  v_mfma_f32_32x32x16_bf16 v[112:127], v[64:67], v[160:163], v[112:127]
  ds_read_b64_tr_b16 v[76:77], v31 offset:16384
  ds_read_b64_tr_b16 v[78:79], v31 offset:16896
  v_add_f32 v60, v60, v61
  v_add_f32 v62, v62, v63
  v_add_f32 v60, v60, v62
  v_cvt_pk_bf16_f32 v61, v60, v60
  v_lshlrev_b32 v61, 16, v61
  v_sub_f32 v62, v60, v61
  v_cvt_pk_bf16_f32 v48, v61, v62
  v_mfma_f32_32x32x16_bf16 v[112:127], v[68:71], v[164:167], v[112:127]
  ds_read_b64_tr_b16 v[64:65], v28 offset:24576
  ds_read_b64_tr_b16 v[66:67], v28 offset:25088
  v_mfma_f32_32x32x8_bf16 v[96:111], v[48:49], v[46:47], v[96:111]
  s_xor_b32 s99, s96, 0
  s_lshl_b32 s99, s99, 12
  s_waitcnt lgkmcnt(2)
  v_mfma_f32_32x32x16_bf16 v[112:127], v[72:75], v[168:171], v[112:127]
  ds_read_b64_tr_b16 v[68:69], v29 offset:24576
  ds_read_b64_tr_b16 v[70:71], v29 offset:25088
  v_mfma_f32_32x32x16_bf16 v[112:127], v[76:79], v[172:175], v[112:127]
  ds_read_b64_tr_b16 v[72:73], v30 offset:24576
  ds_read_b64_tr_b16 v[74:75], v30 offset:25088
  s_waitcnt lgkmcnt(2)
  v_mfma_f32_16x16x32_bf16 v[56:59], v[52:55], v[64:67], v[56:59]
  v_mfma_f32_32x32x16_bf16 v[112:127], v[64:67], v[176:179], v[112:127]
  ds_read_b64_tr_b16 v[76:77], v31 offset:24576
  ds_read_b64_tr_b16 v[78:79], v31 offset:25088
  v_mul_f32 v96, v96, v80
  v_mul_f32 v97, v97, v81
  v_mul_f32 v98, v98, v82
  v_mul_f32 v99, v99, v83
  v_cvt_pk_bf16_f32 v80, v96, v97
  v_mul_f32 v100, v100, v84
  v_mul_f32 v101, v101, v85
  v_cvt_pk_bf16_f32 v81, v98, v99
  v_mul_f32 v102, v102, v86
  v_mul_f32 v103, v103, v87
  v_cvt_pk_bf16_f32 v82, v100, v101
  v_mul_f32 v104, v104, v88
  v_mul_f32 v105, v105, v89
  v_cvt_pk_bf16_f32 v83, v102, v103
  v_mul_f32 v106, v106, v90
  v_mul_f32 v107, v107, v91
  v_mfma_f32_32x32x16_bf16 v[112:127], v[68:71], v[180:183], v[112:127]
  ds_read_b64_tr_b16 v[64:65], v28 offset:32768
  ds_read_b64_tr_b16 v[66:67], v28 offset:33280
  v_cvt_pk_bf16_f32 v84, v104, v105
  v_mul_f32 v108, v108, v92
  v_mul_f32 v109, v109, v93
  v_cvt_pk_bf16_f32 v85, v106, v107
  v_mul_f32 v110, v110, v94
  v_mul_f32 v111, v111, v95
  v_cvt_pk_bf16_f32 v86, v108, v109
  v_cvt_pk_bf16_f32 v87, v110, v111
  buffer_store_dwordx4 v[80:83], v11, s[36:39], s99 offen sc1
  buffer_store_dwordx4 v[84:87], v11, s[36:39], s99 offen offset:1024 sc1
  s_waitcnt lgkmcnt(2)
  v_mfma_f32_32x32x16_bf16 v[112:127], v[72:75], v[184:187], v[112:127]
  ds_read_b64_tr_b16 v[68:69], v29 offset:32768
  ds_read_b64_tr_b16 v[70:71], v29 offset:33280
  v_mfma_f32_32x32x16_bf16 v[112:127], v[76:79], v[188:191], v[112:127]
  ds_read_b64_tr_b16 v[72:73], v30 offset:32768
  ds_read_b64_tr_b16 v[74:75], v30 offset:33280
  s_waitcnt lgkmcnt(2)
  v_mfma_f32_16x16x32_bf16 v[56:59], v[52:55], v[64:67], v[56:59]
  v_mfma_f32_32x32x16_bf16 v[112:127], v[64:67], v[192:195], v[112:127]
  ds_read_b64_tr_b16 v[76:77], v31 offset:32768
  ds_read_b64_tr_b16 v[78:79], v31 offset:33280
  v_mfma_f32_32x32x16_bf16 v[112:127], v[68:71], v[196:199], v[112:127]
  ds_read_b64_tr_b16 v[64:65], v28 offset:40960
  ds_read_b64_tr_b16 v[66:67], v28 offset:41472
  s_waitcnt lgkmcnt(2)
  v_mfma_f32_32x32x16_bf16 v[112:127], v[72:75], v[200:203], v[112:127]
  ds_read_b64_tr_b16 v[68:69], v29 offset:40960
  ds_read_b64_tr_b16 v[70:71], v29 offset:41472
  v_mfma_f32_32x32x16_bf16 v[112:127], v[76:79], v[204:207], v[112:127]
  ds_read_b64_tr_b16 v[72:73], v30 offset:40960
  ds_read_b64_tr_b16 v[74:75], v30 offset:41472
  s_waitcnt lgkmcnt(2)
  v_mfma_f32_16x16x32_bf16 v[56:59], v[52:55], v[64:67], v[56:59]
  v_mfma_f32_32x32x16_bf16 v[112:127], v[64:67], v[208:211], v[112:127]
  ds_read_b64_tr_b16 v[76:77], v31 offset:40960
  ds_read_b64_tr_b16 v[78:79], v31 offset:41472
  s_waitcnt vmcnt(0)
  s_barrier
  v_mfma_f32_32x32x16_bf16 v[112:127], v[68:71], v[212:215], v[112:127]
  ds_read_b64_tr_b16 v[64:65], v28 offset:49152
  ds_read_b64_tr_b16 v[66:67], v28 offset:49664
  s_cmp_lg_u32 s74, 0
  s_cbranch_scc1 L_flag_3
  s_lshl_b32 s83, s70, 9
  s_lshl_b32 s82, s71, 2
  s_add_u32 s83, s83, s82
  s_add_u32 s83, s83, 5120
  v_mov_b32 v5, s80
  v_lshlrev_b32 v6, 24, v7
  buffer_store_dword v5, v6, s[36:39], s83 offen sc1
L_flag_3:
  s_waitcnt lgkmcnt(2)
  v_mfma_f32_32x32x16_bf16 v[112:127], v[72:75], v[216:219], v[112:127]
  ds_read_b64_tr_b16 v[68:69], v29 offset:49152
  ds_read_b64_tr_b16 v[70:71], v29 offset:49664
  buffer_load_dwordx4 v[38:41], v13, s[4:7], 0 offen
  buffer_load_dwordx4 v[42:45], v13, s[4:7], 0 offen offset:32
  v_mfma_f32_32x32x16_bf16 v[112:127], v[76:79], v[220:223], v[112:127]
  ds_read_b64_tr_b16 v[72:73], v30 offset:49152
  ds_read_b64_tr_b16 v[74:75], v30 offset:49664
  s_waitcnt lgkmcnt(2)
  v_mfma_f32_16x16x32_bf16 v[56:59], v[52:55], v[64:67], v[56:59]
  v_mfma_f32_32x32x16_bf16 v[112:127], v[64:67], v[224:227], v[112:127]
  ds_read_b64_tr_b16 v[76:77], v31 offset:49152
  ds_read_b64_tr_b16 v[78:79], v31 offset:49664
  v_mfma_f32_32x32x16_bf16 v[112:127], v[68:71], v[228:231], v[112:127]
  ds_read_b64_tr_b16 v[64:65], v28 offset:57344
  ds_read_b64_tr_b16 v[66:67], v28 offset:57856
  s_waitcnt lgkmcnt(2)
  v_mfma_f32_32x32x16_bf16 v[112:127], v[72:75], v[232:235], v[112:127]
  ds_read_b64_tr_b16 v[68:69], v29 offset:57344
  ds_read_b64_tr_b16 v[70:71], v29 offset:57856
  v_mfma_f32_32x32x16_bf16 v[112:127], v[76:79], v[236:239], v[112:127]
  ds_read_b64_tr_b16 v[72:73], v30 offset:57344
  ds_read_b64_tr_b16 v[74:75], v30 offset:57856
  s_waitcnt lgkmcnt(2)
  v_mfma_f32_16x16x32_bf16 v[56:59], v[52:55], v[64:67], v[56:59]
  v_mfma_f32_32x32x16_bf16 v[112:127], v[64:67], v[240:243], v[112:127]
  ds_read_b64_tr_b16 v[76:77], v31 offset:57344
  ds_read_b64_tr_b16 v[78:79], v31 offset:57856
  s_nop 4
  ds_write2_b32 v10, v56, v57 offset0:0 offset1:64
  v_mfma_f32_32x32x16_bf16 v[112:127], v[68:71], v[244:247], v[112:127]
  v_add_u32 v28, 0x10000, v28
  v_add_u32 v29, 0x10000, v29
  v_add_u32 v30, 0x10000, v30
  v_add_u32 v31, 0x10000, v31
  ds_read_b64_tr_b16 v[64:65], v28 offset:0
  ds_read_b64_tr_b16 v[66:67], v28 offset:512
  s_waitcnt lgkmcnt(3)
  v_mfma_f32_32x32x16_bf16 v[112:127], v[72:75], v[248:251], v[112:127]
  ds_read_b64_tr_b16 v[68:69], v29 offset:0
  ds_read_b64_tr_b16 v[70:71], v29 offset:512
  v_mfma_f32_32x32x16_bf16 v[112:127], v[76:79], v[252:255], v[112:127]
  ds_read_b64_tr_b16 v[72:73], v30 offset:0
  ds_read_b64_tr_b16 v[74:75], v30 offset:512
  s_waitcnt lgkmcnt(2)
  v_mfma_f32_16x16x32_bf16 v[56:59], v[52:55], v[64:67], 0
  v_mfma_f32_32x32x16_bf16 v[128:143], v[64:67], v[144:147], 0
  ds_read_b64_tr_b16 v[76:77], v31 offset:0
  ds_read_b64_tr_b16 v[78:79], v31 offset:512
  s_barrier
  v_mfma_f32_32x32x16_bf16 v[128:143], v[68:71], v[148:151], v[128:143]
  ds_read_b64_tr_b16 v[64:65], v28 offset:8192
  ds_read_b64_tr_b16 v[66:67], v28 offset:8704
  ds_read_b128 v[60:63], v9 offset:0
  s_waitcnt lgkmcnt(3)
  v_mfma_f32_32x32x16_bf16 v[128:143], v[72:75], v[152:155], v[128:143]
  ds_read_b64_tr_b16 v[68:69], v29 offset:8192
  ds_read_b64_tr_b16 v[70:71], v29 offset:8704
  v_mfma_f32_32x32x16_bf16 v[128:143], v[76:79], v[156:159], v[128:143]
  ds_read_b64_tr_b16 v[72:73], v30 offset:8192
  ds_read_b64_tr_b16 v[74:75], v30 offset:8704
  s_waitcnt lgkmcnt(2)
  v_mfma_f32_16x16x32_bf16 v[56:59], v[52:55], v[64:67], v[56:59]
  v_mfma_f32_32x32x16_bf16 v[128:143], v[64:67], v[160:163], v[128:143]
  ds_read_b64_tr_b16 v[76:77], v31 offset:8192
  ds_read_b64_tr_b16 v[78:79], v31 offset:8704
  v_add_f32 v60, v60, v61
  v_add_f32 v62, v62, v63
  v_add_f32 v60, v60, v62
  v_cvt_pk_bf16_f32 v61, v60, v60
  v_lshlrev_b32 v61, 16, v61
  v_sub_f32 v62, v60, v61
  v_cvt_pk_bf16_f32 v48, v61, v62
  v_mfma_f32_32x32x16_bf16 v[128:143], v[68:71], v[164:167], v[128:143]
  ds_read_b64_tr_b16 v[64:65], v28 offset:16384
  ds_read_b64_tr_b16 v[66:67], v28 offset:16896
  v_mfma_f32_32x32x8_bf16 v[112:127], v[48:49], v[46:47], v[112:127]
  s_waitcnt lgkmcnt(2)
  v_mfma_f32_32x32x16_bf16 v[128:143], v[72:75], v[168:171], v[128:143]
  ds_read_b64_tr_b16 v[68:69], v29 offset:16384
  ds_read_b64_tr_b16 v[70:71], v29 offset:16896
  v_mfma_f32_32x32x16_bf16 v[128:143], v[76:79], v[172:175], v[128:143]
  ds_read_b64_tr_b16 v[72:73], v30 offset:16384
  ds_read_b64_tr_b16 v[74:75], v30 offset:16896
  s_waitcnt lgkmcnt(2)
  v_mfma_f32_16x16x32_bf16 v[56:59], v[52:55], v[64:67], v[56:59]
  v_mfma_f32_32x32x16_bf16 v[128:143], v[64:67], v[176:179], v[128:143]
  ds_read_b64_tr_b16 v[76:77], v31 offset:16384
  ds_read_b64_tr_b16 v[78:79], v31 offset:16896
  v_mul_f32 v24, v112, v112
  v_mul_f32 v25, v113, v113
  v_fma_f32 v24, v24, v37, v36
  v_fma_f32 v25, v25, v37, v36
  v_mul_f32 v24, v24, v112
  v_mul_f32 v25, v25, v113
  v_exp_f32 v24, v24
  v_exp_f32 v25, v25
  v_fma_f32 v24, v24, v35, v35
  v_fma_f32 v25, v25, v35, v35
  v_mul_f32 v26, v114, v114
  v_mfma_f32_32x32x16_bf16 v[128:143], v[68:71], v[180:183], v[128:143]
  ds_read_b64_tr_b16 v[64:65], v28 offset:24576
  ds_read_b64_tr_b16 v[66:67], v28 offset:25088
  v_mul_f32 v27, v115, v115
  v_fma_f32 v26, v26, v37, v36
  v_fma_f32 v27, v27, v37, v36
  v_mul_f32 v26, v26, v114
  v_mul_f32 v27, v27, v115
  v_rcp_f32 v24, v24
  v_rcp_f32 v25, v25
  s_waitcnt lgkmcnt(2)
  v_mfma_f32_32x32x16_bf16 v[128:143], v[72:75], v[184:187], v[128:143]
  ds_read_b64_tr_b16 v[68:69], v29 offset:24576
  ds_read_b64_tr_b16 v[70:71], v29 offset:25088
  s_lshr_b32 s83, s76, 1
  s_lshl_b32 s83, s83, 9
  s_add_u32 s83, s83, 5120
  v_lshrrev_b32 v5, 2, v7
  v_min_u32 v5, 52, v5
  v_add_u32 v5, s83, v5
  buffer_load_dword v6, v5, s[36:39], 0 offen sc1
  v_exp_f32 v26, v26
  v_exp_f32 v27, v27
  v_mul_f32 v112, v112, v24
  v_mul_f32 v113, v113, v25
  v_fma_f32 v26, v26, v35, v35
  v_mfma_f32_32x32x16_bf16 v[128:143], v[76:79], v[188:191], v[128:143]
  ds_read_b64_tr_b16 v[72:73], v30 offset:24576
  ds_read_b64_tr_b16 v[74:75], v30 offset:25088
  v_fma_f32 v27, v27, v35, v35
  v_mul_f32 v24, v116, v116
  v_mul_f32 v25, v117, v117
  v_fma_f32 v24, v24, v37, v36
  v_fma_f32 v25, v25, v37, v36
  v_mul_f32 v24, v24, v116
  v_mul_f32 v25, v25, v117
  v_rcp_f32 v26, v26
  s_waitcnt lgkmcnt(2)
  v_mfma_f32_16x16x32_bf16 v[56:59], v[52:55], v[64:67], v[56:59]
  v_mfma_f32_32x32x16_bf16 v[128:143], v[64:67], v[192:195], v[128:143]
  ds_read_b64_tr_b16 v[76:77], v31 offset:24576
  ds_read_b64_tr_b16 v[78:79], v31 offset:25088
  v_rcp_f32 v27, v27
  v_exp_f32 v24, v24
  v_exp_f32 v25, v25
  v_mul_f32 v114, v114, v26
  v_mul_f32 v115, v115, v27
  s_barrier
  v_mfma_f32_32x32x16_bf16 v[128:143], v[68:71], v[196:199], v[128:143]
  ds_read_b64_tr_b16 v[64:65], v28 offset:32768
  ds_read_b64_tr_b16 v[66:67], v28 offset:33280
  v_fma_f32 v24, v24, v35, v35
  v_fma_f32 v25, v25, v35, v35
  v_mul_f32 v26, v118, v118
  v_mul_f32 v27, v119, v119
  v_fma_f32 v26, v26, v37, v36
  v_fma_f32 v27, v27, v37, v36
  v_mul_f32 v26, v26, v118
  v_mul_f32 v27, v27, v119
  s_waitcnt lgkmcnt(2)
  v_mfma_f32_32x32x16_bf16 v[128:143], v[72:75], v[200:203], v[128:143]
  ds_read_b64_tr_b16 v[68:69], v29 offset:32768
  ds_read_b64_tr_b16 v[70:71], v29 offset:33280
  s_waitcnt vmcnt(0)
  v_cmp_ne_u32 vcc, s80, v6
  s_mov_b32 s87, 262144
  s_nop 1
  s_cbranch_vccz L_poll_4_x
L_poll_4:
  buffer_load_dword v6, v5, s[36:39], 0 offen sc1
  s_sub_u32 s87, s87, 1
  s_cbranch_scc1 L_poll_4_y
  s_waitcnt vmcnt(0)
  v_cmp_ne_u32 vcc, s80, v6
  s_nop 4
  s_cbranch_vccnz L_poll_4
L_poll_4_y:
  s_waitcnt vmcnt(0)
  s_nop 4
L_poll_4_x:
  v_rcp_f32 v24, v24
  v_rcp_f32 v25, v25
  v_exp_f32 v26, v26
  v_exp_f32 v27, v27
  v_mfma_f32_32x32x16_bf16 v[128:143], v[76:79], v[204:207], v[128:143]
  ds_read_b64_tr_b16 v[72:73], v30 offset:32768
  ds_read_b64_tr_b16 v[74:75], v30 offset:33280
  buffer_load_dwordx4 v[144:147], v12, s[36:39], s51 offen offset:0 sc1
  buffer_load_dwordx4 v[148:151], v12, s[36:39], s51 offen offset:1024 sc1
  v_mul_f32 v116, v116, v24
  v_mul_f32 v117, v117, v25
  v_fma_f32 v26, v26, v35, v35
  v_fma_f32 v27, v27, v35, v35
  v_mul_f32 v24, v120, v120
  v_mul_f32 v25, v121, v121
  v_fma_f32 v24, v24, v37, v36
  v_fma_f32 v25, v25, v37, v36
  s_waitcnt lgkmcnt(2)
  v_mfma_f32_16x16x32_bf16 v[56:59], v[52:55], v[64:67], v[56:59]
  v_mfma_f32_32x32x16_bf16 v[128:143], v[64:67], v[208:211], v[128:143]
  ds_read_b64_tr_b16 v[76:77], v31 offset:32768
  ds_read_b64_tr_b16 v[78:79], v31 offset:33280
  v_mul_f32 v24, v24, v120
  v_mul_f32 v25, v25, v121
  v_rcp_f32 v26, v26
  v_rcp_f32 v27, v27
  v_exp_f32 v24, v24
  v_mfma_f32_32x32x16_bf16 v[128:143], v[68:71], v[212:215], v[128:143]
  ds_read_b64_tr_b16 v[64:65], v28 offset:40960
  ds_read_b64_tr_b16 v[66:67], v28 offset:41472
  s_add_u32 s86, s51, 8192
  buffer_load_dwordx4 v[152:155], v12, s[36:39], s86 offen offset:0 sc1
  buffer_load_dwordx4 v[156:159], v12, s[36:39], s86 offen offset:1024 sc1
  v_exp_f32 v25, v25
  v_mul_f32 v118, v118, v26
  v_mul_f32 v119, v119, v27
  v_fma_f32 v24, v24, v35, v35
  v_fma_f32 v25, v25, v35, v35
  v_mul_f32 v26, v122, v122
  v_mul_f32 v27, v123, v123
  v_fma_f32 v26, v26, v37, v36
  s_waitcnt lgkmcnt(2)
  v_mfma_f32_32x32x16_bf16 v[128:143], v[72:75], v[216:219], v[128:143]
  ds_read_b64_tr_b16 v[68:69], v29 offset:40960
  ds_read_b64_tr_b16 v[70:71], v29 offset:41472
  v_fma_f32 v27, v27, v37, v36
  v_mul_f32 v26, v26, v122
  v_mul_f32 v27, v27, v123
  v_rcp_f32 v24, v24
  v_rcp_f32 v25, v25
  v_exp_f32 v26, v26
  v_mfma_f32_32x32x16_bf16 v[128:143], v[76:79], v[220:223], v[128:143]
  ds_read_b64_tr_b16 v[72:73], v30 offset:40960
  ds_read_b64_tr_b16 v[74:75], v30 offset:41472
  buffer_load_dwordx4 v[160:163], v12, s[36:39], s52 offen offset:0 sc1
  buffer_load_dwordx4 v[164:167], v12, s[36:39], s52 offen offset:1024 sc1
  v_exp_f32 v27, v27
  v_mul_f32 v120, v120, v24
  v_mul_f32 v121, v121, v25
  v_fma_f32 v26, v26, v35, v35
  v_fma_f32 v27, v27, v35, v35
  v_mul_f32 v24, v124, v124
  s_waitcnt lgkmcnt(2)
  v_mfma_f32_16x16x32_bf16 v[56:59], v[52:55], v[64:67], v[56:59]
  v_mfma_f32_32x32x16_bf16 v[128:143], v[64:67], v[224:227], v[128:143]
  ds_read_b64_tr_b16 v[76:77], v31 offset:40960
  ds_read_b64_tr_b16 v[78:79], v31 offset:41472
  v_mul_f32 v25, v125, v125
  v_fma_f32 v24, v24, v37, v36
  v_fma_f32 v25, v25, v37, v36
  v_mul_f32 v24, v24, v124
  v_mul_f32 v25, v25, v125
  v_rcp_f32 v26, v26
  v_rcp_f32 v27, v27
  v_mfma_f32_32x32x16_bf16 v[128:143], v[68:71], v[228:231], v[128:143]
  ds_read_b64_tr_b16 v[64:65], v28 offset:49152
  ds_read_b64_tr_b16 v[66:67], v28 offset:49664
  s_add_u32 s86, s52, 8192
  buffer_load_dwordx4 v[168:171], v12, s[36:39], s86 offen offset:0 sc1
  buffer_load_dwordx4 v[172:175], v12, s[36:39], s86 offen offset:1024 sc1
  v_exp_f32 v24, v24
  v_exp_f32 v25, v25
  v_mul_f32 v122, v122, v26
  v_mul_f32 v123, v123, v27
  v_fma_f32 v24, v24, v35, v35
  s_waitcnt lgkmcnt(2)
  v_mfma_f32_32x32x16_bf16 v[128:143], v[72:75], v[232:235], v[128:143]
  ds_read_b64_tr_b16 v[68:69], v29 offset:49152
  ds_read_b64_tr_b16 v[70:71], v29 offset:49664
  v_fma_f32 v25, v25, v35, v35
  v_mul_f32 v26, v126, v126
  v_mul_f32 v27, v127, v127
  v_fma_f32 v26, v26, v37, v36
  v_fma_f32 v27, v27, v37, v36
  v_mul_f32 v26, v26, v126
  v_mul_f32 v27, v27, v127
  v_rcp_f32 v24, v24
  v_mfma_f32_32x32x16_bf16 v[128:143], v[76:79], v[236:239], v[128:143]
  ds_read_b64_tr_b16 v[72:73], v30 offset:49152
  ds_read_b64_tr_b16 v[74:75], v30 offset:49664
  buffer_load_dwordx4 v[176:179], v12, s[36:39], s53 offen offset:0 sc1
  buffer_load_dwordx4 v[180:183], v12, s[36:39], s53 offen offset:1024 sc1
  v_rcp_f32 v25, v25
  v_exp_f32 v26, v26
  v_exp_f32 v27, v27
  v_mul_f32 v124, v124, v24
  s_waitcnt lgkmcnt(2)
  v_mfma_f32_16x16x32_bf16 v[56:59], v[52:55], v[64:67], v[56:59]
  v_mfma_f32_32x32x16_bf16 v[128:143], v[64:67], v[240:243], v[128:143]
  ds_read_b64_tr_b16 v[76:77], v31 offset:49152
  ds_read_b64_tr_b16 v[78:79], v31 offset:49664
  v_mul_f32 v125, v125, v25
  v_fma_f32 v26, v26, v35, v35
  v_fma_f32 v27, v27, v35, v35
  v_rcp_f32 v26, v26
  v_rcp_f32 v27, v27
  v_mul_f32 v126, v126, v26
  v_mul_f32 v127, v127, v27
  ds_write2_b32 v10, v56, v57 offset0:128 offset1:192
  s_waitcnt lgkmcnt(0)
  s_barrier
  v_mfma_f32_32x32x16_bf16 v[128:143], v[68:71], v[244:247], v[128:143]
  s_add_u32 s86, s53, 8192
  buffer_load_dwordx4 v[184:187], v12, s[36:39], s86 offen offset:0 sc1
  buffer_load_dwordx4 v[188:191], v12, s[36:39], s86 offen offset:1024 sc1
  ds_read_b128 v[60:63], v9 offset:512
  v_mfma_f32_32x32x16_bf16 v[128:143], v[72:75], v[248:251], v[128:143]
  v_mfma_f32_32x32x16_bf16 v[128:143], v[76:79], v[252:255], v[128:143]
  s_waitcnt lgkmcnt(0)
  v_add_f32 v60, v60, v61
  v_add_f32 v62, v62, v63
  v_add_f32 v60, v60, v62
  v_cvt_pk_bf16_f32 v61, v60, v60
  v_lshlrev_b32 v61, 16, v61
  v_sub_f32 v62, v60, v61
  v_cvt_pk_bf16_f32 v48, v61, v62
  s_nop 1
  v_mfma_f32_32x32x8_bf16 v[128:143], v[48:49], v[46:47], v[128:143]
  s_xor_b32 s99, s96, 1
  s_lshl_b32 s99, s99, 12
  s_nop 9
  v_mul_f32 v128, v128, v112
  v_mul_f32 v129, v129, v113
  v_mul_f32 v130, v130, v114
  v_mul_f32 v131, v131, v115
  v_cvt_pk_bf16_f32 v112, v128, v129
  v_mul_f32 v132, v132, v116
  v_mul_f32 v133, v133, v117
  v_cvt_pk_bf16_f32 v113, v130, v131
  v_mul_f32 v134, v134, v118
  v_mul_f32 v135, v135, v119
  v_cvt_pk_bf16_f32 v114, v132, v133
  v_mul_f32 v136, v136, v120
  v_mul_f32 v137, v137, v121
  v_cvt_pk_bf16_f32 v115, v134, v135
  v_mul_f32 v138, v138, v122
  v_mul_f32 v139, v139, v123
  v_cvt_pk_bf16_f32 v116, v136, v137
  v_mul_f32 v140, v140, v124
  v_mul_f32 v141, v141, v125
  v_cvt_pk_bf16_f32 v117, v138, v139
  v_mul_f32 v142, v142, v126
  v_mul_f32 v143, v143, v127
  v_cvt_pk_bf16_f32 v118, v140, v141
  v_cvt_pk_bf16_f32 v119, v142, v143
  buffer_store_dwordx4 v[112:115], v11, s[36:39], s99 offen sc1
  buffer_store_dwordx4 v[116:119], v11, s[36:39], s99 offen offset:1024 sc1
  v_xor_b32 v16, 64, v0
  s_and_b32 s89, s74, 1
  s_lshl_b32 s89, s89, 9
  v_add_u32 v0, 0x16000, v0
  v_add_u32 v16, 0x16000, v16
  ds_read_b64_tr_b16 v[56:57], v0 offset:32768
  ds_read_b64_tr_b16 v[58:59], v0 offset:33792
  ds_read_b64_tr_b16 v[60:61], v16 offset:32768
  ds_read_b64_tr_b16 v[62:63], v16 offset:33792
  ds_read_b64_tr_b16 v[64:65], v0 offset:34816
  ds_read_b64_tr_b16 v[66:67], v0 offset:35840
  ds_read_b64_tr_b16 v[68:69], v16 offset:34816
  ds_read_b64_tr_b16 v[70:71], v16 offset:35840
  ds_read_b64_tr_b16 v[72:73], v0 offset:40960
  ds_read_b64_tr_b16 v[74:75], v0 offset:41984
  ds_read_b64_tr_b16 v[76:77], v16 offset:40960
  ds_read_b64_tr_b16 v[78:79], v16 offset:41984
  s_waitcnt vmcnt(0)
  s_barrier
  s_cmp_lg_u32 s74, 0
  s_cbranch_scc1 L_flag_5
  s_lshl_b32 s83, s70, 9
  s_lshl_b32 s82, s71, 2
  s_add_u32 s83, s83, s82
  s_add_u32 s83, s83, 13312
  v_mov_b32 v5, s80
  v_lshlrev_b32 v6, 24, v7
  buffer_store_dword v5, v6, s[36:39], s83 offen sc1
L_flag_5:
  buffer_load_dwordx4 v[192:195], v12, s[36:39], s54 offen offset:0 sc1
  buffer_load_dwordx4 v[196:199], v12, s[36:39], s54 offen offset:1024 sc1
  s_add_u32 s86, s54, 8192
  buffer_load_dwordx4 v[200:203], v12, s[36:39], s86 offen offset:0 sc1
  buffer_load_dwordx4 v[204:207], v12, s[36:39], s86 offen offset:1024 sc1
  buffer_load_dwordx4 v[208:211], v12, s[36:39], s55 offen offset:0 sc1
  buffer_load_dwordx4 v[212:215], v12, s[36:39], s55 offen offset:1024 sc1
  s_add_u32 s86, s55, 8192
  buffer_load_dwordx4 v[216:219], v12, s[36:39], s86 offen offset:0 sc1
  buffer_load_dwordx4 v[220:223], v12, s[36:39], s86 offen offset:1024 sc1
  buffer_load_dwordx4 v[224:227], v12, s[36:39], s56 offen offset:0 sc1
  buffer_load_dwordx4 v[228:231], v12, s[36:39], s56 offen offset:1024 sc1
  s_add_u32 s86, s56, 8192
  buffer_load_dwordx4 v[232:235], v12, s[36:39], s86 offen offset:0 sc1
  buffer_load_dwordx4 v[236:239], v12, s[36:39], s86 offen offset:1024 sc1
  s_waitcnt lgkmcnt(8)
  v_mfma_f32_32x32x16_bf16 v[80:95], v[56:59], v[144:147], 0
  ds_read_b64_tr_b16 v[24:25], v0 offset:43008
  ds_read_b64_tr_b16 v[26:27], v0 offset:44032
  v_mfma_f32_32x32x16_bf16 v[96:111], v[60:63], v[144:147], 0
  ds_read_b64_tr_b16 v[28:29], v16 offset:43008
  ds_read_b64_tr_b16 v[30:31], v16 offset:44032
  s_barrier
  buffer_load_dwordx4 v[240:243], v12, s[36:39], s57 offen offset:0 sc1
  buffer_load_dwordx4 v[244:247], v12, s[36:39], s57 offen offset:1024 sc1
  s_add_u32 s86, s57, 8192
  buffer_load_dwordx4 v[248:251], v12, s[36:39], s86 offen offset:0 sc1
  buffer_load_dwordx4 v[252:255], v12, s[36:39], s86 offen offset:1024 sc1
  s_waitcnt lgkmcnt(8)
  v_mfma_f32_32x32x16_bf16 v[80:95], v[64:67], v[148:151], v[80:95]
  ds_read_b64_tr_b16 v[56:57], v0 offset:49152
  ds_read_b64_tr_b16 v[58:59], v0 offset:50176
  v_mfma_f32_32x32x16_bf16 v[96:111], v[68:71], v[148:151], v[96:111]
  ds_read_b64_tr_b16 v[60:61], v16 offset:49152
  ds_read_b64_tr_b16 v[62:63], v16 offset:50176
  s_waitcnt lgkmcnt(8)
  v_mfma_f32_32x32x16_bf16 v[80:95], v[72:75], v[152:155], v[80:95]
  ds_read_b64_tr_b16 v[64:65], v0 offset:51200
  ds_read_b64_tr_b16 v[66:67], v0 offset:52224
  v_mfma_f32_32x32x16_bf16 v[96:111], v[76:79], v[152:155], v[96:111]
  ds_read_b64_tr_b16 v[68:69], v16 offset:51200
  ds_read_b64_tr_b16 v[70:71], v16 offset:52224
  v_permlane32_swap_b32 v38, v40
  v_permlane32_swap_b32 v39, v41
  v_permlane32_swap_b32 v42, v44
  v_permlane32_swap_b32 v43, v45
  s_waitcnt lgkmcnt(8)
  v_mfma_f32_32x32x16_bf16 v[80:95], v[24:27], v[156:159], v[80:95]
  ds_read_b64_tr_b16 v[72:73], v0 offset:57344
  ds_read_b64_tr_b16 v[74:75], v0 offset:58368
  v_mfma_f32_32x32x16_bf16 v[96:111], v[28:31], v[156:159], v[96:111]
  ds_read_b64_tr_b16 v[76:77], v16 offset:57344
  ds_read_b64_tr_b16 v[78:79], v16 offset:58368
  v_lshlrev_b32 v32, 16, v38
  v_and_b32 v33, 0xffff0000, v38
  v_lshlrev_b32 v34, 16, v39
  v_and_b32 v35, 0xffff0000, v39
  s_waitcnt lgkmcnt(8)
  v_mfma_f32_32x32x16_bf16 v[80:95], v[56:59], v[160:163], v[80:95]
  ds_read_b64_tr_b16 v[24:25], v0 offset:59392
  ds_read_b64_tr_b16 v[26:27], v0 offset:60416
  v_mfma_f32_32x32x16_bf16 v[96:111], v[60:63], v[160:163], v[96:111]
  ds_read_b64_tr_b16 v[28:29], v16 offset:59392
  ds_read_b64_tr_b16 v[30:31], v16 offset:60416
  s_barrier
  v_lshlrev_b32 v18, 16, v40
  v_and_b32 v19, 0xffff0000, v40
  v_lshlrev_b32 v20, 16, v41
  v_and_b32 v21, 0xffff0000, v41
  s_waitcnt lgkmcnt(8)
  v_mfma_f32_32x32x16_bf16 v[80:95], v[64:67], v[164:167], v[80:95]
  v_add_u32 v0, 0xfffea000, v0
  v_add_u32 v16, 0xfffea000, v16
  ds_read_b64_tr_b16 v[56:57], v0 offset:0
  ds_read_b64_tr_b16 v[58:59], v0 offset:1024
  v_mfma_f32_32x32x16_bf16 v[96:111], v[68:71], v[164:167], v[96:111]
  ds_read_b64_tr_b16 v[60:61], v16 offset:0
  ds_read_b64_tr_b16 v[62:63], v16 offset:1024
  v_lshlrev_b32 v46, 16, v42
  v_and_b32 v47, 0xffff0000, v42
  v_lshlrev_b32 v48, 16, v43
  v_and_b32 v49, 0xffff0000, v43
  s_waitcnt lgkmcnt(8)
  v_mfma_f32_32x32x16_bf16 v[80:95], v[72:75], v[168:171], v[80:95]
  ds_read_b64_tr_b16 v[64:65], v0 offset:2048
  ds_read_b64_tr_b16 v[66:67], v0 offset:3072
  v_mfma_f32_32x32x16_bf16 v[96:111], v[76:79], v[168:171], v[96:111]
  ds_read_b64_tr_b16 v[68:69], v16 offset:2048
  ds_read_b64_tr_b16 v[70:71], v16 offset:3072
  v_lshlrev_b32 v52, 16, v44
  v_and_b32 v53, 0xffff0000, v44
  v_lshlrev_b32 v54, 16, v45
  v_and_b32 v55, 0xffff0000, v45
  s_waitcnt lgkmcnt(8)
  v_mfma_f32_32x32x16_bf16 v[80:95], v[24:27], v[172:175], v[80:95]
  ds_read_b64_tr_b16 v[72:73], v0 offset:8192
  ds_read_b64_tr_b16 v[74:75], v0 offset:9216
  v_mfma_f32_32x32x16_bf16 v[96:111], v[28:31], v[172:175], v[96:111]
  ds_read_b64_tr_b16 v[76:77], v16 offset:8192
  ds_read_b64_tr_b16 v[78:79], v16 offset:9216
  s_waitcnt lgkmcnt(8)
  v_mfma_f32_32x32x16_bf16 v[80:95], v[56:59], v[176:179], v[80:95]
  ds_read_b64_tr_b16 v[24:25], v0 offset:10240
  ds_read_b64_tr_b16 v[26:27], v0 offset:11264
  v_mfma_f32_32x32x16_bf16 v[96:111], v[60:63], v[176:179], v[96:111]
  ds_read_b64_tr_b16 v[28:29], v16 offset:10240
  ds_read_b64_tr_b16 v[30:31], v16 offset:11264
  s_barrier
  s_waitcnt lgkmcnt(8)
  v_mfma_f32_32x32x16_bf16 v[80:95], v[64:67], v[180:183], v[80:95]
  ds_read_b64_tr_b16 v[56:57], v0 offset:16384
  ds_read_b64_tr_b16 v[58:59], v0 offset:17408
  v_mfma_f32_32x32x16_bf16 v[96:111], v[68:71], v[180:183], v[96:111]
  ds_read_b64_tr_b16 v[60:61], v16 offset:16384
  ds_read_b64_tr_b16 v[62:63], v16 offset:17408
  s_waitcnt lgkmcnt(8)
  v_mfma_f32_32x32x16_bf16 v[80:95], v[72:75], v[184:187], v[80:95]
  ds_read_b64_tr_b16 v[64:65], v0 offset:18432
  ds_read_b64_tr_b16 v[66:67], v0 offset:19456
  v_mfma_f32_32x32x16_bf16 v[96:111], v[76:79], v[184:187], v[96:111]
  ds_read_b64_tr_b16 v[68:69], v16 offset:18432
  ds_read_b64_tr_b16 v[70:71], v16 offset:19456
  s_waitcnt lgkmcnt(8)
  v_mfma_f32_32x32x16_bf16 v[80:95], v[24:27], v[188:191], v[80:95]
  ds_read_b64_tr_b16 v[72:73], v0 offset:24576
  ds_read_b64_tr_b16 v[74:75], v0 offset:25600
  v_mfma_f32_32x32x16_bf16 v[96:111], v[28:31], v[188:191], v[96:111]
  ds_read_b64_tr_b16 v[76:77], v16 offset:24576
  ds_read_b64_tr_b16 v[78:79], v16 offset:25600
  s_waitcnt lgkmcnt(8)
  s_waitcnt vmcnt(15)
  v_mfma_f32_32x32x16_bf16 v[80:95], v[56:59], v[192:195], v[80:95]
  ds_read_b64_tr_b16 v[24:25], v0 offset:26624
  ds_read_b64_tr_b16 v[26:27], v0 offset:27648
  v_mfma_f32_32x32x16_bf16 v[96:111], v[60:63], v[192:195], v[96:111]
  ds_read_b64_tr_b16 v[28:29], v16 offset:26624
  ds_read_b64_tr_b16 v[30:31], v16 offset:27648
  s_barrier
  v_add_u32 v12, s97, v12
  buffer_load_dwordx4 v[144:147], v12, s[36:39], s51 offen offset:0 sc1
  buffer_load_dwordx4 v[148:151], v12, s[36:39], s51 offen offset:1024 sc1
  s_add_u32 s86, s51, 8192
  buffer_load_dwordx4 v[152:155], v12, s[36:39], s86 offen offset:0 sc1
  buffer_load_dwordx4 v[156:159], v12, s[36:39], s86 offen offset:1024 sc1
  s_waitcnt lgkmcnt(8)
  s_waitcnt vmcnt(18)
  v_mfma_f32_32x32x16_bf16 v[80:95], v[64:67], v[196:199], v[80:95]
  ds_read_b64_tr_b16 v[56:57], v0 offset:32768
  ds_read_b64_tr_b16 v[58:59], v0 offset:33792
  v_mfma_f32_32x32x16_bf16 v[96:111], v[68:71], v[196:199], v[96:111]
  ds_read_b64_tr_b16 v[60:61], v16 offset:32768
  ds_read_b64_tr_b16 v[62:63], v16 offset:33792
  buffer_load_dwordx4 v[160:163], v12, s[36:39], s52 offen offset:0 sc1
  buffer_load_dwordx4 v[164:167], v12, s[36:39], s52 offen offset:1024 sc1
  s_add_u32 s86, s52, 8192
  buffer_load_dwordx4 v[168:171], v12, s[36:39], s86 offen offset:0 sc1
  buffer_load_dwordx4 v[172:175], v12, s[36:39], s86 offen offset:1024 sc1
  s_waitcnt lgkmcnt(8)
  s_waitcnt vmcnt(21)
  v_mfma_f32_32x32x16_bf16 v[80:95], v[72:75], v[200:203], v[80:95]
  ds_read_b64_tr_b16 v[64:65], v0 offset:34816
  ds_read_b64_tr_b16 v[66:67], v0 offset:35840
  v_mfma_f32_32x32x16_bf16 v[96:111], v[76:79], v[200:203], v[96:111]
  ds_read_b64_tr_b16 v[68:69], v16 offset:34816
  ds_read_b64_tr_b16 v[70:71], v16 offset:35840
  buffer_load_dwordx4 v[176:179], v12, s[36:39], s53 offen offset:0 sc1
  buffer_load_dwordx4 v[180:183], v12, s[36:39], s53 offen offset:1024 sc1
  s_add_u32 s86, s53, 8192
  buffer_load_dwordx4 v[184:187], v12, s[36:39], s86 offen offset:0 sc1
  buffer_load_dwordx4 v[188:191], v12, s[36:39], s86 offen offset:1024 sc1
  s_waitcnt lgkmcnt(8)
  s_waitcnt vmcnt(24)
  v_mfma_f32_32x32x16_bf16 v[80:95], v[24:27], v[204:207], v[80:95]
  ds_read_b64_tr_b16 v[72:73], v0 offset:40960
  ds_read_b64_tr_b16 v[74:75], v0 offset:41984
  v_mfma_f32_32x32x16_bf16 v[96:111], v[28:31], v[204:207], v[96:111]
  ds_read_b64_tr_b16 v[76:77], v16 offset:40960
  ds_read_b64_tr_b16 v[78:79], v16 offset:41984
  buffer_load_dwordx4 v[192:195], v12, s[36:39], s54 offen offset:0 sc1
  buffer_load_dwordx4 v[196:199], v12, s[36:39], s54 offen offset:1024 sc1
  s_add_u32 s86, s54, 8192
  buffer_load_dwordx4 v[200:203], v12, s[36:39], s86 offen offset:0 sc1
  buffer_load_dwordx4 v[204:207], v12, s[36:39], s86 offen offset:1024 sc1
  s_waitcnt lgkmcnt(8)
  s_waitcnt vmcnt(27)
  v_mfma_f32_32x32x16_bf16 v[80:95], v[56:59], v[208:211], v[80:95]
  ds_read_b64_tr_b16 v[24:25], v0 offset:43008
  ds_read_b64_tr_b16 v[26:27], v0 offset:44032
  v_mfma_f32_32x32x16_bf16 v[96:111], v[60:63], v[208:211], v[96:111]
  ds_read_b64_tr_b16 v[28:29], v16 offset:43008
  ds_read_b64_tr_b16 v[30:31], v16 offset:44032
  s_barrier
  s_waitcnt lgkmcnt(8)
  s_waitcnt vmcnt(26)
  v_mfma_f32_32x32x16_bf16 v[80:95], v[64:67], v[212:215], v[80:95]
  ds_read_b64_tr_b16 v[56:57], v0 offset:49152
  ds_read_b64_tr_b16 v[58:59], v0 offset:50176
  v_mfma_f32_32x32x16_bf16 v[96:111], v[68:71], v[212:215], v[96:111]
  ds_read_b64_tr_b16 v[60:61], v16 offset:49152
  ds_read_b64_tr_b16 v[62:63], v16 offset:50176
  buffer_load_dwordx4 v[208:211], v12, s[36:39], s55 offen offset:0 sc1
  buffer_load_dwordx4 v[212:215], v12, s[36:39], s55 offen offset:1024 sc1
  s_waitcnt lgkmcnt(8)
  s_waitcnt vmcnt(27)
  v_mfma_f32_32x32x16_bf16 v[80:95], v[72:75], v[216:219], v[80:95]
  ds_read_b64_tr_b16 v[64:65], v0 offset:51200
  ds_read_b64_tr_b16 v[66:67], v0 offset:52224
  v_mfma_f32_32x32x16_bf16 v[96:111], v[76:79], v[216:219], v[96:111]
  ds_read_b64_tr_b16 v[68:69], v16 offset:51200
  ds_read_b64_tr_b16 v[70:71], v16 offset:52224
  s_waitcnt lgkmcnt(8)
  s_waitcnt vmcnt(26)
  v_mfma_f32_32x32x16_bf16 v[80:95], v[24:27], v[220:223], v[80:95]
  ds_read_b64_tr_b16 v[72:73], v0 offset:57344
  ds_read_b64_tr_b16 v[74:75], v0 offset:58368
  v_mfma_f32_32x32x16_bf16 v[96:111], v[28:31], v[220:223], v[96:111]
  ds_read_b64_tr_b16 v[76:77], v16 offset:57344
  ds_read_b64_tr_b16 v[78:79], v16 offset:58368
  s_add_u32 s86, s55, 8192
  buffer_load_dwordx4 v[216:219], v12, s[36:39], s86 offen offset:0 sc1
  buffer_load_dwordx4 v[220:223], v12, s[36:39], s86 offen offset:1024 sc1
  s_waitcnt lgkmcnt(8)
  s_waitcnt vmcnt(27)
  v_mfma_f32_32x32x16_bf16 v[80:95], v[56:59], v[224:227], v[80:95]
  ds_read_b64_tr_b16 v[24:25], v0 offset:59392
  ds_read_b64_tr_b16 v[26:27], v0 offset:60416
  v_mfma_f32_32x32x16_bf16 v[96:111], v[60:63], v[224:227], v[96:111]
  ds_read_b64_tr_b16 v[28:29], v16 offset:59392
  ds_read_b64_tr_b16 v[30:31], v16 offset:60416
  s_barrier
  s_waitcnt lgkmcnt(8)
  s_waitcnt vmcnt(26)
  v_mfma_f32_32x32x16_bf16 v[80:95], v[64:67], v[228:231], v[80:95]
  v_add_u32 v0, 0x10000, v0
  v_add_u32 v16, 0x10000, v16
  ds_read_b64_tr_b16 v[56:57], v0 offset:0
  ds_read_b64_tr_b16 v[58:59], v0 offset:1024
  v_mfma_f32_32x32x16_bf16 v[96:111], v[68:71], v[228:231], v[96:111]
  ds_read_b64_tr_b16 v[60:61], v16 offset:0
  ds_read_b64_tr_b16 v[62:63], v16 offset:1024
  buffer_load_dwordx4 v[224:227], v12, s[36:39], s56 offen offset:0 sc1
  buffer_load_dwordx4 v[228:231], v12, s[36:39], s56 offen offset:1024 sc1
  s_waitcnt lgkmcnt(8)
  s_waitcnt vmcnt(27)
  v_mfma_f32_32x32x16_bf16 v[80:95], v[72:75], v[232:235], v[80:95]
  ds_read_b64_tr_b16 v[64:65], v0 offset:2048
  ds_read_b64_tr_b16 v[66:67], v0 offset:3072
  v_mfma_f32_32x32x16_bf16 v[96:111], v[76:79], v[232:235], v[96:111]
  ds_read_b64_tr_b16 v[68:69], v16 offset:2048
  ds_read_b64_tr_b16 v[70:71], v16 offset:3072
  s_waitcnt lgkmcnt(8)
  s_waitcnt vmcnt(26)
  v_mfma_f32_32x32x16_bf16 v[80:95], v[24:27], v[236:239], v[80:95]
  ds_read_b64_tr_b16 v[72:73], v0 offset:8192
  ds_read_b64_tr_b16 v[74:75], v0 offset:9216
  v_mfma_f32_32x32x16_bf16 v[96:111], v[28:31], v[236:239], v[96:111]
  ds_read_b64_tr_b16 v[76:77], v16 offset:8192
  ds_read_b64_tr_b16 v[78:79], v16 offset:9216
  s_add_u32 s86, s56, 8192
  buffer_load_dwordx4 v[232:235], v12, s[36:39], s86 offen offset:0 sc1
  buffer_load_dwordx4 v[236:239], v12, s[36:39], s86 offen offset:1024 sc1
  s_waitcnt lgkmcnt(8)
  s_waitcnt vmcnt(27)
  v_mfma_f32_32x32x16_bf16 v[80:95], v[56:59], v[240:243], v[80:95]
  ds_read_b64_tr_b16 v[24:25], v0 offset:10240
  ds_read_b64_tr_b16 v[26:27], v0 offset:11264
  v_mfma_f32_32x32x16_bf16 v[96:111], v[60:63], v[240:243], v[96:111]
  ds_read_b64_tr_b16 v[28:29], v16 offset:10240
  ds_read_b64_tr_b16 v[30:31], v16 offset:11264
  s_barrier
  s_waitcnt lgkmcnt(8)
  s_waitcnt vmcnt(26)
  v_mfma_f32_32x32x16_bf16 v[80:95], v[64:67], v[244:247], v[80:95]
  ds_read_b64_tr_b16 v[56:57], v0 offset:16384
  ds_read_b64_tr_b16 v[58:59], v0 offset:17408
  v_mfma_f32_32x32x16_bf16 v[96:111], v[68:71], v[244:247], v[96:111]
  ds_read_b64_tr_b16 v[60:61], v16 offset:16384
  ds_read_b64_tr_b16 v[62:63], v16 offset:17408
  buffer_load_dwordx4 v[240:243], v12, s[36:39], s57 offen offset:0 sc1
  buffer_load_dwordx4 v[244:247], v12, s[36:39], s57 offen offset:1024 sc1
  s_waitcnt lgkmcnt(8)
  s_waitcnt vmcnt(27)
  v_mfma_f32_32x32x16_bf16 v[80:95], v[72:75], v[248:251], v[80:95]
  ds_read_b64_tr_b16 v[64:65], v0 offset:18432
  ds_read_b64_tr_b16 v[66:67], v0 offset:19456
  v_mfma_f32_32x32x16_bf16 v[96:111], v[76:79], v[248:251], v[96:111]
  ds_read_b64_tr_b16 v[68:69], v16 offset:18432
  ds_read_b64_tr_b16 v[70:71], v16 offset:19456
  s_waitcnt lgkmcnt(8)
  s_waitcnt vmcnt(26)
  v_mfma_f32_32x32x16_bf16 v[80:95], v[24:27], v[252:255], v[80:95]
  ds_read_b64_tr_b16 v[72:73], v0 offset:24576
  ds_read_b64_tr_b16 v[74:75], v0 offset:25600
  v_mfma_f32_32x32x16_bf16 v[96:111], v[28:31], v[252:255], v[96:111]
  ds_read_b64_tr_b16 v[76:77], v16 offset:24576
  ds_read_b64_tr_b16 v[78:79], v16 offset:25600
  s_add_u32 s86, s57, 8192
  buffer_load_dwordx4 v[248:251], v12, s[36:39], s86 offen offset:0 sc1
  buffer_load_dwordx4 v[252:255], v12, s[36:39], s86 offen offset:1024 sc1
  s_waitcnt lgkmcnt(8)
  s_waitcnt vmcnt(27)
  v_mfma_f32_32x32x16_bf16 v[80:95], v[56:59], v[144:147], v[80:95]
  ds_read_b64_tr_b16 v[24:25], v0 offset:26624
  ds_read_b64_tr_b16 v[26:27], v0 offset:27648
  v_mfma_f32_32x32x16_bf16 v[96:111], v[60:63], v[144:147], v[96:111]
  ds_read_b64_tr_b16 v[28:29], v16 offset:26624
  ds_read_b64_tr_b16 v[30:31], v16 offset:27648
  s_barrier
  s_waitcnt lgkmcnt(8)
  s_waitcnt vmcnt(26)
  v_mfma_f32_32x32x16_bf16 v[80:95], v[64:67], v[148:151], v[80:95]
  ds_read_b64_tr_b16 v[56:57], v0 offset:32768
  ds_read_b64_tr_b16 v[58:59], v0 offset:33792
  v_mfma_f32_32x32x16_bf16 v[96:111], v[68:71], v[148:151], v[96:111]
  ds_read_b64_tr_b16 v[60:61], v16 offset:32768
  ds_read_b64_tr_b16 v[62:63], v16 offset:33792
  s_waitcnt lgkmcnt(8)
  s_waitcnt vmcnt(25)
  v_mfma_f32_32x32x16_bf16 v[80:95], v[72:75], v[152:155], v[80:95]
  ds_read_b64_tr_b16 v[64:65], v0 offset:34816
  ds_read_b64_tr_b16 v[66:67], v0 offset:35840
  v_mfma_f32_32x32x16_bf16 v[96:111], v[76:79], v[152:155], v[96:111]
  ds_read_b64_tr_b16 v[68:69], v16 offset:34816
  ds_read_b64_tr_b16 v[70:71], v16 offset:35840
  s_waitcnt lgkmcnt(8)
  s_waitcnt vmcnt(24)
  v_mfma_f32_32x32x16_bf16 v[80:95], v[24:27], v[156:159], v[80:95]
  ds_read_b64_tr_b16 v[72:73], v0 offset:40960
  ds_read_b64_tr_b16 v[74:75], v0 offset:41984
  v_mfma_f32_32x32x16_bf16 v[96:111], v[28:31], v[156:159], v[96:111]
  ds_read_b64_tr_b16 v[76:77], v16 offset:40960
  ds_read_b64_tr_b16 v[78:79], v16 offset:41984
  s_waitcnt lgkmcnt(8)
  s_waitcnt vmcnt(23)
  v_mfma_f32_32x32x16_bf16 v[80:95], v[56:59], v[160:163], v[80:95]
  ds_read_b64_tr_b16 v[24:25], v0 offset:43008
  ds_read_b64_tr_b16 v[26:27], v0 offset:44032
  v_mfma_f32_32x32x16_bf16 v[96:111], v[60:63], v[160:163], v[96:111]
  ds_read_b64_tr_b16 v[28:29], v16 offset:43008
  ds_read_b64_tr_b16 v[30:31], v16 offset:44032
  s_barrier
  s_waitcnt lgkmcnt(8)
  s_waitcnt vmcnt(22)
  v_mfma_f32_32x32x16_bf16 v[80:95], v[64:67], v[164:167], v[80:95]
  ds_read_b64_tr_b16 v[56:57], v0 offset:49152
  ds_read_b64_tr_b16 v[58:59], v0 offset:50176
  v_mfma_f32_32x32x16_bf16 v[96:111], v[68:71], v[164:167], v[96:111]
  ds_read_b64_tr_b16 v[60:61], v16 offset:49152
  ds_read_b64_tr_b16 v[62:63], v16 offset:50176
  s_waitcnt lgkmcnt(8)
  s_waitcnt vmcnt(21)
  v_mfma_f32_32x32x16_bf16 v[80:95], v[72:75], v[168:171], v[80:95]
  ds_read_b64_tr_b16 v[64:65], v0 offset:51200
  ds_read_b64_tr_b16 v[66:67], v0 offset:52224
  v_mfma_f32_32x32x16_bf16 v[96:111], v[76:79], v[168:171], v[96:111]
  ds_read_b64_tr_b16 v[68:69], v16 offset:51200
  ds_read_b64_tr_b16 v[70:71], v16 offset:52224
  s_waitcnt lgkmcnt(8)
  s_waitcnt vmcnt(20)
  v_mfma_f32_32x32x16_bf16 v[80:95], v[24:27], v[172:175], v[80:95]
  ds_read_b64_tr_b16 v[72:73], v0 offset:57344
  ds_read_b64_tr_b16 v[74:75], v0 offset:58368
  v_mfma_f32_32x32x16_bf16 v[96:111], v[28:31], v[172:175], v[96:111]
  ds_read_b64_tr_b16 v[76:77], v16 offset:57344
  ds_read_b64_tr_b16 v[78:79], v16 offset:58368
  s_waitcnt lgkmcnt(8)
  s_waitcnt vmcnt(19)
  v_mfma_f32_32x32x16_bf16 v[80:95], v[56:59], v[176:179], v[80:95]
  ds_read_b64_tr_b16 v[24:25], v0 offset:59392
  ds_read_b64_tr_b16 v[26:27], v0 offset:60416
  v_mfma_f32_32x32x16_bf16 v[96:111], v[60:63], v[176:179], v[96:111]
  ds_read_b64_tr_b16 v[28:29], v16 offset:59392
  ds_read_b64_tr_b16 v[30:31], v16 offset:60416
  s_barrier
  s_waitcnt lgkmcnt(8)
  s_waitcnt vmcnt(18)
  v_mfma_f32_32x32x16_bf16 v[80:95], v[64:67], v[180:183], v[80:95]
  v_add_u32 v0, 0x6000, v0
  v_add_u32 v16, 0x6000, v16
  ds_read_b64_tr_b16 v[56:57], v0 offset:40960
  ds_read_b64_tr_b16 v[58:59], v0 offset:41984
  v_mfma_f32_32x32x16_bf16 v[96:111], v[68:71], v[180:183], v[96:111]
  ds_read_b64_tr_b16 v[60:61], v16 offset:40960
  ds_read_b64_tr_b16 v[62:63], v16 offset:41984
  s_waitcnt lgkmcnt(8)
  s_waitcnt vmcnt(17)
  v_mfma_f32_32x32x16_bf16 v[80:95], v[72:75], v[184:187], v[80:95]
  ds_read_b64_tr_b16 v[64:65], v0 offset:43008
  ds_read_b64_tr_b16 v[66:67], v0 offset:44032
  v_mfma_f32_32x32x16_bf16 v[96:111], v[76:79], v[184:187], v[96:111]
  ds_read_b64_tr_b16 v[68:69], v16 offset:43008
  ds_read_b64_tr_b16 v[70:71], v16 offset:44032
  s_waitcnt lgkmcnt(8)
  s_waitcnt vmcnt(16)
  v_mfma_f32_32x32x16_bf16 v[80:95], v[24:27], v[188:191], v[80:95]
  ds_read_b64_tr_b16 v[72:73], v0 offset:49152
  ds_read_b64_tr_b16 v[74:75], v0 offset:50176
  v_mfma_f32_32x32x16_bf16 v[96:111], v[28:31], v[188:191], v[96:111]
  ds_read_b64_tr_b16 v[76:77], v16 offset:49152
  ds_read_b64_tr_b16 v[78:79], v16 offset:50176
  s_waitcnt lgkmcnt(8)
  s_waitcnt vmcnt(15)
  v_mfma_f32_32x32x16_bf16 v[80:95], v[56:59], v[192:195], v[80:95]
  ds_read_b64_tr_b16 v[24:25], v0 offset:51200
  ds_read_b64_tr_b16 v[26:27], v0 offset:52224
  v_mfma_f32_32x32x16_bf16 v[96:111], v[60:63], v[192:195], v[96:111]
  ds_read_b64_tr_b16 v[28:29], v16 offset:51200
  ds_read_b64_tr_b16 v[30:31], v16 offset:52224
  s_barrier
  s_waitcnt lgkmcnt(8)
  s_waitcnt vmcnt(14)
  v_mfma_f32_32x32x16_bf16 v[80:95], v[64:67], v[196:199], v[80:95]
  ds_read_b64_tr_b16 v[56:57], v0 offset:57344
  ds_read_b64_tr_b16 v[58:59], v0 offset:58368
  v_mfma_f32_32x32x16_bf16 v[96:111], v[68:71], v[196:199], v[96:111]
  ds_read_b64_tr_b16 v[60:61], v16 offset:57344
  ds_read_b64_tr_b16 v[62:63], v16 offset:58368
  s_waitcnt lgkmcnt(8)
  s_waitcnt vmcnt(13)
  v_mfma_f32_32x32x16_bf16 v[80:95], v[72:75], v[200:203], v[80:95]
  ds_read_b64_tr_b16 v[64:65], v0 offset:59392
  ds_read_b64_tr_b16 v[66:67], v0 offset:60416
  v_mfma_f32_32x32x16_bf16 v[96:111], v[76:79], v[200:203], v[96:111]
  ds_read_b64_tr_b16 v[68:69], v16 offset:59392
  ds_read_b64_tr_b16 v[70:71], v16 offset:60416
  s_waitcnt lgkmcnt(8)
  s_waitcnt vmcnt(12)
  v_mfma_f32_32x32x16_bf16 v[80:95], v[24:27], v[204:207], v[80:95]
  v_add_u32 v0, 0xfffea000, v0
  v_add_u32 v16, 0xfffea000, v16
  ds_read_b64_tr_b16 v[72:73], v0 offset:0
  ds_read_b64_tr_b16 v[74:75], v0 offset:1024
  v_mfma_f32_32x32x16_bf16 v[96:111], v[28:31], v[204:207], v[96:111]
  ds_read_b64_tr_b16 v[76:77], v16 offset:0
  ds_read_b64_tr_b16 v[78:79], v16 offset:1024
  s_waitcnt lgkmcnt(8)
  s_waitcnt vmcnt(11)
  v_mfma_f32_32x32x16_bf16 v[80:95], v[56:59], v[208:211], v[80:95]
  ds_read_b64_tr_b16 v[24:25], v0 offset:2048
  ds_read_b64_tr_b16 v[26:27], v0 offset:3072
  v_mfma_f32_32x32x16_bf16 v[96:111], v[60:63], v[208:211], v[96:111]
  ds_read_b64_tr_b16 v[28:29], v16 offset:2048
  ds_read_b64_tr_b16 v[30:31], v16 offset:3072
  s_barrier
  s_waitcnt lgkmcnt(8)
  s_waitcnt vmcnt(10)
  v_mfma_f32_32x32x16_bf16 v[80:95], v[64:67], v[212:215], v[80:95]
  ds_read_b64_tr_b16 v[56:57], v0 offset:8192
  ds_read_b64_tr_b16 v[58:59], v0 offset:9216
  v_mfma_f32_32x32x16_bf16 v[96:111], v[68:71], v[212:215], v[96:111]
  ds_read_b64_tr_b16 v[60:61], v16 offset:8192
  ds_read_b64_tr_b16 v[62:63], v16 offset:9216
  s_waitcnt lgkmcnt(8)
  s_waitcnt vmcnt(9)
  v_mfma_f32_32x32x16_bf16 v[80:95], v[72:75], v[216:219], v[80:95]
  ds_read_b64_tr_b16 v[64:65], v0 offset:10240
  ds_read_b64_tr_b16 v[66:67], v0 offset:11264
  v_mfma_f32_32x32x16_bf16 v[96:111], v[76:79], v[216:219], v[96:111]
  ds_read_b64_tr_b16 v[68:69], v16 offset:10240
  ds_read_b64_tr_b16 v[70:71], v16 offset:11264
  s_waitcnt lgkmcnt(8)
  s_waitcnt vmcnt(8)
  v_mfma_f32_32x32x16_bf16 v[80:95], v[24:27], v[220:223], v[80:95]
  ds_read_b64_tr_b16 v[72:73], v0 offset:16384
  ds_read_b64_tr_b16 v[74:75], v0 offset:17408
  v_mfma_f32_32x32x16_bf16 v[96:111], v[28:31], v[220:223], v[96:111]
  ds_read_b64_tr_b16 v[76:77], v16 offset:16384
  ds_read_b64_tr_b16 v[78:79], v16 offset:17408
  s_waitcnt lgkmcnt(8)
  s_waitcnt vmcnt(7)
  v_mfma_f32_32x32x16_bf16 v[80:95], v[56:59], v[224:227], v[80:95]
  ds_read_b64_tr_b16 v[24:25], v0 offset:18432
  ds_read_b64_tr_b16 v[26:27], v0 offset:19456
  v_mfma_f32_32x32x16_bf16 v[96:111], v[60:63], v[224:227], v[96:111]
  ds_read_b64_tr_b16 v[28:29], v16 offset:18432
  ds_read_b64_tr_b16 v[30:31], v16 offset:19456
  s_barrier
  s_lshl_b32 s86, s96, 12
  s_add_u32 s86, s86, 110592
  v_add_u32 v12, s86, v12
  s_bfe_u32 s86, s98, 0x40000
  s_lshl_b32 s86, s86, 13
  buffer_load_dwordx4 v[144:147], v12, s[36:39], s86 offen offset:0 sc1
  buffer_load_dwordx4 v[148:151], v12, s[36:39], s86 offen offset:1024 sc1
  s_add_u32 s86, s86, 4096
  buffer_load_dwordx4 v[152:155], v12, s[36:39], s86 offen offset:0 sc1
  buffer_load_dwordx4 v[156:159], v12, s[36:39], s86 offen offset:1024 sc1
  s_waitcnt lgkmcnt(8)
  s_waitcnt vmcnt(10)
  v_mfma_f32_32x32x16_bf16 v[80:95], v[64:67], v[228:231], v[80:95]
  ds_read_b64_tr_b16 v[56:57], v0 offset:24576
  ds_read_b64_tr_b16 v[58:59], v0 offset:25600
  v_mfma_f32_32x32x16_bf16 v[96:111], v[68:71], v[228:231], v[96:111]
  ds_read_b64_tr_b16 v[60:61], v16 offset:24576
  ds_read_b64_tr_b16 v[62:63], v16 offset:25600
  s_bfe_u32 s86, s98, 0x40004
  s_lshl_b32 s86, s86, 13
  buffer_load_dwordx4 v[160:163], v12, s[36:39], s86 offen offset:0 sc1
  buffer_load_dwordx4 v[164:167], v12, s[36:39], s86 offen offset:1024 sc1
  s_add_u32 s86, s86, 4096
  buffer_load_dwordx4 v[168:171], v12, s[36:39], s86 offen offset:0 sc1
  buffer_load_dwordx4 v[172:175], v12, s[36:39], s86 offen offset:1024 sc1
  s_waitcnt lgkmcnt(8)
  s_waitcnt vmcnt(13)
  v_mfma_f32_32x32x16_bf16 v[80:95], v[72:75], v[232:235], v[80:95]
  ds_read_b64_tr_b16 v[64:65], v0 offset:26624
  ds_read_b64_tr_b16 v[66:67], v0 offset:27648
  v_mfma_f32_32x32x16_bf16 v[96:111], v[76:79], v[232:235], v[96:111]
  ds_read_b64_tr_b16 v[68:69], v16 offset:26624
  ds_read_b64_tr_b16 v[70:71], v16 offset:27648
  s_bfe_u32 s86, s98, 0x40008
  s_lshl_b32 s86, s86, 13
  buffer_load_dwordx4 v[176:179], v12, s[36:39], s86 offen offset:0 sc1
  buffer_load_dwordx4 v[180:183], v12, s[36:39], s86 offen offset:1024 sc1
  s_add_u32 s86, s86, 4096
  buffer_load_dwordx4 v[184:187], v12, s[36:39], s86 offen offset:0 sc1
  buffer_load_dwordx4 v[188:191], v12, s[36:39], s86 offen offset:1024 sc1
  s_waitcnt lgkmcnt(8)
  s_waitcnt vmcnt(16)
  v_mfma_f32_32x32x16_bf16 v[80:95], v[24:27], v[236:239], v[80:95]
  ds_read_b64_tr_b16 v[72:73], v0 offset:32768
  ds_read_b64_tr_b16 v[74:75], v0 offset:33792
  v_mfma_f32_32x32x16_bf16 v[96:111], v[28:31], v[236:239], v[96:111]
  ds_read_b64_tr_b16 v[76:77], v16 offset:32768
  ds_read_b64_tr_b16 v[78:79], v16 offset:33792
  s_bfe_u32 s86, s98, 0x4000c
  s_lshl_b32 s86, s86, 13
  buffer_load_dwordx4 v[192:195], v12, s[36:39], s86 offen offset:0 sc1
  buffer_load_dwordx4 v[196:199], v12, s[36:39], s86 offen offset:1024 sc1
  s_add_u32 s86, s86, 4096
  buffer_load_dwordx4 v[200:203], v12, s[36:39], s86 offen offset:0 sc1
  buffer_load_dwordx4 v[204:207], v12, s[36:39], s86 offen offset:1024 sc1
  s_waitcnt lgkmcnt(8)
  s_waitcnt vmcnt(19)
  v_mfma_f32_32x32x16_bf16 v[80:95], v[56:59], v[240:243], v[80:95]
  ds_read_b64_tr_b16 v[24:25], v0 offset:34816
  ds_read_b64_tr_b16 v[26:27], v0 offset:35840
  v_mfma_f32_32x32x16_bf16 v[96:111], v[60:63], v[240:243], v[96:111]
  ds_read_b64_tr_b16 v[28:29], v16 offset:34816
  ds_read_b64_tr_b16 v[30:31], v16 offset:35840
  s_barrier
  s_waitcnt lgkmcnt(8)
  s_waitcnt vmcnt(18)
  v_mfma_f32_32x32x16_bf16 v[80:95], v[64:67], v[244:247], v[80:95]
  v_subrev_u32 v0, s89, v0
  v_subrev_u32 v16, s89, v16
  ds_read_b64_tr_b16 v[56:57], v0 offset:40960
  ds_read_b64_tr_b16 v[58:59], v0 offset:41984
  v_mfma_f32_32x32x16_bf16 v[96:111], v[68:71], v[244:247], v[96:111]
  ds_read_b64_tr_b16 v[60:61], v16 offset:40960
  ds_read_b64_tr_b16 v[62:63], v16 offset:41984
  s_waitcnt lgkmcnt(8)
  s_waitcnt vmcnt(17)
  v_mfma_f32_32x32x16_bf16 v[80:95], v[72:75], v[248:251], v[80:95]
  ds_read_b64_tr_b16 v[64:65], v0 offset:43008
  ds_read_b64_tr_b16 v[66:67], v0 offset:44032
  v_mfma_f32_32x32x16_bf16 v[96:111], v[76:79], v[248:251], v[96:111]
  ds_read_b64_tr_b16 v[68:69], v16 offset:43008
  ds_read_b64_tr_b16 v[70:71], v16 offset:44032
  s_waitcnt lgkmcnt(8)
  s_waitcnt vmcnt(16)
  v_mfma_f32_32x32x16_bf16 v[80:95], v[24:27], v[252:255], v[80:95]
  ds_read_b64_tr_b16 v[72:73], v0 offset:49152
  ds_read_b64_tr_b16 v[74:75], v0 offset:50176
  v_mfma_f32_32x32x16_bf16 v[96:111], v[28:31], v[252:255], v[96:111]
  ds_read_b64_tr_b16 v[76:77], v16 offset:49152
  ds_read_b64_tr_b16 v[78:79], v16 offset:50176
  s_waitcnt lgkmcnt(8)
  s_waitcnt vmcnt(15)
  v_mfma_f32_32x32x16_bf16 v[112:127], v[56:59], v[144:147], 0
  ds_read_b64_tr_b16 v[24:25], v0 offset:51200
  ds_read_b64_tr_b16 v[26:27], v0 offset:52224
  v_mfma_f32_32x32x16_bf16 v[128:143], v[60:63], v[144:147], 0
  ds_read_b64_tr_b16 v[28:29], v16 offset:51200
  ds_read_b64_tr_b16 v[30:31], v16 offset:52224
  v_add_u32 v17, 106496, v50
  ds_write_b128 v17, v[80:83] offset:0
  ds_write_b128 v17, v[84:87] offset:1024
  ds_write_b128 v17, v[88:91] offset:2048
  ds_write_b128 v17, v[92:95] offset:3072
  s_waitcnt lgkmcnt(12)
  s_waitcnt vmcnt(14)
  v_mfma_f32_32x32x16_bf16 v[112:127], v[64:67], v[148:151], v[112:127]
  ds_read_b64_tr_b16 v[56:57], v0 offset:57344
  ds_read_b64_tr_b16 v[58:59], v0 offset:58368
  v_mfma_f32_32x32x16_bf16 v[128:143], v[68:71], v[148:151], v[128:143]
  ds_read_b64_tr_b16 v[60:61], v16 offset:57344
  ds_read_b64_tr_b16 v[62:63], v16 offset:58368
  ds_write_b128 v17, v[96:99] offset:4096
  ds_write_b128 v17, v[100:103] offset:5120
  ds_write_b128 v17, v[104:107] offset:6144
  ds_write_b128 v17, v[108:111] offset:7168
  s_waitcnt lgkmcnt(15)
  s_waitcnt vmcnt(13)
  v_mfma_f32_32x32x16_bf16 v[112:127], v[72:75], v[152:155], v[112:127]
  ds_read_b64_tr_b16 v[64:65], v0 offset:59392
  ds_read_b64_tr_b16 v[66:67], v0 offset:60416
  v_mfma_f32_32x32x16_bf16 v[128:143], v[76:79], v[152:155], v[128:143]
  ds_read_b64_tr_b16 v[68:69], v16 offset:59392
  ds_read_b64_tr_b16 v[70:71], v16 offset:60416
  s_waitcnt lgkmcnt(4)
  s_barrier
  s_lshl_b32 s82, s74, 12
  s_add_u32 s83, s82, 139264
  v_add_u32 v50, s83, v7
  s_xor_b32 s82, s82, 4096
  s_add_u32 s83, s82, 139264
  v_add_u32 v51, s83, v7
  s_waitcnt vmcnt(12)
  v_mfma_f32_32x32x16_bf16 v[112:127], v[24:27], v[156:159], v[112:127]
  v_add_u32 v0, 0x10000, v0
  v_add_u32 v16, 0x10000, v16
  ds_read_b64_tr_b16 v[72:73], v0 offset:0
  ds_read_b64_tr_b16 v[74:75], v0 offset:1024
  v_mfma_f32_32x32x16_bf16 v[128:143], v[28:31], v[156:159], v[128:143]
  ds_read_b64_tr_b16 v[76:77], v16 offset:0
  ds_read_b64_tr_b16 v[78:79], v16 offset:1024
  s_waitcnt vmcnt(11)
  v_mfma_f32_32x32x16_bf16 v[112:127], v[56:59], v[160:163], v[112:127]
  ds_read_b64_tr_b16 v[24:25], v0 offset:2048
  ds_read_b64_tr_b16 v[26:27], v0 offset:3072
  v_mfma_f32_32x32x16_bf16 v[128:143], v[60:63], v[160:163], v[128:143]
  ds_read_b64_tr_b16 v[28:29], v16 offset:2048
  ds_read_b64_tr_b16 v[30:31], v16 offset:3072
  s_waitcnt lgkmcnt(8)
  s_waitcnt vmcnt(10)
  v_mfma_f32_32x32x16_bf16 v[112:127], v[64:67], v[164:167], v[112:127]
  ds_read_b64_tr_b16 v[56:57], v0 offset:8192
  ds_read_b64_tr_b16 v[58:59], v0 offset:9216
  v_mfma_f32_32x32x16_bf16 v[128:143], v[68:71], v[164:167], v[128:143]
  ds_read_b64_tr_b16 v[60:61], v16 offset:8192
  ds_read_b64_tr_b16 v[62:63], v16 offset:9216
  s_waitcnt lgkmcnt(8)
  s_waitcnt vmcnt(9)
  v_mfma_f32_32x32x16_bf16 v[112:127], v[72:75], v[168:171], v[112:127]
  ds_read_b64_tr_b16 v[64:65], v0 offset:10240
  ds_read_b64_tr_b16 v[66:67], v0 offset:11264
  v_mfma_f32_32x32x16_bf16 v[128:143], v[76:79], v[168:171], v[128:143]
  ds_read_b64_tr_b16 v[68:69], v16 offset:10240
  ds_read_b64_tr_b16 v[70:71], v16 offset:11264
  s_waitcnt lgkmcnt(8)
  s_waitcnt vmcnt(8)
  v_mfma_f32_32x32x16_bf16 v[112:127], v[24:27], v[172:175], v[112:127]
  ds_read_b64_tr_b16 v[72:73], v0 offset:16384
  ds_read_b64_tr_b16 v[74:75], v0 offset:17408
  v_mfma_f32_32x32x16_bf16 v[128:143], v[28:31], v[172:175], v[128:143]
  ds_read_b64_tr_b16 v[76:77], v16 offset:16384
  ds_read_b64_tr_b16 v[78:79], v16 offset:17408
  s_waitcnt lgkmcnt(8)
  s_waitcnt vmcnt(7)
  v_mfma_f32_32x32x16_bf16 v[112:127], v[56:59], v[176:179], v[112:127]
  ds_read_b64_tr_b16 v[24:25], v0 offset:18432
  ds_read_b64_tr_b16 v[26:27], v0 offset:19456
  v_mfma_f32_32x32x16_bf16 v[128:143], v[60:63], v[176:179], v[128:143]
  ds_read_b64_tr_b16 v[28:29], v16 offset:18432
  ds_read_b64_tr_b16 v[30:31], v16 offset:19456
  s_waitcnt lgkmcnt(8)
  s_waitcnt vmcnt(6)
  v_mfma_f32_32x32x16_bf16 v[112:127], v[64:67], v[180:183], v[112:127]
  ds_read_b64_tr_b16 v[56:57], v0 offset:24576
  ds_read_b64_tr_b16 v[58:59], v0 offset:25600
  v_mfma_f32_32x32x16_bf16 v[128:143], v[68:71], v[180:183], v[128:143]
  ds_read_b64_tr_b16 v[60:61], v16 offset:24576
  ds_read_b64_tr_b16 v[62:63], v16 offset:25600
  s_waitcnt lgkmcnt(8)
  s_waitcnt vmcnt(5)
  v_mfma_f32_32x32x16_bf16 v[112:127], v[72:75], v[184:187], v[112:127]
  ds_read_b64_tr_b16 v[64:65], v0 offset:26624
  ds_read_b64_tr_b16 v[66:67], v0 offset:27648
  v_mfma_f32_32x32x16_bf16 v[128:143], v[76:79], v[184:187], v[128:143]
  ds_read_b64_tr_b16 v[68:69], v16 offset:26624
  ds_read_b64_tr_b16 v[70:71], v16 offset:27648
  s_waitcnt lgkmcnt(8)
  s_waitcnt vmcnt(4)
  v_mfma_f32_32x32x16_bf16 v[112:127], v[24:27], v[188:191], v[112:127]
  ds_read_b64_tr_b16 v[72:73], v0 offset:32768
  ds_read_b64_tr_b16 v[74:75], v0 offset:33792
  v_mfma_f32_32x32x16_bf16 v[128:143], v[28:31], v[188:191], v[128:143]
  ds_read_b64_tr_b16 v[76:77], v16 offset:32768
  ds_read_b64_tr_b16 v[78:79], v16 offset:33792
  s_waitcnt lgkmcnt(8)
  s_waitcnt vmcnt(3)
  v_mfma_f32_32x32x16_bf16 v[112:127], v[56:59], v[192:195], v[112:127]
  ds_read_b64_tr_b16 v[24:25], v0 offset:34816
  ds_read_b64_tr_b16 v[26:27], v0 offset:35840
  v_mfma_f32_32x32x16_bf16 v[128:143], v[60:63], v[192:195], v[128:143]
  ds_read_b64_tr_b16 v[28:29], v16 offset:34816
  ds_read_b64_tr_b16 v[30:31], v16 offset:35840
  s_waitcnt lgkmcnt(8)
  s_waitcnt vmcnt(2)
  v_mfma_f32_32x32x16_bf16 v[112:127], v[64:67], v[196:199], v[112:127]
  v_mfma_f32_32x32x16_bf16 v[128:143], v[68:71], v[196:199], v[128:143]
  s_waitcnt lgkmcnt(4)
  s_waitcnt vmcnt(1)
  v_mfma_f32_32x32x16_bf16 v[112:127], v[72:75], v[200:203], v[112:127]
  v_mfma_f32_32x32x16_bf16 v[128:143], v[76:79], v[200:203], v[128:143]
  s_waitcnt lgkmcnt(0)
  s_waitcnt vmcnt(0)
  v_mfma_f32_32x32x16_bf16 v[112:127], v[24:27], v[204:207], v[112:127]
  v_mfma_f32_32x32x16_bf16 v[128:143], v[28:31], v[204:207], v[128:143]
  s_nop 11
  ds_write_b128 v50, v[128:131] offset:0
  ds_write_b128 v50, v[132:135] offset:1024
  ds_write_b128 v50, v[136:139] offset:2048
  ds_write_b128 v50, v[140:143] offset:3072
  s_waitcnt lgkmcnt(0)
  s_barrier
  ds_read_b128 v[128:131], v51 offset:0
  ds_read_b128 v[80:83], v17 offset:0
  ds_read_b128 v[132:135], v51 offset:1024
  ds_read_b128 v[84:87], v17 offset:1024
  ds_read_b128 v[136:139], v51 offset:2048
  ds_read_b128 v[88:91], v17 offset:2048
  ds_read_b128 v[140:143], v51 offset:3072
  ds_read_b128 v[92:95], v17 offset:3072
  s_waitcnt lgkmcnt(7)
  v_add_f32 v112, v112, v128
  s_waitcnt lgkmcnt(6)
  v_fma_f32 v112, v112, v80, v32
  v_add_f32 v113, v113, v129
  v_fma_f32 v113, v113, v81, v33
  v_cvt_pk_bf16_f32 v64, v112, v113
  v_add_f32 v114, v114, v130
  v_fma_f32 v114, v114, v82, v34
  v_add_f32 v115, v115, v131
  v_fma_f32 v115, v115, v83, v35
  v_cvt_pk_bf16_f32 v65, v114, v115
  s_waitcnt lgkmcnt(5)
  v_add_f32 v116, v116, v132
  s_waitcnt lgkmcnt(4)
  v_fma_f32 v116, v116, v84, v18
  v_add_f32 v117, v117, v133
  v_fma_f32 v117, v117, v85, v19
  v_cvt_pk_bf16_f32 v66, v116, v117
  v_add_f32 v118, v118, v134
  v_fma_f32 v118, v118, v86, v20
  v_add_f32 v119, v119, v135
  v_fma_f32 v119, v119, v87, v21
  v_cvt_pk_bf16_f32 v67, v118, v119
  s_waitcnt lgkmcnt(3)
  v_add_f32 v120, v120, v136
  s_waitcnt lgkmcnt(2)
  v_fma_f32 v120, v120, v88, v46
  v_add_f32 v121, v121, v137
  v_fma_f32 v121, v121, v89, v47
  v_cvt_pk_bf16_f32 v68, v120, v121
  v_add_f32 v122, v122, v138
  v_fma_f32 v122, v122, v90, v48
  v_add_f32 v123, v123, v139
  v_fma_f32 v123, v123, v91, v49
  v_cvt_pk_bf16_f32 v69, v122, v123
  s_waitcnt lgkmcnt(1)
  v_add_f32 v124, v124, v140
  s_waitcnt lgkmcnt(0)
  v_fma_f32 v124, v124, v92, v52
  v_add_f32 v125, v125, v141
  v_fma_f32 v125, v125, v93, v53
  v_cvt_pk_bf16_f32 v70, v124, v125
  v_add_f32 v126, v126, v142
  v_fma_f32 v126, v126, v94, v54
  v_add_f32 v127, v127, v143
  v_fma_f32 v127, v127, v95, v55
  v_cvt_pk_bf16_f32 v71, v126, v127
  v_permlane32_swap_b32 v64, v66
  v_permlane32_swap_b32 v65, v67
  v_permlane32_swap_b32 v68, v70
  v_permlane32_swap_b32 v69, v71
  buffer_store_dwordx4 v[64:67], v13, s[32:35], 0 offen nt
  buffer_store_dwordx4 v[68:71], v13, s[32:35], 0 offen offset:32 nt
  s_endpgm
L_p1:
  s_and_b32 s82, s2, 7
  s_lshr_b32 s83, s2, 3
  s_mul_i32 s84, s83, 37
  s_lshr_b32 s84, s84, 8
  s_mul_i32 s85, s84, 7
  s_sub_u32 s77, s83, s85
  s_lshl_b32 s76, s82, 2
  s_add_u32 s76, s76, s84
  s_mul_i32 s84, s82, 28
  s_add_u32 s84, s84, s83
  s_cmp_ge_u32 s84, 112
  s_cselect_b32 s85, 112, 0
  s_cselect_b32 s70, 8, 0
  s_sub_u32 s84, s84, s85
  s_lshr_b32 s71, s84, 3
  s_and_b32 s84, s84, 7
  s_add_u32 s70, s70, s84
  s_mov_b32 s96, 0x76543210
  s_mov_b32 s97, 0xfedcba98
  s_lshl_b32 s82, s71, 2
  s_lshr_b64 s[96:97], s[96:97], s82
  s_and_b32 s72, s96, 15
  s_and_b32 s82, s71, 1
  s_mul_i32 s82, s82, 4
  s_and_b32 s84, s84, 7
  s_mul_i32 s84, s84, 1
  s_add_u32 s82, s82, s84
  s_mov_b32 s96, 0
  s_mul_i32 s85, s82, 37
  s_lshr_b32 s85, s85, 8
  s_mul_i32 s85, s85, 7
  s_sub_u32 s82, s82, s85
  s_mov_b32 s84, 0x06543210
  s_mov_b32 s85, 0x00654321
  s_lshl_b32 s82, s82, 2
  s_lshr_b64 s[84:85], s[84:85], s82
  s_mov_b32 s95, s84
  s_and_b32 s74, s73, 3
  s_lshr_b32 s75, s73, 2
  s_lshl_b32 s3, s74, 10
  s_lshl_b32 s94, s74, 11
  v_lshrrev_b32 v1, 3, v0
  v_and_b32 v2, 7, v0
  v_lshrrev_b32 v4, 1, v1
  v_xor_b32 v4, v4, v2
  s_lshl_b32 s83, s70, 3
  s_add_u32 s83, s83, s74
  s_lshl_b32 s83, s83, 4
  v_add_u32 v5, s83, v1
  v_mul_u32_u24 v5, 896, v5
  v_lshl_add_u32 v15, v4, 4, v5
  v_xor_b32 v4, 4, v4
  v_lshl_add_u32 v24, v4, 4, v5
  v_add_u32 v24, 6144, v24
  v_lshrrev_b32 v4, 2, v0
  s_lshl_b32 s82, s74, 4
  v_add_u32 v4, s82, v4
  v_mul_u32_u24 v4, 2688, v4
  s_mul_i32 s82, s72, 56
  s_and_b32 s99, s82, 8
  s_and_b32 s82, s82, 0xfff0
  s_add_u32 s82, s82, 896
  v_and_b32 v5, 3, v0
  v_lshlrev_b32 v5, 4, v5
  v_add3_u32 v14, v4, v5, s82
  s_mov_b32 s6, 1835008
  s_mov_b32 s7, 0x20000
  s_mov_b32 s10, 1204224
  s_mov_b32 s11, 0x20000
  s_mov_b32 s30, 25088
  s_mov_b32 s31, 0x20000
  s_mov_b32 s26, 401408
  s_mov_b32 s27, 0x20000
  s_mov_b32 s14, 1605632
  s_mov_b32 s15, 0x20000
  s_mov_b32 s18, 1605632
  s_mov_b32 s19, 0x20000
  s_mov_b32 s22, 1605632
  s_mov_b32 s23, 0x20000
  s_mov_b32 s34, 1835008
  s_mov_b32 s35, 0x20000
  s_mov_b32 s42, 256
  s_mov_b32 s43, 0x20000
  s_mov_b32 s38, 20971520
  s_mov_b32 s39, 0x20000
  s_waitcnt lgkmcnt(0)
  s_mov_b64 s[4:5], s[48:49]
  s_mov_b64 s[8:9], s[50:51]
  v_lshrrev_b32 v1, 4, v0
  v_and_b32 v2, 15, v0
  v_lshrrev_b32 v3, 5, v0
  v_and_b32 v4, 31, v0
  s_lshl_b32 s82, s75, 1
  s_add_u32 s82, s82, s74
  v_and_b32 v52, 1, v1
  v_lshlrev_b32 v5, 5, v52
  v_and_b32 v6, 3, v2
  v_lshl_add_u32 v5, v6, 3, v5
  v_cmp_eq_u32 vcc, v52, v2
  v_lshrrev_b32 v6, 2, v2
  v_lshl_add_u32 v6, v3, 3, v6
  v_mov_b32 v1, 0x3f803f80
  v_min_u32 v26, 48, v5
  v_lshl_add_u32 v26, v6, 6, v26
  s_lshl_b32 s83, s75, 12
  s_add_u32 s83, s83, s99
  v_add_u32 v26, s83, v26
  v_cndmask_b32 v52, 0, v1, vcc
  s_lshl_b32 s83, s74, 5
  v_add_u32 v4, s83, v4
  v_bfe_u32 v6, v4, 1, 3
  v_xor_b32 v6, v6, v3
  v_lshlrev_b32 v6, 4, v6
  v_lshl_add_u32 v6, v4, 7, v6
  s_add_u32 s83, s82, 0
  s_and_b32 s83, s83, 3
  s_lshl_b32 s84, s83, 5
  v_xor_b32 v20, s84, v6
  v_lshl_add_u32 v16, s83, 10, v26
  s_add_u32 s83, s82, 1
  s_and_b32 s83, s83, 3
  s_lshl_b32 s84, s83, 5
  v_xor_b32 v21, s84, v6
  v_lshl_add_u32 v17, s83, 10, v26
  s_add_u32 s83, s82, 2
  s_and_b32 s83, s83, 3
  s_lshl_b32 s84, s83, 5
  v_xor_b32 v22, s84, v6
  v_lshl_add_u32 v18, s83, 10, v26
  s_add_u32 s83, s82, 3
  s_and_b32 s83, s83, 3
  s_lshl_b32 s84, s83, 5
  v_xor_b32 v23, s84, v6
  v_lshl_add_u32 v19, s83, 10, v26
  v_mov_b32 v53, v52
  v_mov_b32 v54, v52
  v_mov_b32 v55, v52
  v_mov_b32 v1, 0
  v_mov_b32 v2, 0
  v_mov_b32 v3, 0
  v_mov_b32 v4, 0
  s_mov_b64 s[28:29], s[52:53]
  s_mov_b64 s[24:25], s[54:55]
  s_mov_b64 s[12:13], s[58:59]
  s_mov_b64 s[16:17], s[60:61]
  s_mov_b64 s[20:21], s[62:63]
  s_mov_b64 s[32:33], s[64:65]
  s_mov_b64 s[40:41], s[66:67]
  s_mov_b64 s[36:37], s[68:69]
  s_or_b32 s82, s2, s74
  s_cmp_lg_u32 s82, 0
  s_cbranch_scc1 L_nononce
  s_memrealtime s[84:85]
  s_waitcnt lgkmcnt(0)
  s_lshl_b32 s84, s84, 5
  s_or_b32 s84, s84, 16
  v_mov_b32 v5, s84
  v_lshlrev_b32 v6, 12, v0
  buffer_store_dword v5, v6, s[40:43], 0 offen sc1
L_nononce:
  v_bfe_u32 v65, v7, 4, 4
  v_bfe_u32 v66, v7, 9, 1
  v_bfe_u32 v67, v7, 4, 5
  v_bfe_u32 v68, v7, 8, 1
  v_lshlrev_b32 v68, 5, v68
  v_and_b32 v70, 3, v65
  v_lshl_add_u32 v68, v70, 3, v68
  s_lshl_b32 s83, s74, 5
  v_add_u32 v69, s83, v67
  s_bfe_u32 s44, s95, 0x40000
  s_mul_i32 s44, s44, 229376
  s_bfe_u32 s45, s95, 0x40004
  s_mul_i32 s45, s45, 229376
  s_bfe_u32 s46, s95, 0x40008
  s_mul_i32 s46, s46, 229376
  s_bfe_u32 s47, s95, 0x4000c
  s_mul_i32 s47, s47, 229376
  s_bfe_u32 s48, s95, 0x40010
  s_mul_i32 s48, s48, 229376
  s_bfe_u32 s49, s95, 0x40014
  s_mul_i32 s49, s49, 229376
  s_bfe_u32 s50, s95, 0x40018
  s_mul_i32 s50, s50, 229376
  v_lshrrev_b32 v70, 7, v7
  v_bfe_u32 v71, v7, 4, 3
  v_and_b32 v72, 2, v70
  v_lshlrev_b32 v72, 1, v72
  v_xor_b32 v71, v71, v72
  s_lshl_b32 s82, s74, 4
  v_add_u32 v70, s82, v70
  v_mul_u32_u24 v72, 896, v70
  v_lshl_add_u32 v72, v71, 4, v72
  s_lshl_b32 s82, s77, 7
  s_mul_i32 s83, s96, 57344
  s_add_u32 s82, s82, s83
  v_add_u32 v12, s82, v72
  s_lshl_b32 s83, s83, 1
  s_sub_u32 s97, 57344, s83
  s_lshl_b32 s82, s71, 1
  s_add_u32 s82, s82, s96
  s_lshl_b32 s82, s82, 7
  v_mul_u32_u24 v72, 3584, v70
  v_lshl_add_u32 v72, v71, 4, v72
  v_add_u32 v13, s82, v72
  v_add_u32 v0, 27648, v13
  v_bfe_u32 v70, v7, 4, 3
  v_cmp_ne_u32 vcc, 7, v70
  v_mov_b32 v71, 1.0
  v_bfe_u32 v70, v7, 8, 2
  v_cndmask_b32 v76, 0, v71, vcc
  s_lshl_b32 s82, s70, 1
  v_add_u32 v70, s82, v70
  v_cmp_eq_u32 vcc, 29, v70
  v_lshrrev_b32 v75, 9, v7
  v_or_b32 v75, s74, v75
  v_cndmask_b32 v76, 0, v76, vcc
  v_lshl_add_u32 v75, v75, 28, v7
  v_mov_b32 v77, v76
  v_mov_b32 v78, v76
  v_mov_b32 v79, v76
  v_min_u32 v70, 56, v68
  v_add_u32 v70, 64, v70
  v_and_b32 v71, 8, v65
  v_lshlrev_b32 v71, 3, v71
  v_xor_b32 v70, v70, v71
  v_lshrrev_b32 v72, 2, v65
  v_lshl_add_u32 v64, v66, 3, v72
  v_lshl_add_u32 v70, v64, 7, v70
  s_add_u32 s83, s74, 2
  s_and_b32 s83, s83, 3
  v_lshl_add_u32 v28, s83, 11, v70
  s_add_u32 s83, s74, 3
  s_and_b32 s83, s83, 3
  v_lshl_add_u32 v29, s83, 11, v70
  s_add_u32 s83, s74, 4
  s_and_b32 s83, s83, 3
  v_lshl_add_u32 v30, s83, 11, v70
  s_add_u32 s83, s74, 5
  s_and_b32 s83, s83, 3
  v_lshl_add_u32 v31, s83, 11, v70
  s_lshl_b32 s84, s74, 2
  s_add_u32 s84, s84, 156672
  v_add_u32 v70, s84, v7
  v_mov_b32 v10, 161792
  v_cmp_gt_u32 vcc, 256, v7
  v_lshlrev_b32 v9, 4, v67
  v_add_u32 v9, 156672, v9
  v_cndmask_b32 v10, v10, v70, vcc
  v_cmp_eq_u32 vcc, 0, v66
  v_mov_b32 v70, 1.0
  v_mov_b32 v49, 0
  v_cndmask_b32 v32, 0, v70, vcc
  v_mov_b32 v47, 0
  s_mov_b32 s100, -1
  s_mov_b32 s101, 0
  s_lshl_b32 s83, s70, 2
  s_add_u32 s83, s83, s74
  s_mul_i32 s83, s83, 144
  s_lshl_b32 s84, s71, 3
  s_add_u32 s83, s83, s84
  s_add_u32 s83, s83, 2
  s_lshl_b32 s83, s83, 10
  s_add_u32 s83, s83, 3145728
  v_add_u32 v11, s83, v7
  v_bfe_u32 v70, v67, 2, 1
  v_bfe_u32 v71, v67, 3, 1
  v_lshl_or_b32 v70, v71, 1, v70
  v_lshlrev_b32 v70, 4, v70
  v_lshl_add_u32 v70, v69, 6, v70
  v_lshl_add_u32 v70, v66, 3, v70
  v_add_u32 v8, 147456, v70
  s_and_b32 s82, s76, 3
  s_lshl_b32 s82, s82, 1
  s_add_u32 s82, s82, s77
  s_mul_i32 s85, s82, 37
  s_lshr_b32 s85, s85, 8
  s_mul_i32 s85, s85, 7
  s_sub_u32 s82, s82, s85
  s_mov_b32 s84, 0x06543210
  s_mov_b32 s85, 0x00654321
  s_lshl_b32 s82, s82, 2
  s_lshr_b64 s[84:85], s[84:85], s82
  s_mov_b32 s99, s84
  s_add_u32 s82, s76, s77
  s_and_b32 s82, s82, 3
  s_lshl_b32 s82, s82, 2
  s_lshr_b32 s98, 0x02103210, s82
  s_bfe_u32 s51, s99, 0x40000
  s_mul_i32 s51, s51, 229376
  s_bfe_u32 s52, s99, 0x40004
  s_mul_i32 s52, s52, 229376
  s_bfe_u32 s53, s99, 0x40008
  s_mul_i32 s53, s53, 229376
  s_bfe_u32 s54, s99, 0x4000c
  s_mul_i32 s54, s54, 229376
  s_bfe_u32 s55, s99, 0x40010
  s_mul_i32 s55, s55, 229376
  s_bfe_u32 s56, s99, 0x40014
  s_mul_i32 s56, s56, 229376
  s_bfe_u32 s57, s99, 0x40018
  s_mul_i32 s57, s57, 229376
  v_bfe_u32 v73, v7, 8, 2
  v_bfe_u32 v71, v7, 6, 2
  v_lshl_add_u32 v73, v73, 3, v71
  v_bfe_u32 v71, v7, 5, 1
  v_bfe_u32 v72, v7, 4, 1
  v_lshlrev_b32 v72, 3, v72
  v_bfe_u32 v70, v73, 3, 1
  v_and_b32 v38, 2, v73
  v_lshl_or_b32 v38, v70, 2, v38
  v_lshl_or_b32 v39, s74, 1, v71
  v_xor_b32 v38, v38, v39
  v_lshl_add_u32 v38, v38, 4, v72
  v_lshl_add_u32 v38, v73, 7, v38
  v_add_u32 v38, 131072, v38
  v_xor_b32 v39, 16, v38
  v_lshlrev_b32 v40, 1, v70
  v_xor_b32 v40, v40, v71
  v_lshl_add_u32 v40, v40, 4, v72
  v_lshl_add_u32 v40, v73, 6, v40
  v_add_u32 v40, 147456, v40
  v_xor_b32 v41, 16, v40
  v_xor_b32 v42, 32, v40
  v_xor_b32 v43, 48, v40
  s_setprio 1
  s_barrier
  ds_read_b128 v[144:147], v20 offset:0
  ds_read_b64_tr_b16 v[96:97], v16 offset:16384
  ds_read_b64_tr_b16 v[98:99], v16 offset:16640
  ds_read_b128 v[148:151], v21 offset:0
  ds_read_b64_tr_b16 v[100:101], v17 offset:16384
  ds_read_b64_tr_b16 v[102:103], v17 offset:16640
  ds_read_b128 v[152:155], v22 offset:0
  ds_read_b64_tr_b16 v[104:105], v18 offset:16384
  ds_read_b64_tr_b16 v[106:107], v18 offset:16640
  ds_read_b128 v[156:159], v23 offset:0
  ds_read_b64_tr_b16 v[108:109], v19 offset:16384
  ds_read_b64_tr_b16 v[110:111], v19 offset:16640
  s_bfe_u32 s86, s95, 0x40008
  s_add_u32 m0, s94, 49152
  s_lshl_b32 s86, s86, 7
  buffer_load_dwordx4 v15, s[4:7], s86 offen lds
  buffer_load_dwordx4 v24, s[4:7], s86 offen offset:1024 lds
  s_add_u32 m0, s94, 57344
  s_add_u32 s86, s86, 57344
  buffer_load_dwordx4 v15, s[4:7], s86 offen lds
  buffer_load_dwordx4 v24, s[4:7], s86 offen offset:1024 lds
  s_bfe_u32 s86, s95, 0x40008
  s_add_u32 m0, s3, 65536
  s_mul_i32 s86, s86, 172032
  buffer_load_dwordx4 v14, s[8:11], s86 offen lds
  s_add_u32 m0, s3, 68736
  s_nop 0
  buffer_load_dwordx4 v14, s[8:11], s86 offen offset:896 lds
  s_waitcnt lgkmcnt(0)
  s_barrier
  v_dot2c_f32_bf16 v1, 0x3f803f80, v144
  v_dot2c_f32_bf16 v3, v144, v144
  v_dot2c_f32_bf16 v2, 0x3f803f80, v145
  v_dot2c_f32_bf16 v4, v145, v145
  v_dot2c_f32_bf16 v1, 0x3f803f80, v146
  v_dot2c_f32_bf16 v3, v146, v146
  v_dot2c_f32_bf16 v2, 0x3f803f80, v147
  v_dot2c_f32_bf16 v4, v147, v147
  v_dot2c_f32_bf16 v1, 0x3f803f80, v148
  v_dot2c_f32_bf16 v3, v148, v148
  v_dot2c_f32_bf16 v2, 0x3f803f80, v149
  v_dot2c_f32_bf16 v4, v149, v149
  v_dot2c_f32_bf16 v1, 0x3f803f80, v150
  v_dot2c_f32_bf16 v3, v150, v150
  v_dot2c_f32_bf16 v2, 0x3f803f80, v151
  v_dot2c_f32_bf16 v4, v151, v151
  v_mfma_f32_16x16x32_bf16 v[56:59], v[52:55], v[96:99], 0
  v_mfma_f32_32x32x16_bf16 v[112:127], v[96:99], v[144:147], 0
  ds_read_b128 v[160:163], v20 offset:24576
  ds_read_b64_tr_b16 v[80:81], v16 offset:40960
  ds_read_b64_tr_b16 v[82:83], v16 offset:41216
  s_bfe_u32 s86, s95, 0x4000c
  s_add_u32 m0, s94, 0
  s_lshl_b32 s86, s86, 7
  buffer_load_dwordx4 v15, s[4:7], s86 offen lds
  buffer_load_dwordx4 v24, s[4:7], s86 offen offset:1024 lds
  v_mfma_f32_32x32x16_bf16 v[112:127], v[100:103], v[148:151], v[112:127]
  ds_read_b128 v[164:167], v21 offset:24576
  ds_read_b64_tr_b16 v[84:85], v17 offset:40960
  ds_read_b64_tr_b16 v[86:87], v17 offset:41216
  s_add_u32 m0, s94, 8192
  s_add_u32 s86, s86, 57344
  buffer_load_dwordx4 v15, s[4:7], s86 offen lds
  buffer_load_dwordx4 v24, s[4:7], s86 offen offset:1024 lds
  v_mfma_f32_32x32x16_bf16 v[112:127], v[104:107], v[152:155], v[112:127]
  ds_read_b128 v[168:171], v22 offset:24576
  ds_read_b64_tr_b16 v[88:89], v18 offset:40960
  ds_read_b64_tr_b16 v[90:91], v18 offset:41216
  s_bfe_u32 s86, s95, 0x4000c
  s_add_u32 m0, s3, 16384
  s_mul_i32 s86, s86, 172032
  buffer_load_dwordx4 v14, s[8:11], s86 offen lds
  s_add_u32 m0, s3, 19584
  s_nop 0
  buffer_load_dwordx4 v14, s[8:11], s86 offen offset:896 lds
  v_mfma_f32_32x32x16_bf16 v[112:127], v[108:111], v[156:159], v[112:127]
  ds_read_b128 v[172:175], v23 offset:24576
  ds_read_b64_tr_b16 v[92:93], v19 offset:40960
  ds_read_b64_tr_b16 v[94:95], v19 offset:41216
  s_waitcnt vmcnt(6) lgkmcnt(0)
  s_barrier
  v_dot2c_f32_bf16 v1, 0x3f803f80, v160
  v_dot2c_f32_bf16 v3, v160, v160
  v_dot2c_f32_bf16 v2, 0x3f803f80, v161
  v_dot2c_f32_bf16 v4, v161, v161
  v_dot2c_f32_bf16 v1, 0x3f803f80, v162
  v_dot2c_f32_bf16 v3, v162, v162
  v_dot2c_f32_bf16 v2, 0x3f803f80, v163
  v_dot2c_f32_bf16 v4, v163, v163
  v_dot2c_f32_bf16 v1, 0x3f803f80, v164
  v_dot2c_f32_bf16 v3, v164, v164
  v_dot2c_f32_bf16 v2, 0x3f803f80, v165
  v_dot2c_f32_bf16 v4, v165, v165
  v_dot2c_f32_bf16 v1, 0x3f803f80, v166
  v_dot2c_f32_bf16 v3, v166, v166
  v_dot2c_f32_bf16 v2, 0x3f803f80, v167
  v_dot2c_f32_bf16 v4, v167, v167
  v_mfma_f32_16x16x32_bf16 v[56:59], v[52:55], v[80:83], v[56:59]
  v_mfma_f32_32x32x16_bf16 v[112:127], v[80:83], v[160:163], v[112:127]
  v_add_u32 v16, 0x10000, v16
  v_add_u32 v17, 0x10000, v17
  v_add_u32 v18, 0x10000, v18
  v_add_u32 v19, 0x10000, v19
  ds_read_b128 v[176:179], v20 offset:49152
  ds_read_b64_tr_b16 v[96:97], v16 offset:0
  ds_read_b64_tr_b16 v[98:99], v16 offset:256
  v_mfma_f32_32x32x16_bf16 v[112:127], v[84:87], v[164:167], v[112:127]
  ds_read_b128 v[180:183], v21 offset:49152
  ds_read_b64_tr_b16 v[100:101], v17 offset:0
  ds_read_b64_tr_b16 v[102:103], v17 offset:256
  v_mfma_f32_32x32x16_bf16 v[112:127], v[88:91], v[168:171], v[112:127]
  ds_read_b128 v[184:187], v22 offset:49152
  ds_read_b64_tr_b16 v[104:105], v18 offset:0
  ds_read_b64_tr_b16 v[106:107], v18 offset:256
  v_mfma_f32_32x32x16_bf16 v[112:127], v[92:95], v[172:175], v[112:127]
  ds_read_b128 v[188:191], v23 offset:49152
  ds_read_b64_tr_b16 v[108:109], v19 offset:0
  ds_read_b64_tr_b16 v[110:111], v19 offset:256
  s_mul_i32 s82, s72, 1568
  s_lshl_b32 s83, s73, 8
  s_add_u32 s82, s82, s83
  s_add_u32 m0, s83, 159744
  v_lshrrev_b32 v74, 2, v7
  buffer_load_dword v74, s[28:31], s82 offen lds
  s_lshl_b32 s82, s72, 4
  s_add_u32 s82, s82, s70
  s_lshl_b32 s82, s82, 9
  s_add_u32 s82, s82, 65536
  buffer_store_dwordx4 v[76:79], v75, s[36:39], s82 offen sc1
  s_waitcnt vmcnt(2) lgkmcnt(0)
  s_barrier
  v_dot2c_f32_bf16 v1, 0x3f803f80, v176
  v_dot2c_f32_bf16 v3, v176, v176
  v_dot2c_f32_bf16 v2, 0x3f803f80, v177
  v_dot2c_f32_bf16 v4, v177, v177
  v_dot2c_f32_bf16 v1, 0x3f803f80, v178
  v_dot2c_f32_bf16 v3, v178, v178
  v_dot2c_f32_bf16 v2, 0x3f803f80, v179
  v_dot2c_f32_bf16 v4, v179, v179
  v_dot2c_f32_bf16 v1, 0x3f803f80, v180
  v_dot2c_f32_bf16 v3, v180, v180
  v_dot2c_f32_bf16 v2, 0x3f803f80, v181
  v_dot2c_f32_bf16 v4, v181, v181
  v_dot2c_f32_bf16 v1, 0x3f803f80, v182
  v_dot2c_f32_bf16 v3, v182, v182
  v_dot2c_f32_bf16 v2, 0x3f803f80, v183
  v_dot2c_f32_bf16 v4, v183, v183
  v_mfma_f32_16x16x32_bf16 v[56:59], v[52:55], v[96:99], v[56:59]
  v_mfma_f32_32x32x16_bf16 v[112:127], v[96:99], v[176:179], v[112:127]
  v_add_u32 v16, 0xffff4000, v16
  v_add_u32 v17, 0xffff4000, v17
  v_add_u32 v18, 0xffff4000, v18
  v_add_u32 v19, 0xffff4000, v19
  ds_read_b128 v[192:195], v20 offset:0
  ds_read_b64_tr_b16 v[80:81], v16 offset:0
  ds_read_b64_tr_b16 v[82:83], v16 offset:256
  s_bfe_u32 s86, s95, 0x40014
  s_add_u32 m0, s94, 49152
  s_lshl_b32 s86, s86, 7
  buffer_load_dwordx4 v15, s[4:7], s86 offen lds
  buffer_load_dwordx4 v24, s[4:7], s86 offen offset:1024 lds
  v_mfma_f32_32x32x16_bf16 v[112:127], v[100:103], v[180:183], v[112:127]
  ds_read_b128 v[196:199], v21 offset:0
  ds_read_b64_tr_b16 v[84:85], v17 offset:0
  ds_read_b64_tr_b16 v[86:87], v17 offset:256
  s_add_u32 m0, s94, 57344
  s_add_u32 s86, s86, 57344
  buffer_load_dwordx4 v15, s[4:7], s86 offen lds
  buffer_load_dwordx4 v24, s[4:7], s86 offen offset:1024 lds
  v_mfma_f32_32x32x16_bf16 v[112:127], v[104:107], v[184:187], v[112:127]
  ds_read_b128 v[200:203], v22 offset:0
  ds_read_b64_tr_b16 v[88:89], v18 offset:0
  ds_read_b64_tr_b16 v[90:91], v18 offset:256
  s_bfe_u32 s86, s95, 0x40014
  s_add_u32 m0, s3, 65536
  s_mul_i32 s86, s86, 172032
  buffer_load_dwordx4 v14, s[8:11], s86 offen lds
  s_add_u32 m0, s3, 68736
  s_nop 0
  buffer_load_dwordx4 v14, s[8:11], s86 offen offset:896 lds
  v_mfma_f32_32x32x16_bf16 v[112:127], v[108:111], v[188:191], v[112:127]
  ds_read_b128 v[204:207], v23 offset:0
  ds_read_b64_tr_b16 v[92:93], v19 offset:0
  ds_read_b64_tr_b16 v[94:95], v19 offset:256
  s_waitcnt lgkmcnt(0)
  s_barrier
  v_dot2c_f32_bf16 v1, 0x3f803f80, v192
  v_dot2c_f32_bf16 v3, v192, v192
  v_dot2c_f32_bf16 v2, 0x3f803f80, v193
  v_dot2c_f32_bf16 v4, v193, v193
  v_dot2c_f32_bf16 v1, 0x3f803f80, v194
  v_dot2c_f32_bf16 v3, v194, v194
  v_dot2c_f32_bf16 v2, 0x3f803f80, v195
  v_dot2c_f32_bf16 v4, v195, v195
  v_dot2c_f32_bf16 v1, 0x3f803f80, v196
  v_dot2c_f32_bf16 v3, v196, v196
  v_dot2c_f32_bf16 v2, 0x3f803f80, v197
  v_dot2c_f32_bf16 v4, v197, v197
  v_dot2c_f32_bf16 v1, 0x3f803f80, v198
  v_dot2c_f32_bf16 v3, v198, v198
  v_dot2c_f32_bf16 v2, 0x3f803f80, v199
  v_dot2c_f32_bf16 v4, v199, v199
  v_mfma_f32_16x16x32_bf16 v[56:59], v[52:55], v[80:83], v[56:59]
  v_mfma_f32_32x32x16_bf16 v[112:127], v[80:83], v[192:195], v[112:127]
  ds_read_b128 v[208:211], v20 offset:24576
  ds_read_b64_tr_b16 v[96:97], v16 offset:24576
  ds_read_b64_tr_b16 v[98:99], v16 offset:24832
  v_mfma_f32_32x32x16_bf16 v[112:127], v[84:87], v[196:199], v[112:127]
  ds_read_b128 v[212:215], v21 offset:24576
  ds_read_b64_tr_b16 v[100:101], v17 offset:24576
  ds_read_b64_tr_b16 v[102:103], v17 offset:24832
  v_mfma_f32_32x32x16_bf16 v[112:127], v[88:91], v[200:203], v[112:127]
  ds_read_b128 v[216:219], v22 offset:24576
  ds_read_b64_tr_b16 v[104:105], v18 offset:24576
  ds_read_b64_tr_b16 v[106:107], v18 offset:24832
  v_mfma_f32_32x32x16_bf16 v[112:127], v[92:95], v[204:207], v[112:127]
  ds_read_b128 v[220:223], v23 offset:24576
  ds_read_b64_tr_b16 v[108:109], v19 offset:24576
  ds_read_b64_tr_b16 v[110:111], v19 offset:24832
  v_mov_b32 v5, 0
  buffer_load_dword v6, v5, s[40:43], 0 offen sc1
  s_waitcnt vmcnt(1) lgkmcnt(0)
  s_barrier
  v_dot2c_f32_bf16 v1, 0x3f803f80, v208
  v_dot2c_f32_bf16 v3, v208, v208
  v_dot2c_f32_bf16 v2, 0x3f803f80, v209
  v_dot2c_f32_bf16 v4, v209, v209
  v_dot2c_f32_bf16 v1, 0x3f803f80, v210
  v_dot2c_f32_bf16 v3, v210, v210
  v_dot2c_f32_bf16 v2, 0x3f803f80, v211
  v_dot2c_f32_bf16 v4, v211, v211
  v_dot2c_f32_bf16 v1, 0x3f803f80, v212
  v_dot2c_f32_bf16 v3, v212, v212
  v_dot2c_f32_bf16 v2, 0x3f803f80, v213
  v_dot2c_f32_bf16 v4, v213, v213
  v_dot2c_f32_bf16 v1, 0x3f803f80, v214
  v_dot2c_f32_bf16 v3, v214, v214
  v_dot2c_f32_bf16 v2, 0x3f803f80, v215
  v_dot2c_f32_bf16 v4, v215, v215
  v_mfma_f32_16x16x32_bf16 v[56:59], v[52:55], v[96:99], v[56:59]
  v_mfma_f32_32x32x16_bf16 v[112:127], v[96:99], v[208:211], v[112:127]
  ds_read_b128 v[224:227], v20 offset:49152
  ds_read_b64_tr_b16 v[80:81], v16 offset:49152
  ds_read_b64_tr_b16 v[82:83], v16 offset:49408
  s_add_u32 m0, s94, 24576
  s_nop 0
  buffer_load_dwordx4 v13, s[12:15], s44 offen lds
  buffer_load_dwordx4 v0, s[12:15], s44 offen offset:1024 lds
  v_mfma_f32_32x32x16_bf16 v[112:127], v[100:103], v[212:215], v[112:127]
  ds_read_b128 v[228:231], v21 offset:49152
  ds_read_b64_tr_b16 v[84:85], v17 offset:49152
  ds_read_b64_tr_b16 v[86:87], v17 offset:49408
  s_add_u32 m0, s94, 32768
  s_nop 0
  buffer_load_dwordx4 v13, s[12:15], s45 offen lds
  buffer_load_dwordx4 v0, s[12:15], s45 offen offset:1024 lds
  v_mfma_f32_32x32x16_bf16 v[112:127], v[104:107], v[216:219], v[112:127]
  ds_read_b128 v[232:235], v22 offset:49152
  ds_read_b64_tr_b16 v[88:89], v18 offset:49152
  ds_read_b64_tr_b16 v[90:91], v18 offset:49408
  s_add_u32 m0, s94, 40960
  s_nop 0
  buffer_load_dwordx4 v13, s[12:15], s46 offen lds
  buffer_load_dwordx4 v0, s[12:15], s46 offen offset:1024 lds
  v_mfma_f32_32x32x16_bf16 v[112:127], v[108:111], v[220:223], v[112:127]
  ds_read_b128 v[236:239], v23 offset:49152
  ds_read_b64_tr_b16 v[92:93], v19 offset:49152
  ds_read_b64_tr_b16 v[94:95], v19 offset:49408
  s_waitcnt lgkmcnt(0)
  s_barrier
  v_dot2c_f32_bf16 v1, 0x3f803f80, v224
  v_dot2c_f32_bf16 v3, v224, v224
  v_dot2c_f32_bf16 v2, 0x3f803f80, v225
  v_dot2c_f32_bf16 v4, v225, v225
  v_dot2c_f32_bf16 v1, 0x3f803f80, v226
  v_dot2c_f32_bf16 v3, v226, v226
  v_dot2c_f32_bf16 v2, 0x3f803f80, v227
  v_dot2c_f32_bf16 v4, v227, v227
  v_dot2c_f32_bf16 v1, 0x3f803f80, v228
  v_dot2c_f32_bf16 v3, v228, v228
  v_dot2c_f32_bf16 v2, 0x3f803f80, v229
  v_dot2c_f32_bf16 v4, v229, v229
  v_dot2c_f32_bf16 v1, 0x3f803f80, v230
  v_dot2c_f32_bf16 v3, v230, v230
  v_dot2c_f32_bf16 v2, 0x3f803f80, v231
  v_dot2c_f32_bf16 v4, v231, v231
  v_mfma_f32_16x16x32_bf16 v[56:59], v[52:55], v[80:83], v[56:59]
  v_mfma_f32_32x32x16_bf16 v[112:127], v[80:83], v[224:227], v[112:127]
  ds_read_b128 v[240:243], v20 offset:0
  ds_read_b64_tr_b16 v[96:97], v16 offset:0
  ds_read_b64_tr_b16 v[98:99], v16 offset:256
  s_add_u32 m0, s94, 49152
  s_nop 0
  buffer_load_dwordx4 v13, s[12:15], s47 offen lds
  buffer_load_dwordx4 v0, s[12:15], s47 offen offset:1024 lds
  v_mfma_f32_32x32x16_bf16 v[112:127], v[84:87], v[228:231], v[112:127]
  ds_read_b128 v[244:247], v21 offset:0
  ds_read_b64_tr_b16 v[100:101], v17 offset:0
  ds_read_b64_tr_b16 v[102:103], v17 offset:256
  s_add_u32 m0, s94, 57344
  s_nop 0
  buffer_load_dwordx4 v13, s[12:15], s48 offen lds
  buffer_load_dwordx4 v0, s[12:15], s48 offen offset:1024 lds
  v_mfma_f32_32x32x16_bf16 v[112:127], v[88:91], v[232:235], v[112:127]
  ds_read_b128 v[248:251], v22 offset:0
  ds_read_b64_tr_b16 v[104:105], v18 offset:0
  ds_read_b64_tr_b16 v[106:107], v18 offset:256
  s_add_u32 m0, s94, 65536
  s_nop 0
  buffer_load_dwordx4 v13, s[12:15], s49 offen lds
  buffer_load_dwordx4 v0, s[12:15], s49 offen offset:1024 lds
  v_mfma_f32_32x32x16_bf16 v[112:127], v[92:95], v[236:239], v[112:127]
  ds_read_b128 v[252:255], v23 offset:0
  ds_read_b64_tr_b16 v[108:109], v19 offset:0
  ds_read_b64_tr_b16 v[110:111], v19 offset:256
  s_waitcnt vmcnt(8) lgkmcnt(0)
  s_barrier
  v_dot2c_f32_bf16 v1, 0x3f803f80, v240
  v_dot2c_f32_bf16 v3, v240, v240
  v_dot2c_f32_bf16 v2, 0x3f803f80, v241
  v_dot2c_f32_bf16 v4, v241, v241
  v_dot2c_f32_bf16 v1, 0x3f803f80, v242
  v_dot2c_f32_bf16 v3, v242, v242
  v_dot2c_f32_bf16 v2, 0x3f803f80, v243
  v_dot2c_f32_bf16 v4, v243, v243
  v_dot2c_f32_bf16 v1, 0x3f803f80, v244
  v_dot2c_f32_bf16 v3, v244, v244
  v_dot2c_f32_bf16 v2, 0x3f803f80, v245
  v_dot2c_f32_bf16 v4, v245, v245
  v_dot2c_f32_bf16 v1, 0x3f803f80, v246
  v_dot2c_f32_bf16 v3, v246, v246
  v_dot2c_f32_bf16 v2, 0x3f803f80, v247
  v_dot2c_f32_bf16 v4, v247, v247
  v_mfma_f32_16x16x32_bf16 v[56:59], v[52:55], v[96:99], v[56:59]
  v_mfma_f32_32x32x16_bf16 v[112:127], v[96:99], v[240:243], v[112:127]
  ds_read_b64_tr_b16 v[64:65], v28 offset:24576
  ds_read_b64_tr_b16 v[66:67], v28 offset:25088
  s_add_u32 m0, s94, 73728
  s_nop 0
  buffer_load_dwordx4 v13, s[12:15], s50 offen lds
  buffer_load_dwordx4 v0, s[12:15], s50 offen offset:1024 lds
  v_mfma_f32_32x32x16_bf16 v[112:127], v[100:103], v[244:247], v[112:127]
  ds_read_b64_tr_b16 v[68:69], v29 offset:24576
  ds_read_b64_tr_b16 v[70:71], v29 offset:25088
  v_add_f32 v2, v1, v2
  v_add_f32 v3, v3, v4
  v_bfe_u32 v16, v7, 4, 5
  v_mov_b32 v1, v2
  v_mov_b32 v4, v3
  s_lshl_b32 s82, s74, 8
  s_add_u32 s82, s82, 157696
  v_lshl_add_u32 v15, v16, 3, s82
  s_add_u32 m0, s94, 81920
  s_nop 0
  buffer_load_dwordx4 v13, s[16:19], s44 offen lds
  buffer_load_dwordx4 v0, s[16:19], s44 offen offset:1024 lds
  v_mfma_f32_32x32x16_bf16 v[112:127], v[104:107], v[248:251], v[112:127]
  ds_read_b64_tr_b16 v[72:73], v30 offset:24576
  ds_read_b64_tr_b16 v[74:75], v30 offset:25088
  v_permlane32_swap_b32 v2, v1
  v_permlane32_swap_b32 v3, v4
  ds_write2_b32 v10, v56, v57 offset0:128 offset1:192
  v_add_f32 v2, v2, v1
  v_add_f32 v3, v3, v4
  ds_write_b64 v15, v[2:3] offset:1024
  s_add_u32 m0, s94, 90112
  s_nop 0
  buffer_load_dwordx4 v13, s[16:19], s45 offen lds
  buffer_load_dwordx4 v0, s[16:19], s45 offen offset:1024 lds
  v_mfma_f32_32x32x16_bf16 v[112:127], v[108:111], v[252:255], v[112:127]
  s_waitcnt lgkmcnt(4)
  v_mfma_f32_16x16x32_bf16 v[56:59], v[52:55], v[64:67], 0
  v_mfma_f32_32x32x16_bf16 v[80:95], v[64:67], v[144:147], 0
  ds_read_b64_tr_b16 v[76:77], v31 offset:24576
  ds_read_b64_tr_b16 v[78:79], v31 offset:25088
  v_mfma_f32_32x32x16_bf16 v[80:95], v[68:71], v[148:151], v[80:95]
  ds_read_b64_tr_b16 v[64:65], v28 offset:32768
  ds_read_b64_tr_b16 v[66:67], v28 offset:33280
  s_waitcnt lgkmcnt(4)
  s_barrier
  v_cmp_eq_u32 vcc, 0, v6
  s_mov_b32 s87, 262144
  s_nop 1
  s_cbranch_vccz L_nonce_6_x
L_nonce_6:
  buffer_load_dword v6, v5, s[40:43], 0 offen sc1
  s_sub_u32 s87, s87, 1
  s_cbranch_scc1 L_nonce_6_y
  s_waitcnt vmcnt(0)
  v_cmp_eq_u32 vcc, 0, v6
  s_nop 4
  s_cbranch_vccnz L_nonce_6
L_nonce_6_y:
  s_waitcnt vmcnt(0)
  s_nop 4
L_nonce_6_x:
  v_readfirstlane_b32 s80, v6
  s_cmp_lg_u32 s74, 0
  s_cbranch_scc1 L_flag_7
  s_lshl_b32 s83, s72, 6
  s_lshl_b32 s82, s70, 2
  s_add_u32 s83, s83, s82
  s_add_u32 s83, s83, 4096
  v_mov_b32 v5, s80
  v_lshlrev_b32 v6, 24, v7
  buffer_store_dword v5, v6, s[36:39], s83 offen sc1
L_flag_7:
  s_setprio 0
  ds_read_b64 v[16:17], v15 offset:0
  ds_read_b128 v[60:63], v9 offset:512
  s_waitcnt lgkmcnt(4)
  v_mfma_f32_32x32x16_bf16 v[80:95], v[72:75], v[152:155], v[80:95]
  ds_read_b64_tr_b16 v[68:69], v29 offset:32768
  ds_read_b64_tr_b16 v[70:71], v29 offset:33280
  v_mfma_f32_32x32x16_bf16 v[80:95], v[76:79], v[156:159], v[80:95]
  ds_read_b64_tr_b16 v[72:73], v30 offset:32768
  ds_read_b64_tr_b16 v[74:75], v30 offset:33280
  s_waitcnt lgkmcnt(2)
  v_mfma_f32_16x16x32_bf16 v[56:59], v[52:55], v[64:67], v[56:59]
  v_mfma_f32_32x32x16_bf16 v[80:95], v[64:67], v[160:163], v[80:95]
  ds_read_b64_tr_b16 v[76:77], v31 offset:32768
  ds_read_b64_tr_b16 v[78:79], v31 offset:33280
  v_add_f32 v2, v2, v16
  v_add_f32 v3, v3, v17
  v_mul_f32 v2, 0x3b124925, v2
  v_mul_f32 v3, 0x3b124925, v3
  v_mul_f32_e64 v16, -v2, v32
  v_fma_f32 v3, -v2, v2, v3
  v_cvt_pk_bf16_f32 v46, v16, v16
  s_waitcnt vmcnt(4)
  s_barrier
  v_mfma_f32_32x32x16_bf16 v[80:95], v[68:71], v[164:167], v[80:95]
  ds_read_b64_tr_b16 v[64:65], v28 offset:40960
  ds_read_b64_tr_b16 v[66:67], v28 offset:41472
  s_add_u32 m0, s94, 98304
  s_nop 0
  buffer_load_dwordx4 v13, s[16:19], s46 offen lds
  v_max_f32 v3, 0, v3
  v_add_f32 v60, v60, v61
  v_add_f32 v62, v62, v63
  s_waitcnt lgkmcnt(2)
  v_mfma_f32_32x32x16_bf16 v[80:95], v[72:75], v[168:171], v[80:95]
  ds_read_b64_tr_b16 v[68:69], v29 offset:40960
  ds_read_b64_tr_b16 v[70:71], v29 offset:41472
  buffer_load_dwordx4 v0, s[16:19], s46 offen offset:1024 lds
  v_add_f32 v60, v60, v62
  v_cvt_pk_bf16_f32 v61, v60, v60
  v_lshlrev_b32 v61, 16, v61
  v_mfma_f32_32x32x16_bf16 v[80:95], v[76:79], v[172:175], v[80:95]
  ds_read_b64_tr_b16 v[72:73], v30 offset:40960
  ds_read_b64_tr_b16 v[74:75], v30 offset:41472
  s_add_u32 m0, s94, 106496
  s_nop 0
  buffer_load_dwordx4 v13, s[16:19], s47 offen lds
  v_sub_f32 v62, v60, v61
  v_cvt_pk_bf16_f32 v48, v61, v62
  v_cvt_pk_bf16_f32 v3, v3, v3
  s_waitcnt lgkmcnt(2)
  v_mfma_f32_16x16x32_bf16 v[56:59], v[52:55], v[64:67], v[56:59]
  v_mfma_f32_32x32x16_bf16 v[80:95], v[64:67], v[176:179], v[80:95]
  ds_read_b64_tr_b16 v[76:77], v31 offset:40960
  ds_read_b64_tr_b16 v[78:79], v31 offset:41472
  buffer_load_dwordx4 v0, s[16:19], s47 offen offset:1024 lds
  v_lshlrev_b32 v3, 16, v3
  v_mfma_f32_32x32x8_bf16 v[112:127], v[48:49], v[46:47], v[112:127]
  v_mfma_f32_32x32x16_bf16 v[80:95], v[68:71], v[180:183], v[80:95]
  ds_read_b64_tr_b16 v[64:65], v28 offset:49152
  ds_read_b64_tr_b16 v[66:67], v28 offset:49664
  s_add_u32 m0, s94, 114688
  s_nop 0
  buffer_load_dwordx4 v13, s[16:19], s48 offen lds
  v_add_f32 v3, 0x3727c5ac, v3
  v_cvt_pk_bf16_f32 v3, v3, v3
  v_lshlrev_b32 v3, 16, v3
  s_waitcnt lgkmcnt(2)
  v_mfma_f32_32x32x16_bf16 v[80:95], v[72:75], v[184:187], v[80:95]
  ds_read_b64_tr_b16 v[68:69], v29 offset:49152
  ds_read_b64_tr_b16 v[70:71], v29 offset:49664
  buffer_load_dwordx4 v0, s[16:19], s48 offen offset:1024 lds
  v_sqrt_f32 v3, v3
  s_nop 0
  v_cvt_pk_bf16_f32 v3, v3, v3
  v_mfma_f32_32x32x16_bf16 v[80:95], v[76:79], v[188:191], v[80:95]
  ds_read_b64_tr_b16 v[72:73], v30 offset:49152
  ds_read_b64_tr_b16 v[74:75], v30 offset:49664
  s_add_u32 m0, s94, 122880
  s_nop 0
  buffer_load_dwordx4 v13, s[16:19], s49 offen lds
  v_lshlrev_b32 v3, 16, v3
  v_rcp_f32 v34, v3
  s_waitcnt lgkmcnt(2)
  v_mfma_f32_16x16x32_bf16 v[56:59], v[52:55], v[64:67], v[56:59]
  v_mfma_f32_32x32x16_bf16 v[80:95], v[64:67], v[192:195], v[80:95]
  ds_read_b64_tr_b16 v[76:77], v31 offset:49152
  ds_read_b64_tr_b16 v[78:79], v31 offset:49664
  buffer_load_dwordx4 v0, s[16:19], s49 offen offset:1024 lds
  v_mul_f32 v35, v3, v3
  v_mul_f32 v33, 0x3fb8aa3b, v34
  v_mul_f32 v36, 0xc0135761, v34
  v_mfma_f32_32x32x16_bf16 v[80:95], v[68:71], v[196:199], v[80:95]
  ds_read_b64_tr_b16 v[64:65], v28 offset:57344
  ds_read_b64_tr_b16 v[66:67], v28 offset:57856
  s_add_u32 m0, s94, 0
  s_nop 0
  buffer_load_dwordx4 v13, s[16:19], s50 offen lds
  v_mul_f32 v2, v34, v34
  v_mul_f32 v2, v2, v36
  v_mul_f32 v37, 0x3d372713, v2
  s_waitcnt lgkmcnt(2)
  v_mfma_f32_32x32x16_bf16 v[80:95], v[72:75], v[200:203], v[80:95]
  ds_read_b64_tr_b16 v[68:69], v29 offset:57344
  ds_read_b64_tr_b16 v[70:71], v29 offset:57856
  buffer_load_dwordx4 v0, s[16:19], s50 offen offset:1024 lds
  v_mul_f32 v1, v34, v32
  v_sub_f32 v2, 1.0, v32
  v_mul_f32 v112, v112, v34
  v_mfma_f32_32x32x16_bf16 v[80:95], v[76:79], v[204:207], v[80:95]
  ds_read_b64_tr_b16 v[72:73], v30 offset:57344
  ds_read_b64_tr_b16 v[74:75], v30 offset:57856
  s_add_u32 m0, s94, 8192
  v_xor_b32 v13, 128, v13
  v_xor_b32 v0, 128, v0
  buffer_load_dwordx4 v13, s[12:15], s44 offen lds
  v_mul_f32 v113, v113, v34
  v_mul_f32 v114, v114, v34
  v_mul_f32 v115, v115, v34
  s_waitcnt lgkmcnt(2)
  v_mfma_f32_16x16x32_bf16 v[56:59], v[52:55], v[64:67], v[56:59]
  v_mfma_f32_32x32x16_bf16 v[80:95], v[64:67], v[208:211], v[80:95]
  ds_read_b64_tr_b16 v[76:77], v31 offset:57344
  ds_read_b64_tr_b16 v[78:79], v31 offset:57856
  buffer_load_dwordx4 v0, s[12:15], s44 offen offset:1024 lds
  v_cvt_pk_bf16_f32 v112, v112, v113
  v_cvt_pk_bf16_f32 v113, v114, v115
  ds_write_b64 v8, v[112:113]
  v_mfma_f32_32x32x16_bf16 v[80:95], v[68:71], v[212:215], v[80:95]
  v_add_u32 v28, 0x10000, v28
  v_add_u32 v29, 0x10000, v29
  v_add_u32 v30, 0x10000, v30
  v_add_u32 v31, 0x10000, v31
  ds_read_b64_tr_b16 v[64:65], v28 offset:0
  ds_read_b64_tr_b16 v[66:67], v28 offset:512
  s_add_u32 m0, s94, 16384
  s_nop 0
  buffer_load_dwordx4 v13, s[12:15], s45 offen lds
  v_mul_f32 v116, v116, v34
  v_mul_f32 v117, v117, v34
  v_mul_f32 v118, v118, v34
  s_waitcnt lgkmcnt(3)
  v_mfma_f32_32x32x16_bf16 v[80:95], v[72:75], v[216:219], v[80:95]
  ds_read_b64_tr_b16 v[68:69], v29 offset:0
  ds_read_b64_tr_b16 v[70:71], v29 offset:512
  buffer_load_dwordx4 v0, s[12:15], s45 offen offset:1024 lds
  v_mul_f32 v119, v119, v34
  v_xor_b32 v21, 16, v8
  v_cvt_pk_bf16_f32 v116, v116, v117
  v_mfma_f32_32x32x16_bf16 v[80:95], v[76:79], v[220:223], v[80:95]
  ds_read_b64_tr_b16 v[72:73], v30 offset:0
  ds_read_b64_tr_b16 v[74:75], v30 offset:512
  v_cvt_pk_bf16_f32 v117, v118, v119
  ds_write_b64 v21, v[116:117]
  v_mul_f32 v120, v120, v34
  s_waitcnt lgkmcnt(3)
  v_mfma_f32_16x16x32_bf16 v[56:59], v[52:55], v[64:67], v[56:59]
  v_mfma_f32_32x32x16_bf16 v[80:95], v[64:67], v[224:227], v[80:95]
  ds_read_b64_tr_b16 v[76:77], v31 offset:0
  ds_read_b64_tr_b16 v[78:79], v31 offset:512
  s_add_u32 m0, s94, 24576
  s_nop 0
  buffer_load_dwordx4 v13, s[12:15], s46 offen lds
  v_mul_f32 v121, v121, v34
  v_mul_f32 v122, v122, v34
  v_mul_f32 v123, v123, v34
  v_mfma_f32_32x32x16_bf16 v[80:95], v[68:71], v[228:231], v[80:95]
  ds_read_b64_tr_b16 v[64:65], v28 offset:8192
  ds_read_b64_tr_b16 v[66:67], v28 offset:8704
  v_xor_b32 v22, 32, v8
  v_cvt_pk_bf16_f32 v120, v120, v121
  v_cvt_pk_bf16_f32 v121, v122, v123
  s_waitcnt lgkmcnt(2)
  v_mfma_f32_32x32x16_bf16 v[80:95], v[72:75], v[232:235], v[80:95]
  ds_read_b64_tr_b16 v[68:69], v29 offset:8192
  ds_read_b64_tr_b16 v[70:71], v29 offset:8704
  buffer_load_dwordx4 v0, s[12:15], s46 offen offset:1024 lds
  ds_write_b64 v22, v[120:121]
  v_fma_f32 v124, v124, v1, v2
  v_mul_f32 v125, v125, v1
  v_mfma_f32_32x32x16_bf16 v[80:95], v[76:79], v[236:239], v[80:95]
  ds_read_b64_tr_b16 v[72:73], v30 offset:8192
  ds_read_b64_tr_b16 v[74:75], v30 offset:8704
  v_mul_f32 v126, v126, v1
  v_mul_f32 v127, v127, v1
  v_xor_b32 v23, 48, v8
  s_waitcnt lgkmcnt(3)
  v_mfma_f32_16x16x32_bf16 v[56:59], v[52:55], v[64:67], v[56:59]
  v_mfma_f32_32x32x16_bf16 v[80:95], v[64:67], v[240:243], v[80:95]
  ds_read_b64_tr_b16 v[76:77], v31 offset:8192
  ds_read_b64_tr_b16 v[78:79], v31 offset:8704
  v_cvt_pk_bf16_f32 v124, v124, v125
  v_cvt_pk_bf16_f32 v125, v126, v127
  ds_write_b64 v23, v[124:125]
  s_nop 1
  ds_write2_b32 v10, v56, v57 offset0:0 offset1:64
  s_waitcnt vmcnt(14) lgkmcnt(0)
  s_barrier
  v_mfma_f32_32x32x16_bf16 v[80:95], v[68:71], v[244:247], v[80:95]
  ds_read_b64_tr_b16 v[64:65], v28 offset:16384
  ds_read_b64_tr_b16 v[66:67], v28 offset:16896
  s_add_u32 m0, s94, 32768
  s_nop 0
  buffer_load_dwordx4 v13, s[12:15], s47 offen lds
  ds_read_b128 v[60:63], v9 offset:0
  v_mfma_f32_32x32x16_bf16 v[80:95], v[72:75], v[248:251], v[80:95]
  ds_read_b64_tr_b16 v[68:69], v29 offset:16384
  ds_read_b64_tr_b16 v[70:71], v29 offset:16896
  buffer_load_dwordx4 v0, s[12:15], s47 offen offset:1024 lds
  v_mfma_f32_32x32x16_bf16 v[80:95], v[76:79], v[252:255], v[80:95]
  ds_read_b64_tr_b16 v[72:73], v30 offset:16384
  ds_read_b64_tr_b16 v[74:75], v30 offset:16896
  s_add_u32 m0, s94, 40960
  s_nop 0
  buffer_load_dwordx4 v13, s[12:15], s48 offen lds
  s_waitcnt lgkmcnt(2)
  v_mfma_f32_16x16x32_bf16 v[56:59], v[52:55], v[64:67], 0
  v_mfma_f32_32x32x16_bf16 v[96:111], v[64:67], v[144:147], 0
  ds_read_b64_tr_b16 v[76:77], v31 offset:16384
  ds_read_b64_tr_b16 v[78:79], v31 offset:16896
  buffer_load_dwordx4 v0, s[12:15], s48 offen offset:1024 lds
  v_add_f32 v60, v60, v61
  v_add_f32 v62, v62, v63
  v_add_f32 v60, v60, v62
  v_cvt_pk_bf16_f32 v61, v60, v60
  v_lshlrev_b32 v61, 16, v61
  v_sub_f32 v62, v60, v61
  v_cvt_pk_bf16_f32 v48, v61, v62
  v_mfma_f32_32x32x16_bf16 v[96:111], v[68:71], v[148:151], v[96:111]
  ds_read_b64_tr_b16 v[64:65], v28 offset:24576
  ds_read_b64_tr_b16 v[66:67], v28 offset:25088
  s_add_u32 m0, s94, 49152
  s_nop 0
  buffer_load_dwordx4 v13, s[12:15], s49 offen lds
  v_mfma_f32_32x32x8_bf16 v[80:95], v[48:49], v[46:47], v[80:95]
  s_waitcnt lgkmcnt(2)
  v_mfma_f32_32x32x16_bf16 v[96:111], v[72:75], v[152:155], v[96:111]
  ds_read_b64_tr_b16 v[68:69], v29 offset:24576
  ds_read_b64_tr_b16 v[70:71], v29 offset:25088
  buffer_load_dwordx4 v0, s[12:15], s49 offen offset:1024 lds
  v_mfma_f32_32x32x16_bf16 v[96:111], v[76:79], v[156:159], v[96:111]
  ds_read_b64_tr_b16 v[72:73], v30 offset:24576
  ds_read_b64_tr_b16 v[74:75], v30 offset:25088
  s_lshl_b32 s83, s72, 6
  s_add_u32 s83, s83, 4096
  v_lshrrev_b32 v5, 2, v7
  v_min_u32 v5, 60, v5
  v_add_u32 v5, s83, v5
  buffer_load_dword v6, v5, s[36:39], 0 offen sc1
  s_add_u32 m0, s94, 57344
  s_nop 0
  buffer_load_dwordx4 v13, s[12:15], s50 offen lds
  v_mul_f32 v24, v80, v80
  v_mul_f32 v25, v81, v81
  v_fma_f32 v24, v24, v37, v36
  v_fma_f32 v25, v25, v37, v36
  v_mul_f32 v24, v24, v80
  v_mul_f32 v25, v25, v81
  v_exp_f32 v24, v24
  v_exp_f32 v25, v25
  s_waitcnt lgkmcnt(2)
  v_mfma_f32_16x16x32_bf16 v[56:59], v[52:55], v[64:67], v[56:59]
  v_mfma_f32_32x32x16_bf16 v[96:111], v[64:67], v[160:163], v[96:111]
  ds_read_b64_tr_b16 v[76:77], v31 offset:24576
  ds_read_b64_tr_b16 v[78:79], v31 offset:25088
  buffer_load_dwordx4 v0, s[12:15], s50 offen offset:1024 lds
  v_fma_f32 v24, v24, v35, v35
  v_fma_f32 v25, v25, v35, v35
  v_mul_f32 v26, v82, v82
  v_mul_f32 v27, v83, v83
  v_fma_f32 v26, v26, v37, v36
  v_mfma_f32_32x32x16_bf16 v[96:111], v[68:71], v[164:167], v[96:111]
  ds_read_b64_tr_b16 v[64:65], v28 offset:32768
  ds_read_b64_tr_b16 v[66:67], v28 offset:33280
  s_add_u32 m0, s94, 65536
  s_nop 0
  buffer_load_dwordx4 v13, s[16:19], s44 offen lds
  v_fma_f32 v27, v27, v37, v36
  v_mul_f32 v26, v26, v82
  v_mul_f32 v27, v27, v83
  v_rcp_f32 v24, v24
  v_rcp_f32 v25, v25
  s_waitcnt lgkmcnt(2)
  v_mfma_f32_32x32x16_bf16 v[96:111], v[72:75], v[168:171], v[96:111]
  ds_read_b64_tr_b16 v[68:69], v29 offset:32768
  ds_read_b64_tr_b16 v[70:71], v29 offset:33280
  buffer_load_dwordx4 v0, s[16:19], s44 offen offset:1024 lds
  v_exp_f32 v26, v26
  v_exp_f32 v27, v27
  v_mfma_f32_32x32x16_bf16 v[96:111], v[76:79], v[172:175], v[96:111]
  ds_read_b64_tr_b16 v[72:73], v30 offset:32768
  ds_read_b64_tr_b16 v[74:75], v30 offset:33280
  v_mul_f32 v80, v80, v24
  v_mul_f32 v81, v81, v25
  v_fma_f32 v26, v26, v35, v35
  v_fma_f32 v27, v27, v35, v35
  v_mul_f32 v24, v84, v84
  s_waitcnt lgkmcnt(2)
  v_mfma_f32_16x16x32_bf16 v[56:59], v[52:55], v[64:67], v[56:59]
  v_mfma_f32_32x32x16_bf16 v[96:111], v[64:67], v[176:179], v[96:111]
  ds_read_b64_tr_b16 v[76:77], v31 offset:32768
  ds_read_b64_tr_b16 v[78:79], v31 offset:33280
  v_mul_f32 v25, v85, v85
  v_fma_f32 v24, v24, v37, v36
  v_fma_f32 v25, v25, v37, v36
  v_mul_f32 v24, v24, v84
  v_mul_f32 v25, v25, v85
  v_rcp_f32 v26, v26
  s_waitcnt vmcnt(15)
  s_barrier
  v_mfma_f32_32x32x16_bf16 v[96:111], v[68:71], v[180:183], v[96:111]
  ds_read_b64_tr_b16 v[64:65], v28 offset:40960
  ds_read_b64_tr_b16 v[66:67], v28 offset:41472
  s_setprio 1
  ds_read_b64_tr_b16 v[112:113], v38 offset:0
  ds_read_b64_tr_b16 v[114:115], v39 offset:512
  ds_read_b64_tr_b16 v[116:117], v40 offset:0
  ds_read_b64_tr_b16 v[118:119], v41 offset:256
  ds_read_b64_tr_b16 v[120:121], v42 offset:0
  ds_read_b64_tr_b16 v[122:123], v43 offset:256
  ds_read_b64_tr_b16 v[124:125], v38 offset:4096
  s_waitcnt lgkmcnt(9)
  v_mfma_f32_32x32x16_bf16 v[96:111], v[72:75], v[184:187], v[96:111]
  ds_read_b64_tr_b16 v[68:69], v29 offset:40960
  ds_read_b64_tr_b16 v[70:71], v29 offset:41472
  s_add_u32 m0, s94, 73728
  s_nop 0
  buffer_load_dwordx4 v13, s[16:19], s45 offen lds
  ds_read_b64_tr_b16 v[126:127], v39 offset:4608
  ds_read_b64_tr_b16 v[128:129], v40 offset:2048
  ds_read_b64_tr_b16 v[130:131], v41 offset:2304
  ds_read_b64_tr_b16 v[132:133], v42 offset:2048
  ds_read_b64_tr_b16 v[134:135], v43 offset:2304
  s_lshl_b32 s99, s72, 7
  s_add_u32 s99, s99, s74
  s_lshl_b32 s99, s99, 6
  s_add_u32 s99, s99, 65536
  v_mfma_f32_32x32x16_bf16 v[96:111], v[76:79], v[188:191], v[96:111]
  ds_read_b64_tr_b16 v[72:73], v30 offset:40960
  ds_read_b64_tr_b16 v[74:75], v30 offset:41472
  s_waitcnt lgkmcnt(12)
  v_mfma_f32_16x16x32_bf16 v[136:139], v[116:119], v[112:115], 0
  s_waitcnt lgkmcnt(10)
  v_mfma_f32_16x16x32_bf16 v[140:143], v[120:123], v[112:115], 0
  ds_read_b64_tr_b16 v[112:113], v38 offset:8192
  ds_read_b64_tr_b16 v[114:115], v39 offset:8704
  ds_read_b64_tr_b16 v[116:117], v40 offset:4096
  ds_read_b64_tr_b16 v[118:119], v41 offset:4352
  ds_read_b64_tr_b16 v[120:121], v42 offset:4096
  s_waitcnt lgkmcnt(12)
  v_mfma_f32_16x16x32_bf16 v[56:59], v[52:55], v[64:67], v[56:59]
  v_mfma_f32_32x32x16_bf16 v[96:111], v[64:67], v[192:195], v[96:111]
  ds_read_b64_tr_b16 v[76:77], v31 offset:40960
  ds_read_b64_tr_b16 v[78:79], v31 offset:41472
  buffer_load_dwordx4 v0, s[16:19], s45 offen offset:1024 lds
  ds_read_b64_tr_b16 v[122:123], v43 offset:4352
  s_waitcnt lgkmcnt(12)
  v_mfma_f32_16x16x32_bf16 v[136:139], v[128:131], v[124:127], v[136:139]
  s_waitcnt lgkmcnt(10)
  v_mfma_f32_16x16x32_bf16 v[140:143], v[132:135], v[124:127], v[140:143]
  ds_read_b64_tr_b16 v[124:125], v38 offset:12288
  ds_read_b64_tr_b16 v[126:127], v39 offset:12800
  ds_read_b64_tr_b16 v[128:129], v40 offset:6144
  v_mfma_f32_32x32x16_bf16 v[96:111], v[68:71], v[196:199], v[96:111]
  ds_read_b64_tr_b16 v[64:65], v28 offset:49152
  ds_read_b64_tr_b16 v[66:67], v28 offset:49664
  ds_read_b64_tr_b16 v[130:131], v41 offset:6400
  ds_read_b64_tr_b16 v[132:133], v42 offset:6144
  ds_read_b64_tr_b16 v[134:135], v43 offset:6400
  s_waitcnt lgkmcnt(12)
  v_mfma_f32_16x16x32_bf16 v[136:139], v[116:119], v[112:115], v[136:139]
  s_waitcnt lgkmcnt(8)
  v_mfma_f32_16x16x32_bf16 v[140:143], v[120:123], v[112:115], v[140:143]
  v_mfma_f32_32x32x16_bf16 v[96:111], v[72:75], v[200:203], v[96:111]
  ds_read_b64_tr_b16 v[68:69], v29 offset:49152
  ds_read_b64_tr_b16 v[70:71], v29 offset:49664
  s_add_u32 m0, s94, 81920
  s_nop 0
  buffer_load_dwordx4 v13, s[16:19], s46 offen lds
  v_mfma_f32_32x32x16_bf16 v[96:111], v[76:79], v[204:207], v[96:111]
  ds_read_b64_tr_b16 v[72:73], v30 offset:49152
  ds_read_b64_tr_b16 v[74:75], v30 offset:49664
  s_waitcnt lgkmcnt(6)
  v_mfma_f32_16x16x32_bf16 v[136:139], v[128:131], v[124:127], v[136:139]
  s_waitcnt lgkmcnt(4)
  v_mfma_f32_16x16x32_bf16 v[140:143], v[132:135], v[124:127], v[140:143]
  v_bfe_u32 v39, v7, 8, 2
  v_bfe_u32 v38, v7, 2, 6
  v_lshl_add_u32 v39, v39, 10, v38
  s_waitcnt vmcnt(7)
  v_cmp_ne_u32 vcc, s80, v6
  s_mov_b32 s87, 262144
  s_nop 1
  s_cbranch_vccz L_poll_8_x
L_poll_8:
  buffer_load_dword v6, v5, s[36:39], 0 offen sc1
  s_sub_u32 s87, s87, 1
  s_cbranch_scc1 L_poll_8_y
  s_waitcnt vmcnt(0)
  v_cmp_ne_u32 vcc, s80, v6
  s_nop 4
  s_cbranch_vccnz L_poll_8
L_poll_8_y:
  s_waitcnt vmcnt(0)
  s_nop 4
L_poll_8_x:
  buffer_atomic_add_f32 v136, v39, s[36:39], s99 offen offset:0
  buffer_atomic_add_f32 v137, v39, s[36:39], s99 offen offset:256
  buffer_atomic_add_f32 v138, v39, s[36:39], s99 offen offset:512
  buffer_atomic_add_f32 v139, v39, s[36:39], s99 offen offset:768
  s_add_u32 s99, s99, 4096
  buffer_atomic_add_f32 v140, v39, s[36:39], s99 offen offset:0
  s_waitcnt lgkmcnt(2)
  v_mfma_f32_16x16x32_bf16 v[56:59], v[52:55], v[64:67], v[56:59]
  v_mfma_f32_32x32x16_bf16 v[96:111], v[64:67], v[208:211], v[96:111]
  ds_read_b64_tr_b16 v[76:77], v31 offset:49152
  ds_read_b64_tr_b16 v[78:79], v31 offset:49664
  buffer_load_dwordx4 v0, s[16:19], s46 offen offset:1024 lds
  buffer_atomic_add_f32 v141, v39, s[36:39], s99 offen offset:256
  buffer_atomic_add_f32 v142, v39, s[36:39], s99 offen offset:512
  buffer_atomic_add_f32 v143, v39, s[36:39], s99 offen offset:768
  v_rcp_f32 v27, v27
  v_exp_f32 v24, v24
  v_exp_f32 v25, v25
  v_mfma_f32_32x32x16_bf16 v[96:111], v[68:71], v[212:215], v[96:111]
  ds_read_b64_tr_b16 v[64:65], v28 offset:57344
  ds_read_b64_tr_b16 v[66:67], v28 offset:57856
  v_mul_f32 v82, v82, v26
  v_mul_f32 v83, v83, v27
  v_fma_f32 v24, v24, v35, v35
  v_fma_f32 v25, v25, v35, v35
  v_mul_f32 v26, v86, v86
  v_mul_f32 v27, v87, v87
  v_fma_f32 v26, v26, v37, v36
  v_fma_f32 v27, v27, v37, v36
  s_waitcnt lgkmcnt(2)
  v_mfma_f32_32x32x16_bf16 v[96:111], v[72:75], v[216:219], v[96:111]
  ds_read_b64_tr_b16 v[68:69], v29 offset:57344
  ds_read_b64_tr_b16 v[70:71], v29 offset:57856
  s_add_u32 m0, s94, 90112
  s_nop 0
  buffer_load_dwordx4 v13, s[16:19], s47 offen lds
  v_mul_f32 v26, v26, v86
  v_mul_f32 v27, v27, v87
  v_rcp_f32 v24, v24
  v_rcp_f32 v25, v25
  v_exp_f32 v26, v26
  v_exp_f32 v27, v27
  v_mfma_f32_32x32x16_bf16 v[96:111], v[76:79], v[220:223], v[96:111]
  ds_read_b64_tr_b16 v[72:73], v30 offset:57344
  ds_read_b64_tr_b16 v[74:75], v30 offset:57856
  v_mul_f32 v84, v84, v24
  v_mul_f32 v85, v85, v25
  v_fma_f32 v26, v26, v35, v35
  v_fma_f32 v27, v27, v35, v35
  v_mul_f32 v24, v88, v88
  v_mul_f32 v25, v89, v89
  v_fma_f32 v24, v24, v37, v36
  s_waitcnt lgkmcnt(2)
  v_mfma_f32_16x16x32_bf16 v[56:59], v[52:55], v[64:67], v[56:59]
  v_mfma_f32_32x32x16_bf16 v[96:111], v[64:67], v[224:227], v[96:111]
  ds_read_b64_tr_b16 v[76:77], v31 offset:57344
  ds_read_b64_tr_b16 v[78:79], v31 offset:57856
  buffer_load_dwordx4 v0, s[16:19], s47 offen offset:1024 lds
  v_fma_f32 v25, v25, v37, v36
  v_mul_f32 v24, v24, v88
  v_mul_f32 v25, v25, v89
  v_rcp_f32 v26, v26
  v_rcp_f32 v27, v27
  v_exp_f32 v24, v24
  v_mfma_f32_32x32x16_bf16 v[96:111], v[68:71], v[228:231], v[96:111]
  v_add_u32 v28, 0xffff0000, v28
  v_add_u32 v29, 0xffff0000, v29
  v_add_u32 v30, 0xffff0000, v30
  v_add_u32 v31, 0xffff0000, v31
  ds_read_b64_tr_b16 v[64:65], v28 offset:0
  ds_read_b64_tr_b16 v[66:67], v28 offset:512
  v_exp_f32 v25, v25
  v_mul_f32 v86, v86, v26
  v_mul_f32 v87, v87, v27
  v_fma_f32 v24, v24, v35, v35
  v_fma_f32 v25, v25, v35, v35
  v_mul_f32 v26, v90, v90
  s_waitcnt lgkmcnt(2)
  v_mfma_f32_32x32x16_bf16 v[96:111], v[72:75], v[232:235], v[96:111]
  ds_read_b64_tr_b16 v[68:69], v29 offset:0
  ds_read_b64_tr_b16 v[70:71], v29 offset:512
  v_mul_f32 v27, v91, v91
  v_fma_f32 v26, v26, v37, v36
  v_fma_f32 v27, v27, v37, v36
  v_mul_f32 v26, v26, v90
  v_mul_f32 v27, v27, v91
  v_rcp_f32 v24, v24
  v_rcp_f32 v25, v25
  v_mfma_f32_32x32x16_bf16 v[96:111], v[76:79], v[236:239], v[96:111]
  ds_read_b64_tr_b16 v[72:73], v30 offset:0
  ds_read_b64_tr_b16 v[74:75], v30 offset:512
  v_exp_f32 v26, v26
  v_exp_f32 v27, v27
  v_mul_f32 v88, v88, v24
  v_mul_f32 v89, v89, v25
  v_fma_f32 v26, v26, v35, v35
  v_fma_f32 v27, v27, v35, v35
  s_waitcnt lgkmcnt(2)
  v_mfma_f32_16x16x32_bf16 v[56:59], v[52:55], v[64:67], v[56:59]
  v_mfma_f32_32x32x16_bf16 v[96:111], v[64:67], v[240:243], v[96:111]
  ds_read_b64_tr_b16 v[76:77], v31 offset:0
  ds_read_b64_tr_b16 v[78:79], v31 offset:512
  v_mul_f32 v24, v92, v92
  v_mul_f32 v25, v93, v93
  v_fma_f32 v24, v24, v37, v36
  v_fma_f32 v25, v25, v37, v36
  v_mul_f32 v24, v24, v92
  v_mul_f32 v25, v25, v93
  v_rcp_f32 v26, v26
  v_rcp_f32 v27, v27
  ds_write2_b32 v10, v56, v57 offset0:128 offset1:192
  v_mfma_f32_32x32x16_bf16 v[96:111], v[68:71], v[244:247], v[96:111]
  ds_read_b64_tr_b16 v[64:65], v28 offset:8192
  ds_read_b64_tr_b16 v[66:67], v28 offset:8704
  v_exp_f32 v24, v24
  v_exp_f32 v25, v25
  v_mul_f32 v90, v90, v26
  v_mul_f32 v91, v91, v27
  v_fma_f32 v24, v24, v35, v35
  s_waitcnt lgkmcnt(3)
  v_mfma_f32_32x32x16_bf16 v[96:111], v[72:75], v[248:251], v[96:111]
  ds_read_b64_tr_b16 v[68:69], v29 offset:8192
  ds_read_b64_tr_b16 v[70:71], v29 offset:8704
  v_fma_f32 v25, v25, v35, v35
  v_mul_f32 v26, v94, v94
  v_mul_f32 v27, v95, v95
  v_fma_f32 v26, v26, v37, v36
  v_fma_f32 v27, v27, v37, v36
  v_mul_f32 v26, v26, v94
  v_mul_f32 v27, v27, v95
  v_rcp_f32 v24, v24
  v_mfma_f32_32x32x16_bf16 v[96:111], v[76:79], v[252:255], v[96:111]
  ds_read_b64_tr_b16 v[72:73], v30 offset:8192
  ds_read_b64_tr_b16 v[74:75], v30 offset:8704
  v_rcp_f32 v25, v25
  v_exp_f32 v26, v26
  v_exp_f32 v27, v27
  v_mul_f32 v92, v92, v24
  s_waitcnt lgkmcnt(2)
  v_mfma_f32_16x16x32_bf16 v[56:59], v[52:55], v[64:67], 0
  v_mfma_f32_32x32x16_bf16 v[112:127], v[64:67], v[144:147], 0
  ds_read_b64_tr_b16 v[76:77], v31 offset:8192
  ds_read_b64_tr_b16 v[78:79], v31 offset:8704
  v_mul_f32 v93, v93, v25
  v_fma_f32 v26, v26, v35, v35
  v_fma_f32 v27, v27, v35, v35
  v_rcp_f32 v26, v26
  v_rcp_f32 v27, v27
  v_mul_f32 v94, v94, v26
  v_mul_f32 v95, v95, v27
  s_barrier
  v_mfma_f32_32x32x16_bf16 v[112:127], v[68:71], v[148:151], v[112:127]
  ds_read_b64_tr_b16 v[64:65], v28 offset:16384
  ds_read_b64_tr_b16 v[66:67], v28 offset:16896
  s_add_u32 m0, s94, 98304
  s_nop 0
  buffer_load_dwordx4 v13, s[16:19], s48 offen lds
  ds_read_b128 v[60:63], v9 offset:512
  s_waitcnt lgkmcnt(3)
  v_mfma_f32_32x32x16_bf16 v[112:127], v[72:75], v[152:155], v[112:127]
  ds_read_b64_tr_b16 v[68:69], v29 offset:16384
  ds_read_b64_tr_b16 v[70:71], v29 offset:16896
  buffer_load_dwordx4 v0, s[16:19], s48 offen offset:1024 lds
  v_mfma_f32_32x32x16_bf16 v[112:127], v[76:79], v[156:159], v[112:127]
  ds_read_b64_tr_b16 v[72:73], v30 offset:16384
  ds_read_b64_tr_b16 v[74:75], v30 offset:16896
  s_add_u32 m0, s94, 106496
  s_nop 0
  buffer_load_dwordx4 v13, s[16:19], s49 offen lds
  s_waitcnt lgkmcnt(2)
  v_mfma_f32_16x16x32_bf16 v[56:59], v[52:55], v[64:67], v[56:59]
  v_mfma_f32_32x32x16_bf16 v[112:127], v[64:67], v[160:163], v[112:127]
  ds_read_b64_tr_b16 v[76:77], v31 offset:16384
  ds_read_b64_tr_b16 v[78:79], v31 offset:16896
  buffer_load_dwordx4 v0, s[16:19], s49 offen offset:1024 lds
  v_add_f32 v60, v60, v61
  v_add_f32 v62, v62, v63
  v_add_f32 v60, v60, v62
  v_cvt_pk_bf16_f32 v61, v60, v60
  v_lshlrev_b32 v61, 16, v61
  v_sub_f32 v62, v60, v61
  v_cvt_pk_bf16_f32 v48, v61, v62
  v_mfma_f32_32x32x16_bf16 v[112:127], v[68:71], v[164:167], v[112:127]
  ds_read_b64_tr_b16 v[64:65], v28 offset:24576
  ds_read_b64_tr_b16 v[66:67], v28 offset:25088
  s_add_u32 m0, s94, 114688
  s_nop 0
  buffer_load_dwordx4 v13, s[16:19], s50 offen lds
  v_mfma_f32_32x32x8_bf16 v[96:111], v[48:49], v[46:47], v[96:111]
  s_xor_b32 s99, s96, 0
  s_lshl_b32 s99, s99, 12
  s_waitcnt lgkmcnt(2)
  v_mfma_f32_32x32x16_bf16 v[112:127], v[72:75], v[168:171], v[112:127]
  ds_read_b64_tr_b16 v[68:69], v29 offset:24576
  ds_read_b64_tr_b16 v[70:71], v29 offset:25088
  s_waitcnt vmcnt(7)
  s_lshl_b32 s83, s72, 2
  s_add_u32 s83, s83, s74
  s_lshl_b32 s83, s83, 4
  s_add_u32 s83, s83, s70
  s_lshl_b32 s83, s83, 2
  v_mov_b32 v5, s80
  v_lshlrev_b32 v6, 24, v7
  buffer_store_dword v5, v6, s[36:39], s83 offen sc1
  buffer_load_dwordx4 v0, s[16:19], s50 offen offset:1024 lds
  v_mul_f32 v96, v96, v80
  v_mul_f32 v97, v97, v81
  v_mul_f32 v98, v98, v82
  v_mul_f32 v99, v99, v83
  v_cvt_pk_bf16_f32 v80, v96, v97
  v_mul_f32 v100, v100, v84
  v_mul_f32 v101, v101, v85
  v_cvt_pk_bf16_f32 v81, v98, v99
  v_mul_f32 v102, v102, v86
  v_mul_f32 v103, v103, v87
  v_cvt_pk_bf16_f32 v82, v100, v101
  v_mul_f32 v104, v104, v88
  v_mul_f32 v105, v105, v89
  v_cvt_pk_bf16_f32 v83, v102, v103
  v_mul_f32 v106, v106, v90
  v_mul_f32 v107, v107, v91
  v_mfma_f32_32x32x16_bf16 v[112:127], v[76:79], v[172:175], v[112:127]
  ds_read_b64_tr_b16 v[72:73], v30 offset:24576
  ds_read_b64_tr_b16 v[74:75], v30 offset:25088
  s_add_u32 m0, s94, 122880
  v_add_u32 v14, 6144, v12
  buffer_load_dwordx4 v12, s[20:23], s51 offen lds
  v_cvt_pk_bf16_f32 v84, v104, v105
  v_mul_f32 v108, v108, v92
  v_mul_f32 v109, v109, v93
  v_cvt_pk_bf16_f32 v85, v106, v107
  v_mul_f32 v110, v110, v94
  v_mul_f32 v111, v111, v95
  v_cvt_pk_bf16_f32 v86, v108, v109
  v_cvt_pk_bf16_f32 v87, v110, v111
  buffer_store_dwordx4 v[80:83], v11, s[36:39], s99 offen sc1
  buffer_store_dwordx4 v[84:87], v11, s[36:39], s99 offen offset:1024 sc1
  s_waitcnt lgkmcnt(2)
  v_mfma_f32_16x16x32_bf16 v[56:59], v[52:55], v[64:67], v[56:59]
  v_mfma_f32_32x32x16_bf16 v[112:127], v[64:67], v[176:179], v[112:127]
  ds_read_b64_tr_b16 v[76:77], v31 offset:24576
  ds_read_b64_tr_b16 v[78:79], v31 offset:25088
  buffer_load_dwordx4 v14, s[20:23], s51 offen offset:1024 lds
  v_mfma_f32_32x32x16_bf16 v[112:127], v[68:71], v[180:183], v[112:127]
  ds_read_b64_tr_b16 v[64:65], v28 offset:32768
  ds_read_b64_tr_b16 v[66:67], v28 offset:33280
  s_add_u32 m0, s94, 131072
  s_add_u32 s89, s51, 114688
  buffer_load_dwordx4 v12, s[20:23], s89 offen lds
  s_waitcnt lgkmcnt(2)
  v_mfma_f32_32x32x16_bf16 v[112:127], v[72:75], v[184:187], v[112:127]
  ds_read_b64_tr_b16 v[68:69], v29 offset:32768
  ds_read_b64_tr_b16 v[70:71], v29 offset:33280
  buffer_load_dwordx4 v14, s[20:23], s89 offen offset:1024 lds
  v_mfma_f32_32x32x16_bf16 v[112:127], v[76:79], v[188:191], v[112:127]
  ds_read_b64_tr_b16 v[72:73], v30 offset:32768
  ds_read_b64_tr_b16 v[74:75], v30 offset:33280
  s_add_u32 m0, s94, 139264
  s_nop 0
  buffer_load_dwordx4 v12, s[20:23], s52 offen lds
  s_waitcnt lgkmcnt(2)
  v_mfma_f32_16x16x32_bf16 v[56:59], v[52:55], v[64:67], v[56:59]
  v_mfma_f32_32x32x16_bf16 v[112:127], v[64:67], v[192:195], v[112:127]
  ds_read_b64_tr_b16 v[76:77], v31 offset:32768
  ds_read_b64_tr_b16 v[78:79], v31 offset:33280
  buffer_load_dwordx4 v14, s[20:23], s52 offen offset:1024 lds
  v_mfma_f32_32x32x16_bf16 v[112:127], v[68:71], v[196:199], v[112:127]
  ds_read_b64_tr_b16 v[64:65], v28 offset:40960
  ds_read_b64_tr_b16 v[66:67], v28 offset:41472
  s_add_u32 m0, s94, 147456
  s_add_u32 s89, s52, 114688
  buffer_load_dwordx4 v12, s[20:23], s89 offen lds
  s_waitcnt lgkmcnt(2)
  v_mfma_f32_32x32x16_bf16 v[112:127], v[72:75], v[200:203], v[112:127]
  ds_read_b64_tr_b16 v[68:69], v29 offset:40960
  ds_read_b64_tr_b16 v[70:71], v29 offset:41472
  buffer_load_dwordx4 v14, s[20:23], s89 offen offset:1024 lds
  v_mfma_f32_32x32x16_bf16 v[112:127], v[76:79], v[204:207], v[112:127]
  ds_read_b64_tr_b16 v[72:73], v30 offset:40960
  ds_read_b64_tr_b16 v[74:75], v30 offset:41472
  s_add_u32 m0, s94, 0
  s_nop 0
  buffer_load_dwordx4 v12, s[20:23], s53 offen lds
  s_waitcnt lgkmcnt(2)
  v_mfma_f32_16x16x32_bf16 v[56:59], v[52:55], v[64:67], v[56:59]
  v_mfma_f32_32x32x16_bf16 v[112:127], v[64:67], v[208:211], v[112:127]
  ds_read_b64_tr_b16 v[76:77], v31 offset:40960
  ds_read_b64_tr_b16 v[78:79], v31 offset:41472
  buffer_load_dwordx4 v14, s[20:23], s53 offen offset:1024 lds
  s_waitcnt vmcnt(9)
  s_barrier
  v_mfma_f32_32x32x16_bf16 v[112:127], v[68:71], v[212:215], v[112:127]
  ds_read_b64_tr_b16 v[64:65], v28 offset:49152
  ds_read_b64_tr_b16 v[66:67], v28 offset:49664
  s_add_u32 m0, s94, 8192
  s_add_u32 s89, s53, 114688
  buffer_load_dwordx4 v12, s[20:23], s89 offen lds
  s_waitcnt lgkmcnt(2)
  v_mfma_f32_32x32x16_bf16 v[112:127], v[72:75], v[216:219], v[112:127]
  ds_read_b64_tr_b16 v[68:69], v29 offset:49152
  ds_read_b64_tr_b16 v[70:71], v29 offset:49664
  buffer_load_dwordx4 v14, s[20:23], s89 offen offset:1024 lds
  v_mfma_f32_32x32x16_bf16 v[112:127], v[76:79], v[220:223], v[112:127]
  ds_read_b64_tr_b16 v[72:73], v30 offset:49152
  ds_read_b64_tr_b16 v[74:75], v30 offset:49664
  s_add_u32 m0, s94, 16384
  s_nop 0
  buffer_load_dwordx4 v12, s[20:23], s54 offen lds
  s_waitcnt lgkmcnt(2)
  v_mfma_f32_16x16x32_bf16 v[56:59], v[52:55], v[64:67], v[56:59]
  v_mfma_f32_32x32x16_bf16 v[112:127], v[64:67], v[224:227], v[112:127]
  ds_read_b64_tr_b16 v[76:77], v31 offset:49152
  ds_read_b64_tr_b16 v[78:79], v31 offset:49664
  buffer_load_dwordx4 v14, s[20:23], s54 offen offset:1024 lds
  v_mfma_f32_32x32x16_bf16 v[112:127], v[68:71], v[228:231], v[112:127]
  ds_read_b64_tr_b16 v[64:65], v28 offset:57344
  ds_read_b64_tr_b16 v[66:67], v28 offset:57856
  s_add_u32 m0, s94, 24576
  s_add_u32 s89, s54, 114688
  buffer_load_dwordx4 v12, s[20:23], s89 offen lds
  s_waitcnt lgkmcnt(2)
  v_mfma_f32_32x32x16_bf16 v[112:127], v[72:75], v[232:235], v[112:127]
  ds_read_b64_tr_b16 v[68:69], v29 offset:57344
  ds_read_b64_tr_b16 v[70:71], v29 offset:57856
  buffer_load_dwordx4 v14, s[20:23], s89 offen offset:1024 lds
  v_mfma_f32_32x32x16_bf16 v[112:127], v[76:79], v[236:239], v[112:127]
  ds_read_b64_tr_b16 v[72:73], v30 offset:57344
  ds_read_b64_tr_b16 v[74:75], v30 offset:57856
  s_waitcnt lgkmcnt(2)
  v_mfma_f32_16x16x32_bf16 v[56:59], v[52:55], v[64:67], v[56:59]
  v_mfma_f32_32x32x16_bf16 v[112:127], v[64:67], v[240:243], v[112:127]
  ds_read_b64_tr_b16 v[76:77], v31 offset:57344
  ds_read_b64_tr_b16 v[78:79], v31 offset:57856
  s_add_u32 m0, s94, 32768
  s_nop 0
  buffer_load_dwordx4 v12, s[20:23], s55 offen lds
  s_nop 1
  ds_write2_b32 v10, v56, v57 offset0:0 offset1:64
  v_mfma_f32_32x32x16_bf16 v[112:127], v[68:71], v[244:247], v[112:127]
  v_add_u32 v28, 0x10000, v28
  v_add_u32 v29, 0x10000, v29
  v_add_u32 v30, 0x10000, v30
  v_add_u32 v31, 0x10000, v31
  ds_read_b64_tr_b16 v[64:65], v28 offset:0
  ds_read_b64_tr_b16 v[66:67], v28 offset:512
  s_waitcnt lgkmcnt(3)
  v_mfma_f32_32x32x16_bf16 v[112:127], v[72:75], v[248:251], v[112:127]
  ds_read_b64_tr_b16 v[68:69], v29 offset:0
  ds_read_b64_tr_b16 v[70:71], v29 offset:512
  buffer_load_dwordx4 v14, s[20:23], s55 offen offset:1024 lds
  v_mfma_f32_32x32x16_bf16 v[112:127], v[76:79], v[252:255], v[112:127]
  ds_read_b64_tr_b16 v[72:73], v30 offset:0
  ds_read_b64_tr_b16 v[74:75], v30 offset:512
  s_waitcnt lgkmcnt(2)
  v_mfma_f32_16x16x32_bf16 v[56:59], v[52:55], v[64:67], 0
  v_mfma_f32_32x32x16_bf16 v[128:143], v[64:67], v[144:147], 0
  ds_read_b64_tr_b16 v[76:77], v31 offset:0
  ds_read_b64_tr_b16 v[78:79], v31 offset:512
  s_barrier
  v_mfma_f32_32x32x16_bf16 v[128:143], v[68:71], v[148:151], v[128:143]
  ds_read_b64_tr_b16 v[64:65], v28 offset:8192
  ds_read_b64_tr_b16 v[66:67], v28 offset:8704
  s_add_u32 m0, s94, 40960
  s_add_u32 s89, s55, 114688
  buffer_load_dwordx4 v12, s[20:23], s89 offen lds
  ds_read_b128 v[60:63], v9 offset:0
  s_waitcnt lgkmcnt(3)
  v_mfma_f32_32x32x16_bf16 v[128:143], v[72:75], v[152:155], v[128:143]
  ds_read_b64_tr_b16 v[68:69], v29 offset:8192
  ds_read_b64_tr_b16 v[70:71], v29 offset:8704
  buffer_load_dwordx4 v14, s[20:23], s89 offen offset:1024 lds
  v_mfma_f32_32x32x16_bf16 v[128:143], v[76:79], v[156:159], v[128:143]
  ds_read_b64_tr_b16 v[72:73], v30 offset:8192
  ds_read_b64_tr_b16 v[74:75], v30 offset:8704
  s_waitcnt lgkmcnt(2)
  v_mfma_f32_16x16x32_bf16 v[56:59], v[52:55], v[64:67], v[56:59]
  v_mfma_f32_32x32x16_bf16 v[128:143], v[64:67], v[160:163], v[128:143]
  ds_read_b64_tr_b16 v[76:77], v31 offset:8192
  ds_read_b64_tr_b16 v[78:79], v31 offset:8704
  s_add_u32 m0, s94, 49152
  s_nop 0
  buffer_load_dwordx4 v12, s[20:23], s56 offen lds
  v_add_f32 v60, v60, v61
  v_add_f32 v62, v62, v63
  v_add_f32 v60, v60, v62
  v_cvt_pk_bf16_f32 v61, v60, v60
  v_lshlrev_b32 v61, 16, v61
  v_sub_f32 v62, v60, v61
  v_cvt_pk_bf16_f32 v48, v61, v62
  v_mfma_f32_32x32x16_bf16 v[128:143], v[68:71], v[164:167], v[128:143]
  ds_read_b64_tr_b16 v[64:65], v28 offset:16384
  ds_read_b64_tr_b16 v[66:67], v28 offset:16896
  v_mfma_f32_32x32x8_bf16 v[112:127], v[48:49], v[46:47], v[112:127]
  s_waitcnt lgkmcnt(2)
  v_mfma_f32_32x32x16_bf16 v[128:143], v[72:75], v[168:171], v[128:143]
  ds_read_b64_tr_b16 v[68:69], v29 offset:16384
  ds_read_b64_tr_b16 v[70:71], v29 offset:16896
  buffer_load_dwordx4 v14, s[20:23], s56 offen offset:1024 lds
  v_mfma_f32_32x32x16_bf16 v[128:143], v[76:79], v[172:175], v[128:143]
  ds_read_b64_tr_b16 v[72:73], v30 offset:16384
  ds_read_b64_tr_b16 v[74:75], v30 offset:16896
  s_waitcnt lgkmcnt(2)
  v_mfma_f32_16x16x32_bf16 v[56:59], v[52:55], v[64:67], v[56:59]
  v_mfma_f32_32x32x16_bf16 v[128:143], v[64:67], v[176:179], v[128:143]
  ds_read_b64_tr_b16 v[76:77], v31 offset:16384
  ds_read_b64_tr_b16 v[78:79], v31 offset:16896
  s_add_u32 m0, s94, 57344
  s_add_u32 s89, s56, 114688
  buffer_load_dwordx4 v12, s[20:23], s89 offen lds
  v_mul_f32 v24, v112, v112
  v_mul_f32 v25, v113, v113
  v_fma_f32 v24, v24, v37, v36
  v_fma_f32 v25, v25, v37, v36
  v_mul_f32 v24, v24, v112
  v_mul_f32 v25, v25, v113
  v_exp_f32 v24, v24
  v_exp_f32 v25, v25
  v_fma_f32 v24, v24, v35, v35
  v_fma_f32 v25, v25, v35, v35
  v_mul_f32 v26, v114, v114
  v_mfma_f32_32x32x16_bf16 v[128:143], v[68:71], v[180:183], v[128:143]
  ds_read_b64_tr_b16 v[64:65], v28 offset:24576
  ds_read_b64_tr_b16 v[66:67], v28 offset:25088
  v_mul_f32 v27, v115, v115
  v_fma_f32 v26, v26, v37, v36
  v_fma_f32 v27, v27, v37, v36
  v_mul_f32 v26, v26, v114
  v_mul_f32 v27, v27, v115
  v_rcp_f32 v24, v24
  v_rcp_f32 v25, v25
  s_waitcnt lgkmcnt(2)
  v_mfma_f32_32x32x16_bf16 v[128:143], v[72:75], v[184:187], v[128:143]
  ds_read_b64_tr_b16 v[68:69], v29 offset:24576
  ds_read_b64_tr_b16 v[70:71], v29 offset:25088
  buffer_load_dwordx4 v14, s[20:23], s89 offen offset:1024 lds
  v_exp_f32 v26, v26
  v_exp_f32 v27, v27
  v_mul_f32 v112, v112, v24
  v_mul_f32 v113, v113, v25
  v_fma_f32 v26, v26, v35, v35
  v_mfma_f32_32x32x16_bf16 v[128:143], v[76:79], v[188:191], v[128:143]
  ds_read_b64_tr_b16 v[72:73], v30 offset:24576
  ds_read_b64_tr_b16 v[74:75], v30 offset:25088
  v_fma_f32 v27, v27, v35, v35
  v_mul_f32 v24, v116, v116
  v_mul_f32 v25, v117, v117
  v_fma_f32 v24, v24, v37, v36
  v_fma_f32 v25, v25, v37, v36
  v_mul_f32 v24, v24, v116
  v_mul_f32 v25, v25, v117
  v_rcp_f32 v26, v26
  s_waitcnt lgkmcnt(2)
  v_mfma_f32_16x16x32_bf16 v[56:59], v[52:55], v[64:67], v[56:59]
  v_mfma_f32_32x32x16_bf16 v[128:143], v[64:67], v[192:195], v[128:143]
  ds_read_b64_tr_b16 v[76:77], v31 offset:24576
  ds_read_b64_tr_b16 v[78:79], v31 offset:25088
  v_rcp_f32 v27, v27
  v_exp_f32 v24, v24
  v_exp_f32 v25, v25
  v_mul_f32 v114, v114, v26
  v_mul_f32 v115, v115, v27
  s_barrier
  v_mfma_f32_32x32x16_bf16 v[128:143], v[68:71], v[196:199], v[128:143]
  ds_read_b64_tr_b16 v[64:65], v28 offset:32768
  ds_read_b64_tr_b16 v[66:67], v28 offset:33280
  s_add_u32 m0, s94, 65536
  s_nop 0
  buffer_load_dwordx4 v12, s[20:23], s57 offen lds
  v_fma_f32 v24, v24, v35, v35
  v_fma_f32 v25, v25, v35, v35
  v_mul_f32 v26, v118, v118
  v_mul_f32 v27, v119, v119
  v_fma_f32 v26, v26, v37, v36
  v_fma_f32 v27, v27, v37, v36
  v_mul_f32 v26, v26, v118
  v_mul_f32 v27, v27, v119
  s_waitcnt lgkmcnt(2)
  v_mfma_f32_32x32x16_bf16 v[128:143], v[72:75], v[200:203], v[128:143]
  ds_read_b64_tr_b16 v[68:69], v29 offset:32768
  ds_read_b64_tr_b16 v[70:71], v29 offset:33280
  buffer_load_dwordx4 v14, s[20:23], s57 offen offset:1024 lds
  v_rcp_f32 v24, v24
  v_rcp_f32 v25, v25
  v_exp_f32 v26, v26
  v_exp_f32 v27, v27
  v_mfma_f32_32x32x16_bf16 v[128:143], v[76:79], v[204:207], v[128:143]
  ds_read_b64_tr_b16 v[72:73], v30 offset:32768
  ds_read_b64_tr_b16 v[74:75], v30 offset:33280
  v_mul_f32 v116, v116, v24
  v_mul_f32 v117, v117, v25
  v_fma_f32 v26, v26, v35, v35
  v_fma_f32 v27, v27, v35, v35
  v_mul_f32 v24, v120, v120
  v_mul_f32 v25, v121, v121
  v_fma_f32 v24, v24, v37, v36
  v_fma_f32 v25, v25, v37, v36
  s_waitcnt lgkmcnt(2)
  v_mfma_f32_16x16x32_bf16 v[56:59], v[52:55], v[64:67], v[56:59]
  v_mfma_f32_32x32x16_bf16 v[128:143], v[64:67], v[208:211], v[128:143]
  ds_read_b64_tr_b16 v[76:77], v31 offset:32768
  ds_read_b64_tr_b16 v[78:79], v31 offset:33280
  s_add_u32 m0, s94, 73728
  s_add_u32 s89, s57, 114688
  buffer_load_dwordx4 v12, s[20:23], s89 offen lds
  v_mul_f32 v24, v24, v120
  v_mul_f32 v25, v25, v121
  v_rcp_f32 v26, v26
  v_rcp_f32 v27, v27
  v_exp_f32 v24, v24
  v_mfma_f32_32x32x16_bf16 v[128:143], v[68:71], v[212:215], v[128:143]
  ds_read_b64_tr_b16 v[64:65], v28 offset:40960
  ds_read_b64_tr_b16 v[66:67], v28 offset:41472
  v_exp_f32 v25, v25
  v_mul_f32 v118, v118, v26
  v_mul_f32 v119, v119, v27
  v_fma_f32 v24, v24, v35, v35
  v_fma_f32 v25, v25, v35, v35
  v_mul_f32 v26, v122, v122
  v_mul_f32 v27, v123, v123
  v_fma_f32 v26, v26, v37, v36
  s_waitcnt lgkmcnt(2)
  v_mfma_f32_32x32x16_bf16 v[128:143], v[72:75], v[216:219], v[128:143]
  ds_read_b64_tr_b16 v[68:69], v29 offset:40960
  ds_read_b64_tr_b16 v[70:71], v29 offset:41472
  buffer_load_dwordx4 v14, s[20:23], s89 offen offset:1024 lds
  v_fma_f32 v27, v27, v37, v36
  v_mul_f32 v26, v26, v122
  v_mul_f32 v27, v27, v123
  v_rcp_f32 v24, v24
  v_rcp_f32 v25, v25
  v_exp_f32 v26, v26
  v_mfma_f32_32x32x16_bf16 v[128:143], v[76:79], v[220:223], v[128:143]
  ds_read_b64_tr_b16 v[72:73], v30 offset:40960
  ds_read_b64_tr_b16 v[74:75], v30 offset:41472
  v_exp_f32 v27, v27
  v_mul_f32 v120, v120, v24
  v_mul_f32 v121, v121, v25
  v_fma_f32 v26, v26, v35, v35
  v_fma_f32 v27, v27, v35, v35
  v_mul_f32 v24, v124, v124
  s_waitcnt lgkmcnt(2)
  v_mfma_f32_16x16x32_bf16 v[56:59], v[52:55], v[64:67], v[56:59]
  v_mfma_f32_32x32x16_bf16 v[128:143], v[64:67], v[224:227], v[128:143]
  ds_read_b64_tr_b16 v[76:77], v31 offset:40960
  ds_read_b64_tr_b16 v[78:79], v31 offset:41472
  s_add_u32 m0, s94, 81920
  v_add_u32 v12, s97, v12
  v_add_u32 v14, s97, v14
  buffer_load_dwordx4 v12, s[20:23], s51 offen lds
  v_mul_f32 v25, v125, v125
  v_fma_f32 v24, v24, v37, v36
  v_fma_f32 v25, v25, v37, v36
  v_mul_f32 v24, v24, v124
  v_mul_f32 v25, v25, v125
  v_rcp_f32 v26, v26
  v_rcp_f32 v27, v27
  v_mfma_f32_32x32x16_bf16 v[128:143], v[68:71], v[228:231], v[128:143]
  ds_read_b64_tr_b16 v[64:65], v28 offset:49152
  ds_read_b64_tr_b16 v[66:67], v28 offset:49664
  v_exp_f32 v24, v24
  v_exp_f32 v25, v25
  v_mul_f32 v122, v122, v26
  v_mul_f32 v123, v123, v27
  v_fma_f32 v24, v24, v35, v35
  s_waitcnt lgkmcnt(2)
  v_mfma_f32_32x32x16_bf16 v[128:143], v[72:75], v[232:235], v[128:143]
  ds_read_b64_tr_b16 v[68:69], v29 offset:49152
  ds_read_b64_tr_b16 v[70:71], v29 offset:49664
  buffer_load_dwordx4 v14, s[20:23], s51 offen offset:1024 lds
  v_fma_f32 v25, v25, v35, v35
  v_mul_f32 v26, v126, v126
  v_mul_f32 v27, v127, v127
  v_fma_f32 v26, v26, v37, v36
  v_fma_f32 v27, v27, v37, v36
  v_mul_f32 v26, v26, v126
  v_mul_f32 v27, v27, v127
  v_rcp_f32 v24, v24
  v_mfma_f32_32x32x16_bf16 v[128:143], v[76:79], v[236:239], v[128:143]
  ds_read_b64_tr_b16 v[72:73], v30 offset:49152
  ds_read_b64_tr_b16 v[74:75], v30 offset:49664
  v_rcp_f32 v25, v25
  v_exp_f32 v26, v26
  v_exp_f32 v27, v27
  v_mul_f32 v124, v124, v24
  s_waitcnt lgkmcnt(2)
  v_mfma_f32_16x16x32_bf16 v[56:59], v[52:55], v[64:67], v[56:59]
  v_mfma_f32_32x32x16_bf16 v[128:143], v[64:67], v[240:243], v[128:143]
  ds_read_b64_tr_b16 v[76:77], v31 offset:49152
  ds_read_b64_tr_b16 v[78:79], v31 offset:49664
  v_mul_f32 v125, v125, v25
  v_fma_f32 v26, v26, v35, v35
  v_fma_f32 v27, v27, v35, v35
  v_rcp_f32 v26, v26
  v_rcp_f32 v27, v27
  v_mul_f32 v126, v126, v26
  v_mul_f32 v127, v127, v27
  ds_write2_b32 v10, v56, v57 offset0:128 offset1:192
  s_waitcnt vmcnt(26) lgkmcnt(0)
  s_barrier
  v_mfma_f32_32x32x16_bf16 v[128:143], v[68:71], v[244:247], v[128:143]
  ds_read_b128 v[60:63], v9 offset:512
  v_mfma_f32_32x32x16_bf16 v[128:143], v[72:75], v[248:251], v[128:143]
  v_mfma_f32_32x32x16_bf16 v[128:143], v[76:79], v[252:255], v[128:143]
  s_waitcnt lgkmcnt(0)
  v_add_f32 v60, v60, v61
  v_add_f32 v62, v62, v63
  v_add_f32 v60, v60, v62
  v_cvt_pk_bf16_f32 v61, v60, v60
  v_lshlrev_b32 v61, 16, v61
  v_sub_f32 v62, v60, v61
  v_cvt_pk_bf16_f32 v48, v61, v62
  s_nop 1
  v_mfma_f32_32x32x8_bf16 v[128:143], v[48:49], v[46:47], v[128:143]
  s_xor_b32 s99, s96, 1
  s_lshl_b32 s99, s99, 12
  s_nop 9
  v_mul_f32 v128, v128, v112
  v_mul_f32 v129, v129, v113
  v_mul_f32 v130, v130, v114
  v_mul_f32 v131, v131, v115
  v_cvt_pk_bf16_f32 v112, v128, v129
  v_mul_f32 v132, v132, v116
  v_mul_f32 v133, v133, v117
  v_cvt_pk_bf16_f32 v113, v130, v131
  v_mul_f32 v134, v134, v118
  v_mul_f32 v135, v135, v119
  v_cvt_pk_bf16_f32 v114, v132, v133
  v_mul_f32 v136, v136, v120
  v_mul_f32 v137, v137, v121
  v_cvt_pk_bf16_f32 v115, v134, v135
  v_mul_f32 v138, v138, v122
  v_mul_f32 v139, v139, v123
  v_cvt_pk_bf16_f32 v116, v136, v137
  v_mul_f32 v140, v140, v124
  v_mul_f32 v141, v141, v125
  v_cvt_pk_bf16_f32 v117, v138, v139
  v_mul_f32 v142, v142, v126
  v_mul_f32 v143, v143, v127
  v_cvt_pk_bf16_f32 v118, v140, v141
  v_cvt_pk_bf16_f32 v119, v142, v143
  buffer_store_dwordx4 v[112:115], v11, s[36:39], s99 offen sc1
  buffer_store_dwordx4 v[116:119], v11, s[36:39], s99 offen offset:1024 sc1
  s_setprio 2
  s_waitcnt vmcnt(0)
  s_barrier
  v_add_u32 v17, s94, v7
  s_barrier
  s_add_u32 m0, s94, 90112
  s_add_u32 s89, s51, 114688
  buffer_load_dwordx4 v12, s[20:23], s89 offen lds
  buffer_load_dwordx4 v14, s[20:23], s89 offen offset:1024 lds
  s_add_u32 m0, s94, 98304
  s_nop 0
  buffer_load_dwordx4 v12, s[20:23], s52 offen lds
  buffer_load_dwordx4 v14, s[20:23], s52 offen offset:1024 lds
  s_add_u32 m0, s94, 106496
  s_add_u32 s89, s52, 114688
  buffer_load_dwordx4 v12, s[20:23], s89 offen lds
  buffer_load_dwordx4 v14, s[20:23], s89 offen offset:1024 lds
  s_add_u32 m0, s94, 114688
  s_nop 0
  buffer_load_dwordx4 v12, s[20:23], s53 offen lds
  buffer_load_dwordx4 v14, s[20:23], s53 offen offset:1024 lds
  s_barrier
  s_add_u32 m0, s94, 122880
  s_add_u32 s89, s53, 114688
  buffer_load_dwordx4 v12, s[20:23], s89 offen lds
  buffer_load_dwordx4 v14, s[20:23], s89 offen offset:1024 lds
  s_add_u32 m0, s94, 131072
  s_nop 0
  buffer_load_dwordx4 v12, s[20:23], s54 offen lds
  buffer_load_dwordx4 v14, s[20:23], s54 offen offset:1024 lds
  s_barrier
  s_lshr_b32 s83, s76, 1
  s_lshl_b32 s83, s83, 9
  s_add_u32 s83, s83, 13312
  v_lshrrev_b32 v5, 2, v7
  v_min_u32 v5, 52, v5
  v_add_u32 v5, s83, v5
  buffer_load_dword v6, v5, s[36:39], 0 offen sc1
  s_add_u32 m0, s94, 139264
  s_add_u32 s89, s54, 114688
  buffer_load_dwordx4 v12, s[20:23], s89 offen lds
  buffer_load_dwordx4 v14, s[20:23], s89 offen offset:1024 lds
  s_add_u32 m0, s94, 147456
  s_nop 0
  buffer_load_dwordx4 v12, s[20:23], s55 offen lds
  buffer_load_dwordx4 v14, s[20:23], s55 offen offset:1024 lds
  s_waitcnt vmcnt(4)
  v_cmp_ne_u32 vcc, s80, v6
  s_mov_b32 s87, 262144
  s_nop 1
  s_cbranch_vccz L_poll_9_x
L_poll_9:
  buffer_load_dword v6, v5, s[36:39], 0 offen sc1
  s_sub_u32 s87, s87, 1
  s_cbranch_scc1 L_poll_9_y
  s_waitcnt vmcnt(0)
  v_cmp_ne_u32 vcc, s80, v6
  s_nop 4
  s_cbranch_vccnz L_poll_9
L_poll_9_y:
  s_waitcnt vmcnt(0)
  s_nop 4
L_poll_9_x:
  s_barrier
  s_add_u32 m0, s94, 0
  s_add_u32 s89, s55, 114688
  buffer_load_dwordx4 v12, s[20:23], s89 offen lds
  buffer_load_dwordx4 v14, s[20:23], s89 offen offset:1024 lds
  s_add_u32 m0, s94, 8192
  s_nop 0
  buffer_load_dwordx4 v12, s[20:23], s56 offen lds
  buffer_load_dwordx4 v14, s[20:23], s56 offen offset:1024 lds
  s_barrier
  s_add_u32 m0, s94, 16384
  s_add_u32 s89, s56, 114688
  buffer_load_dwordx4 v12, s[20:23], s89 offen lds
  buffer_load_dwordx4 v14, s[20:23], s89 offen offset:1024 lds
  s_add_u32 m0, s94, 24576
  s_nop 0
  buffer_load_dwordx4 v12, s[20:23], s57 offen lds
  buffer_load_dwordx4 v14, s[20:23], s57 offen offset:1024 lds
  s_barrier
  s_add_u32 m0, s94, 32768
  s_add_u32 s89, s57, 114688
  buffer_load_dwordx4 v12, s[20:23], s89 offen lds
  buffer_load_dwordx4 v14, s[20:23], s89 offen offset:1024 lds
  s_add_u32 m0, s94, 40960
  s_mul_i32 s89, s96, 57344
  s_sub_u32 s89, s89, 57344
  v_add_u32 v12, s89, v12
  v_add_u32 v14, s89, v14
  s_bfe_u32 s89, s98, 0x40000
  s_mul_i32 s89, s89, 100352
  buffer_load_dwordx4 v12, s[24:27], s89 offen lds
  buffer_load_dwordx4 v14, s[24:27], s89 offen offset:1024 lds
  s_barrier
  s_add_u32 m0, s94, 49152
  s_add_u32 s89, s89, 50176
  buffer_load_dwordx4 v12, s[24:27], s89 offen lds
  buffer_load_dwordx4 v14, s[24:27], s89 offen offset:1024 lds
  s_add_u32 m0, s94, 57344
  s_bfe_u32 s89, s98, 0x40004
  s_mul_i32 s89, s89, 100352
  buffer_load_dwordx4 v12, s[24:27], s89 offen lds
  buffer_load_dwordx4 v14, s[24:27], s89 offen offset:1024 lds
  s_barrier
  s_add_u32 m0, s94, 65536
  s_add_u32 s89, s89, 50176
  buffer_load_dwordx4 v12, s[24:27], s89 offen lds
  buffer_load_dwordx4 v14, s[24:27], s89 offen offset:1024 lds
  s_add_u32 m0, s94, 73728
  s_bfe_u32 s89, s98, 0x40008
  s_mul_i32 s89, s89, 100352
  buffer_load_dwordx4 v12, s[24:27], s89 offen lds
  buffer_load_dwordx4 v14, s[24:27], s89 offen offset:1024 lds
  s_barrier
  s_add_u32 m0, s94, 81920
  s_add_u32 s89, s89, 50176
  buffer_load_dwordx4 v12, s[24:27], s89 offen lds
  buffer_load_dwordx4 v14, s[24:27], s89 offen offset:1024 lds
  s_add_u32 m0, s94, 90112
  s_bfe_u32 s89, s98, 0x4000c
  s_mul_i32 s89, s89, 100352
  buffer_load_dwordx4 v12, s[24:27], s89 offen lds
  buffer_load_dwordx4 v14, s[24:27], s89 offen offset:1024 lds
  s_waitcnt vmcnt(26)
  s_barrier
  s_add_u32 m0, s94, 98304
  s_add_u32 s89, s89, 50176
  buffer_load_dwordx4 v12, s[24:27], s89 offen lds
  buffer_load_dwordx4 v14, s[24:27], s89 offen offset:1024 lds
  s_waitcnt vmcnt(24)
  s_barrier
  s_waitcnt vmcnt(20)
  s_barrier
  s_lshr_b32 s83, s76, 1
  s_lshl_b32 s83, s83, 7
  s_add_u32 s83, s83, 21504
  v_lshrrev_b32 v5, 2, v7
  v_min_u32 v5, 4, v5
  v_add_u32 v5, s83, v5
  buffer_load_dword v6, v5, s[36:39], 0 offen sc1
  s_waitcnt vmcnt(0)
  v_cmp_ne_u32 vcc, s80, v6
  s_mov_b32 s87, 262144
  s_nop 1
  s_cbranch_vccz L_poll_10_x
L_poll_10:
  buffer_load_dword v6, v5, s[36:39], 0 offen sc1
  s_sub_u32 s87, s87, 1
  s_cbranch_scc1 L_poll_10_y
  s_waitcnt vmcnt(0)
  v_cmp_ne_u32 vcc, s80, v6
  s_nop 4
  s_cbranch_vccnz L_poll_10
L_poll_10_y:
  s_waitcnt vmcnt(0)
  s_nop 4
L_poll_10_x:
  s_barrier
  s_barrier
  s_barrier
  s_lshl_b32 s82, s74, 13
  s_add_u32 s83, s82, 106496
  v_add_u32 v16, s83, v7
  s_xor_b32 s82, s82, 8192
  s_add_u32 s83, s82, 110592
  v_add_u32 v18, s83, v7
  ds_read_b128 v[80:83], v16 offset:0
  ds_read_b128 v[96:99], v18 offset:0
  ds_read_b128 v[84:87], v16 offset:1024
  ds_read_b128 v[100:103], v18 offset:1024
  ds_read_b128 v[88:91], v16 offset:2048
  ds_read_b128 v[104:107], v18 offset:2048
  ds_read_b128 v[92:95], v16 offset:3072
  ds_read_b128 v[108:111], v18 offset:3072
  s_waitcnt lgkmcnt(6)
  v_add_f32 v80, v80, v96
  v_mul_f32 v96, 0xbfb8aa3b, v80
  v_exp_f32 v96, v96
  v_add_f32 v81, v81, v97
  v_mul_f32 v97, 0xbfb8aa3b, v81
  v_exp_f32 v97, v97
  v_add_f32 v96, 1.0, v96
  v_rcp_f32 v96, v96
  v_add_f32 v82, v82, v98
  v_mul_f32 v98, 0xbfb8aa3b, v82
  v_exp_f32 v98, v98
  v_add_f32 v97, 1.0, v97
  v_rcp_f32 v97, v97
  v_mul_f32 v80, v80, v96
  v_add_f32 v83, v83, v99
  v_mul_f32 v99, 0xbfb8aa3b, v83
  v_exp_f32 v99, v99
  v_add_f32 v98, 1.0, v98
  v_rcp_f32 v98, v98
  v_mul_f32 v81, v81, v97
  s_waitcnt lgkmcnt(4)
  v_add_f32 v84, v84, v100
  v_mul_f32 v100, 0xbfb8aa3b, v84
  v_exp_f32 v100, v100
  v_add_f32 v99, 1.0, v99
  v_rcp_f32 v99, v99
  v_mul_f32 v82, v82, v98
  v_add_f32 v85, v85, v101
  v_mul_f32 v101, 0xbfb8aa3b, v85
  v_exp_f32 v101, v101
  v_add_f32 v100, 1.0, v100
  v_rcp_f32 v100, v100
  v_mul_f32 v83, v83, v99
  ds_write_b128 v16, v[80:83] offset:0
  v_add_f32 v86, v86, v102
  v_mul_f32 v102, 0xbfb8aa3b, v86
  v_exp_f32 v102, v102
  v_add_f32 v101, 1.0, v101
  v_rcp_f32 v101, v101
  v_mul_f32 v84, v84, v100
  v_add_f32 v87, v87, v103
  v_mul_f32 v103, 0xbfb8aa3b, v87
  v_exp_f32 v103, v103
  v_add_f32 v102, 1.0, v102
  v_rcp_f32 v102, v102
  v_mul_f32 v85, v85, v101
  s_waitcnt lgkmcnt(3)
  v_add_f32 v88, v88, v104
  v_mul_f32 v104, 0xbfb8aa3b, v88
  v_exp_f32 v104, v104
  v_add_f32 v103, 1.0, v103
  v_rcp_f32 v103, v103
  v_mul_f32 v86, v86, v102
  v_add_f32 v89, v89, v105
  v_mul_f32 v105, 0xbfb8aa3b, v89
  v_exp_f32 v105, v105
  v_add_f32 v104, 1.0, v104
  v_rcp_f32 v104, v104
  v_mul_f32 v87, v87, v103
  ds_write_b128 v16, v[84:87] offset:1024
  v_add_f32 v90, v90, v106
  v_mul_f32 v106, 0xbfb8aa3b, v90
  v_exp_f32 v106, v106
  v_add_f32 v105, 1.0, v105
  v_rcp_f32 v105, v105
  v_mul_f32 v88, v88, v104
  v_add_f32 v91, v91, v107
  v_mul_f32 v107, 0xbfb8aa3b, v91
  v_exp_f32 v107, v107
  v_add_f32 v106, 1.0, v106
  v_rcp_f32 v106, v106
  v_mul_f32 v89, v89, v105
  s_waitcnt lgkmcnt(2)
  v_add_f32 v92, v92, v108
  v_mul_f32 v108, 0xbfb8aa3b, v92
  v_exp_f32 v108, v108
  v_add_f32 v107, 1.0, v107
  v_rcp_f32 v107, v107
  v_mul_f32 v90, v90, v106
  v_add_f32 v93, v93, v109
  v_mul_f32 v109, 0xbfb8aa3b, v93
  v_exp_f32 v109, v109
  v_add_f32 v108, 1.0, v108
  v_rcp_f32 v108, v108
  v_mul_f32 v91, v91, v107
  ds_write_b128 v16, v[88:91] offset:2048
  v_add_f32 v94, v94, v110
  v_mul_f32 v110, 0xbfb8aa3b, v94
  v_exp_f32 v110, v110
  v_add_f32 v109, 1.0, v109
  v_rcp_f32 v109, v109
  v_mul_f32 v92, v92, v108
  v_add_f32 v95, v95, v111
  v_mul_f32 v111, 0xbfb8aa3b, v95
  v_exp_f32 v111, v111
  v_add_f32 v110, 1.0, v110
  v_rcp_f32 v110, v110
  v_mul_f32 v93, v93, v109
  v_add_f32 v111, 1.0, v111
  v_rcp_f32 v111, v111
  v_mul_f32 v94, v94, v110
  v_mul_f32 v95, v95, v111
  ds_write_b128 v16, v[92:95] offset:3072
  s_waitcnt lgkmcnt(0)
  s_barrier
  s_endpgm
L_p2:
  s_and_b32 s82, s2, 7
  s_lshr_b32 s83, s2, 3
  s_and_b32 s84, s82, 3
  s_lshl_b32 s84, s84, 2
  s_add_u32 s84, s84, s83
  s_sub_u32 s84, s84, 28
  s_lshr_b32 s79, s84, 3
  s_and_b32 s84, s84, 7
  s_lshr_b32 s70, s82, 2
  s_lshl_b32 s70, s70, 3
  s_add_u32 s70, s70, s84
  s_add_u32 s71, s79, 14
  s_mov_b32 s96, 0x76543210
  s_mov_b32 s97, 0xfedcba98
  s_lshl_b32 s82, s71, 2
  s_lshr_b64 s[96:97], s[96:97], s82
  s_and_b32 s72, s96, 15
  s_and_b32 s82, s71, 1
  s_mul_i32 s82, s82, 4
  s_and_b32 s84, s84, 7
  s_mul_i32 s84, s84, 1
  s_add_u32 s82, s82, s84
  s_mov_b32 s96, 0
  s_mul_i32 s85, s82, 37
  s_lshr_b32 s85, s85, 8
  s_mul_i32 s85, s85, 7
  s_sub_u32 s82, s82, s85
  s_mov_b32 s84, 0x06543210
  s_mov_b32 s85, 0x00654321
  s_lshl_b32 s82, s82, 2
  s_lshr_b64 s[84:85], s[84:85], s82
  s_mov_b32 s95, s84
  s_and_b32 s74, s73, 3
  s_lshr_b32 s75, s73, 2
  s_lshl_b32 s3, s74, 10
  s_lshl_b32 s94, s74, 11
  v_lshrrev_b32 v1, 3, v0
  v_and_b32 v2, 7, v0
  v_lshrrev_b32 v4, 1, v1
  v_xor_b32 v4, v4, v2
  s_lshl_b32 s83, s70, 3
  s_add_u32 s83, s83, s74
  s_lshl_b32 s83, s83, 4
  v_add_u32 v5, s83, v1
  v_mul_u32_u24 v5, 896, v5
  v_lshl_add_u32 v15, v4, 4, v5
  v_xor_b32 v4, 4, v4
  v_lshl_add_u32 v24, v4, 4, v5
  v_add_u32 v24, 6144, v24
  v_lshrrev_b32 v4, 2, v0
  s_lshl_b32 s82, s74, 4
  v_add_u32 v4, s82, v4
  v_mul_u32_u24 v4, 2688, v4
  s_mul_i32 s82, s72, 56
  s_and_b32 s99, s82, 8
  s_and_b32 s82, s82, 0xfff0
  s_add_u32 s82, s82, 896
  v_and_b32 v5, 3, v0
  v_lshlrev_b32 v5, 4, v5
  v_add3_u32 v14, v4, v5, s82
  s_mov_b32 s6, 1835008
  s_mov_b32 s7, 0x20000
  s_mov_b32 s10, 1204224
  s_mov_b32 s11, 0x20000
  s_mov_b32 s30, 25088
  s_mov_b32 s31, 0x20000
  s_mov_b32 s26, 401408
  s_mov_b32 s27, 0x20000
  s_mov_b32 s14, 1605632
  s_mov_b32 s15, 0x20000
  s_mov_b32 s18, 1605632
  s_mov_b32 s19, 0x20000
  s_mov_b32 s22, 1605632
  s_mov_b32 s23, 0x20000
  s_mov_b32 s34, 1835008
  s_mov_b32 s35, 0x20000
  s_mov_b32 s42, 256
  s_mov_b32 s43, 0x20000
  s_mov_b32 s38, 20971520
  s_mov_b32 s39, 0x20000
  s_waitcnt lgkmcnt(0)
  s_mov_b64 s[4:5], s[48:49]
  s_mov_b64 s[8:9], s[50:51]
  s_bfe_u32 s86, s95, 0x40000
  s_add_u32 m0, s94, 0
  s_lshl_b32 s86, s86, 7
  buffer_load_dwordx4 v15, s[4:7], s86 offen lds
  buffer_load_dwordx4 v24, s[4:7], s86 offen offset:1024 lds
  s_add_u32 m0, s94, 8192
  s_add_u32 s86, s86, 57344
  buffer_load_dwordx4 v15, s[4:7], s86 offen lds
  buffer_load_dwordx4 v24, s[4:7], s86 offen offset:1024 lds
  s_bfe_u32 s86, s95, 0x40000
  s_add_u32 m0, s3, 16384
  s_mul_i32 s86, s86, 172032
  buffer_load_dwordx4 v14, s[8:11], s86 offen lds
  s_add_u32 m0, s3, 19584
  s_nop 0
  buffer_load_dwordx4 v14, s[8:11], s86 offen offset:896 lds
  v_lshrrev_b32 v1, 4, v0
  v_and_b32 v2, 15, v0
  v_lshrrev_b32 v3, 5, v0
  v_and_b32 v4, 31, v0
  s_lshl_b32 s82, s75, 1
  s_add_u32 s82, s82, s74
  v_and_b32 v52, 1, v1
  v_lshlrev_b32 v5, 5, v52
  v_and_b32 v6, 3, v2
  v_lshl_add_u32 v5, v6, 3, v5
  v_cmp_eq_u32 vcc, v52, v2
  v_lshrrev_b32 v6, 2, v2
  v_lshl_add_u32 v6, v3, 3, v6
  v_mov_b32 v1, 0x3f803f80
  v_min_u32 v26, 48, v5
  v_lshl_add_u32 v26, v6, 6, v26
  s_lshl_b32 s83, s75, 12
  s_add_u32 s83, s83, s99
  v_add_u32 v26, s83, v26
  v_cndmask_b32 v52, 0, v1, vcc
  s_lshl_b32 s83, s74, 5
  v_add_u32 v4, s83, v4
  v_bfe_u32 v6, v4, 1, 3
  v_xor_b32 v6, v6, v3
  v_lshlrev_b32 v6, 4, v6
  v_lshl_add_u32 v6, v4, 7, v6
  s_add_u32 s83, s82, 0
  s_and_b32 s83, s83, 3
  s_lshl_b32 s84, s83, 5
  v_xor_b32 v20, s84, v6
  v_lshl_add_u32 v16, s83, 10, v26
  s_add_u32 s83, s82, 1
  s_and_b32 s83, s83, 3
  s_lshl_b32 s84, s83, 5
  v_xor_b32 v21, s84, v6
  v_lshl_add_u32 v17, s83, 10, v26
  s_add_u32 s83, s82, 2
  s_and_b32 s83, s83, 3
  s_lshl_b32 s84, s83, 5
  v_xor_b32 v22, s84, v6
  v_lshl_add_u32 v18, s83, 10, v26
  s_add_u32 s83, s82, 3
  s_and_b32 s83, s83, 3
  s_lshl_b32 s84, s83, 5
  v_xor_b32 v23, s84, v6
  v_lshl_add_u32 v19, s83, 10, v26
  v_mov_b32 v53, v52
  v_mov_b32 v54, v52
  v_mov_b32 v55, v52
  v_mov_b32 v1, 0
  v_mov_b32 v2, 0
  v_mov_b32 v3, 0
  v_mov_b32 v4, 0
  s_mov_b64 s[28:29], s[52:53]
  s_mov_b64 s[24:25], s[54:55]
  s_mov_b64 s[12:13], s[58:59]
  s_mov_b64 s[16:17], s[60:61]
  s_mov_b64 s[20:21], s[62:63]
  s_mov_b64 s[32:33], s[64:65]
  s_mov_b64 s[40:41], s[66:67]
  s_mov_b64 s[36:37], s[68:69]
  s_bfe_u32 s86, s95, 0x40004
  s_add_u32 m0, s94, 24576
  s_lshl_b32 s86, s86, 7
  buffer_load_dwordx4 v15, s[4:7], s86 offen lds
  buffer_load_dwordx4 v24, s[4:7], s86 offen offset:1024 lds
  s_add_u32 m0, s94, 32768
  s_add_u32 s86, s86, 57344
  buffer_load_dwordx4 v15, s[4:7], s86 offen lds
  buffer_load_dwordx4 v24, s[4:7], s86 offen offset:1024 lds
  s_bfe_u32 s86, s95, 0x40004
  s_add_u32 m0, s3, 40960
  s_mul_i32 s86, s86, 172032
  buffer_load_dwordx4 v14, s[8:11], s86 offen lds
  s_add_u32 m0, s3, 44160
  s_nop 0
  buffer_load_dwordx4 v14, s[8:11], s86 offen offset:896 lds
  v_bfe_u32 v65, v7, 4, 4
  v_bfe_u32 v66, v7, 9, 1
  v_bfe_u32 v67, v7, 4, 5
  v_bfe_u32 v68, v7, 8, 1
  v_lshlrev_b32 v68, 5, v68
  v_and_b32 v70, 3, v65
  v_lshl_add_u32 v68, v70, 3, v68
  s_lshl_b32 s83, s74, 5
  v_add_u32 v69, s83, v67
  s_lshl_b32 s78, s70, 1
  s_add_u32 s78, s78, s79
  v_min_u32 v70, 48, v68
  v_add_u32 v70, 0, v70
  v_and_b32 v71, 8, v65
  v_lshlrev_b32 v71, 3, v71
  v_xor_b32 v70, v70, v71
  v_lshrrev_b32 v72, 2, v65
  v_lshl_add_u32 v64, v66, 3, v72
  v_lshl_add_u32 v70, v64, 7, v70
  s_add_u32 s83, s74, 0
  s_and_b32 s83, s83, 3
  v_lshl_add_u32 v28, s83, 11, v70
  s_add_u32 s83, s74, 1
  s_and_b32 s83, s83, 3
  v_lshl_add_u32 v29, s83, 11, v70
  s_add_u32 s83, s74, 2
  s_and_b32 s83, s83, 3
  v_lshl_add_u32 v30, s83, 11, v70
  s_add_u32 s83, s74, 3
  s_and_b32 s83, s83, 3
  v_lshl_add_u32 v31, s83, 11, v70
  s_lshl_b32 s84, s74, 2
  s_add_u32 s84, s84, 155648
  v_add_u32 v70, s84, v7
  v_mov_b32 v10, 161792
  v_cmp_gt_u32 vcc, 256, v7
  v_lshlrev_b32 v9, 4, v67
  v_add_u32 v9, 155648, v9
  v_cndmask_b32 v10, v10, v70, vcc
  v_cmp_eq_u32 vcc, 0, v66
  v_mov_b32 v70, 1.0
  v_mov_b32 v49, 0
  v_cndmask_b32 v32, 0, v70, vcc
  v_mov_b32 v47, 0
  s_mov_b32 s100, -1
  s_mov_b32 s101, 0
  s_lshl_b32 s83, s70, 2
  s_add_u32 s83, s83, s74
  s_mul_i32 s83, s83, 144
  s_lshl_b32 s84, s79, 4
  s_add_u32 s83, s83, s84
  s_add_u32 s83, s83, 112
  s_lshl_b32 s83, s83, 10
  s_add_u32 s83, s83, 3145728
  v_add_u32 v11, s83, v7
  v_bfe_u32 v70, v67, 2, 1
  v_bfe_u32 v71, v67, 3, 1
  v_lshl_or_b32 v70, v71, 2, v70
  v_and_b32 v71, 2, v67
  v_or_b32 v70, v70, v71
  v_lshlrev_b32 v70, 4, v70
  v_lshl_add_u32 v70, v69, 7, v70
  v_lshl_add_u32 v70, v66, 3, v70
  v_add_u32 v8, 131072, v70
  s_waitcnt vmcnt(6)
  s_barrier
  ds_read_b128 v[144:147], v20 offset:0
  ds_read_b64_tr_b16 v[96:97], v16 offset:16384
  ds_read_b64_tr_b16 v[98:99], v16 offset:16640
  ds_read_b128 v[148:151], v21 offset:0
  ds_read_b64_tr_b16 v[100:101], v17 offset:16384
  ds_read_b64_tr_b16 v[102:103], v17 offset:16640
  ds_read_b128 v[152:155], v22 offset:0
  ds_read_b64_tr_b16 v[104:105], v18 offset:16384
  ds_read_b64_tr_b16 v[106:107], v18 offset:16640
  ds_read_b128 v[156:159], v23 offset:0
  ds_read_b64_tr_b16 v[108:109], v19 offset:16384
  ds_read_b64_tr_b16 v[110:111], v19 offset:16640
  s_waitcnt vmcnt(0) lgkmcnt(0)
  s_barrier
  v_mfma_f32_16x16x32_bf16 v[56:59], v[52:55], v[96:99], 0
  v_mfma_f32_32x32x16_bf16 v[112:127], v[96:99], v[144:147], 0
  ds_read_b128 v[160:163], v20 offset:24576
  ds_read_b64_tr_b16 v[80:81], v16 offset:40960
  ds_read_b64_tr_b16 v[82:83], v16 offset:41216
  v_mfma_f32_32x32x16_bf16 v[112:127], v[100:103], v[148:151], v[112:127]
  ds_read_b128 v[164:167], v21 offset:24576
  ds_read_b64_tr_b16 v[84:85], v17 offset:40960
  ds_read_b64_tr_b16 v[86:87], v17 offset:41216
  v_mfma_f32_32x32x16_bf16 v[112:127], v[104:107], v[152:155], v[112:127]
  ds_read_b128 v[168:171], v22 offset:24576
  ds_read_b64_tr_b16 v[88:89], v18 offset:40960
  ds_read_b64_tr_b16 v[90:91], v18 offset:41216
  v_mfma_f32_32x32x16_bf16 v[112:127], v[108:111], v[156:159], v[112:127]
  ds_read_b128 v[172:175], v23 offset:24576
  ds_read_b64_tr_b16 v[92:93], v19 offset:40960
  ds_read_b64_tr_b16 v[94:95], v19 offset:41216
  v_dot2c_f32_bf16 v1, 0x3f803f80, v144
  v_dot2c_f32_bf16 v3, v144, v144
  v_dot2c_f32_bf16 v2, 0x3f803f80, v145
  v_dot2c_f32_bf16 v4, v145, v145
  v_dot2c_f32_bf16 v1, 0x3f803f80, v146
  v_dot2c_f32_bf16 v3, v146, v146
  v_dot2c_f32_bf16 v2, 0x3f803f80, v147
  v_dot2c_f32_bf16 v4, v147, v147
  v_dot2c_f32_bf16 v1, 0x3f803f80, v148
  v_dot2c_f32_bf16 v3, v148, v148
  v_dot2c_f32_bf16 v2, 0x3f803f80, v149
  v_dot2c_f32_bf16 v4, v149, v149
  v_dot2c_f32_bf16 v1, 0x3f803f80, v150
  v_dot2c_f32_bf16 v3, v150, v150
  v_dot2c_f32_bf16 v2, 0x3f803f80, v151
  v_dot2c_f32_bf16 v4, v151, v151
  s_waitcnt lgkmcnt(0)
  s_barrier
  v_mfma_f32_16x16x32_bf16 v[56:59], v[52:55], v[80:83], v[56:59]
  v_mfma_f32_32x32x16_bf16 v[112:127], v[80:83], v[160:163], v[112:127]
  v_add_u32 v16, 0x10000, v16
  v_add_u32 v17, 0x10000, v17
  v_add_u32 v18, 0x10000, v18
  v_add_u32 v19, 0x10000, v19
  ds_read_b128 v[176:179], v20 offset:49152
  ds_read_b64_tr_b16 v[96:97], v16 offset:0
  ds_read_b64_tr_b16 v[98:99], v16 offset:256
  s_bfe_u32 s86, s95, 0x40010
  s_add_u32 m0, s94, 24576
  s_lshl_b32 s86, s86, 7
  buffer_load_dwordx4 v15, s[4:7], s86 offen lds
  buffer_load_dwordx4 v24, s[4:7], s86 offen offset:1024 lds
  v_mfma_f32_32x32x16_bf16 v[112:127], v[84:87], v[164:167], v[112:127]
  ds_read_b128 v[180:183], v21 offset:49152
  ds_read_b64_tr_b16 v[100:101], v17 offset:0
  ds_read_b64_tr_b16 v[102:103], v17 offset:256
  s_add_u32 m0, s94, 32768
  s_add_u32 s86, s86, 57344
  buffer_load_dwordx4 v15, s[4:7], s86 offen lds
  buffer_load_dwordx4 v24, s[4:7], s86 offen offset:1024 lds
  v_mfma_f32_32x32x16_bf16 v[112:127], v[88:91], v[168:171], v[112:127]
  ds_read_b128 v[184:187], v22 offset:49152
  ds_read_b64_tr_b16 v[104:105], v18 offset:0
  ds_read_b64_tr_b16 v[106:107], v18 offset:256
  s_bfe_u32 s86, s95, 0x40010
  s_add_u32 m0, s3, 40960
  s_mul_i32 s86, s86, 172032
  buffer_load_dwordx4 v14, s[8:11], s86 offen lds
  s_add_u32 m0, s3, 44160
  s_nop 0
  buffer_load_dwordx4 v14, s[8:11], s86 offen offset:896 lds
  v_mfma_f32_32x32x16_bf16 v[112:127], v[92:95], v[172:175], v[112:127]
  ds_read_b128 v[188:191], v23 offset:49152
  ds_read_b64_tr_b16 v[108:109], v19 offset:0
  ds_read_b64_tr_b16 v[110:111], v19 offset:256
  s_mul_i32 s82, s72, 1568
  s_lshl_b32 s83, s73, 8
  s_add_u32 s82, s82, s83
  s_add_u32 m0, s83, 159744
  v_lshrrev_b32 v74, 2, v7
  buffer_load_dword v74, s[28:31], s82 offen lds
  v_dot2c_f32_bf16 v1, 0x3f803f80, v160
  v_dot2c_f32_bf16 v3, v160, v160
  v_dot2c_f32_bf16 v2, 0x3f803f80, v161
  v_dot2c_f32_bf16 v4, v161, v161
  v_dot2c_f32_bf16 v1, 0x3f803f80, v162
  v_dot2c_f32_bf16 v3, v162, v162
  v_dot2c_f32_bf16 v2, 0x3f803f80, v163
  v_dot2c_f32_bf16 v4, v163, v163
  v_dot2c_f32_bf16 v1, 0x3f803f80, v164
  v_dot2c_f32_bf16 v3, v164, v164
  v_dot2c_f32_bf16 v2, 0x3f803f80, v165
  v_dot2c_f32_bf16 v4, v165, v165
  v_dot2c_f32_bf16 v1, 0x3f803f80, v166
  v_dot2c_f32_bf16 v3, v166, v166
  v_dot2c_f32_bf16 v2, 0x3f803f80, v167
  v_dot2c_f32_bf16 v4, v167, v167
  s_waitcnt lgkmcnt(0)
  s_barrier
  v_mfma_f32_16x16x32_bf16 v[56:59], v[52:55], v[96:99], v[56:59]
  v_mfma_f32_32x32x16_bf16 v[112:127], v[96:99], v[176:179], v[112:127]
  v_add_u32 v16, 0xffff4000, v16
  v_add_u32 v17, 0xffff4000, v17
  v_add_u32 v18, 0xffff4000, v18
  v_add_u32 v19, 0xffff4000, v19
  ds_read_b128 v[192:195], v20 offset:0
  ds_read_b64_tr_b16 v[80:81], v16 offset:0
  ds_read_b64_tr_b16 v[82:83], v16 offset:256
  v_mfma_f32_32x32x16_bf16 v[112:127], v[100:103], v[180:183], v[112:127]
  ds_read_b128 v[196:199], v21 offset:0
  ds_read_b64_tr_b16 v[84:85], v17 offset:0
  ds_read_b64_tr_b16 v[86:87], v17 offset:256
  v_mfma_f32_32x32x16_bf16 v[112:127], v[104:107], v[184:187], v[112:127]
  ds_read_b128 v[200:203], v22 offset:0
  ds_read_b64_tr_b16 v[88:89], v18 offset:0
  ds_read_b64_tr_b16 v[90:91], v18 offset:256
  v_mfma_f32_32x32x16_bf16 v[112:127], v[108:111], v[188:191], v[112:127]
  ds_read_b128 v[204:207], v23 offset:0
  ds_read_b64_tr_b16 v[92:93], v19 offset:0
  ds_read_b64_tr_b16 v[94:95], v19 offset:256
  v_dot2c_f32_bf16 v1, 0x3f803f80, v176
  v_dot2c_f32_bf16 v3, v176, v176
  v_dot2c_f32_bf16 v2, 0x3f803f80, v177
  v_dot2c_f32_bf16 v4, v177, v177
  v_dot2c_f32_bf16 v1, 0x3f803f80, v178
  v_dot2c_f32_bf16 v3, v178, v178
  v_dot2c_f32_bf16 v2, 0x3f803f80, v179
  v_dot2c_f32_bf16 v4, v179, v179
  v_dot2c_f32_bf16 v1, 0x3f803f80, v180
  v_dot2c_f32_bf16 v3, v180, v180
  v_dot2c_f32_bf16 v2, 0x3f803f80, v181
  v_dot2c_f32_bf16 v4, v181, v181
  v_dot2c_f32_bf16 v1, 0x3f803f80, v182
  v_dot2c_f32_bf16 v3, v182, v182
  v_dot2c_f32_bf16 v2, 0x3f803f80, v183
  v_dot2c_f32_bf16 v4, v183, v183
  s_waitcnt vmcnt(1) lgkmcnt(0)
  s_barrier
  v_mfma_f32_16x16x32_bf16 v[56:59], v[52:55], v[80:83], v[56:59]
  v_mfma_f32_32x32x16_bf16 v[112:127], v[80:83], v[192:195], v[112:127]
  ds_read_b128 v[208:211], v20 offset:24576
  ds_read_b64_tr_b16 v[96:97], v16 offset:24576
  ds_read_b64_tr_b16 v[98:99], v16 offset:24832
  s_bfe_u32 s86, s95, 0x40018
  s_add_u32 m0, s94, 0
  s_lshl_b32 s86, s86, 7
  buffer_load_dwordx4 v15, s[4:7], s86 offen lds
  buffer_load_dwordx4 v24, s[4:7], s86 offen offset:1024 lds
  v_mfma_f32_32x32x16_bf16 v[112:127], v[84:87], v[196:199], v[112:127]
  ds_read_b128 v[212:215], v21 offset:24576
  ds_read_b64_tr_b16 v[100:101], v17 offset:24576
  ds_read_b64_tr_b16 v[102:103], v17 offset:24832
  s_add_u32 m0, s94, 8192
  s_add_u32 s86, s86, 57344
  buffer_load_dwordx4 v15, s[4:7], s86 offen lds
  buffer_load_dwordx4 v24, s[4:7], s86 offen offset:1024 lds
  v_mfma_f32_32x32x16_bf16 v[112:127], v[88:91], v[200:203], v[112:127]
  ds_read_b128 v[216:219], v22 offset:24576
  ds_read_b64_tr_b16 v[104:105], v18 offset:24576
  ds_read_b64_tr_b16 v[106:107], v18 offset:24832
  s_bfe_u32 s86, s95, 0x40018
  s_add_u32 m0, s3, 16384
  s_mul_i32 s86, s86, 172032
  buffer_load_dwordx4 v14, s[8:11], s86 offen lds
  s_add_u32 m0, s3, 19584
  s_nop 0
  buffer_load_dwordx4 v14, s[8:11], s86 offen offset:896 lds
  v_mfma_f32_32x32x16_bf16 v[112:127], v[92:95], v[204:207], v[112:127]
  ds_read_b128 v[220:223], v23 offset:24576
  ds_read_b64_tr_b16 v[108:109], v19 offset:24576
  ds_read_b64_tr_b16 v[110:111], v19 offset:24832
  v_mov_b32 v5, 0
  buffer_load_dword v6, v5, s[40:43], 0 offen sc1
  v_dot2c_f32_bf16 v1, 0x3f803f80, v192
  v_dot2c_f32_bf16 v3, v192, v192
  v_dot2c_f32_bf16 v2, 0x3f803f80, v193
  v_dot2c_f32_bf16 v4, v193, v193
  v_dot2c_f32_bf16 v1, 0x3f803f80, v194
  v_dot2c_f32_bf16 v3, v194, v194
  v_dot2c_f32_bf16 v2, 0x3f803f80, v195
  v_dot2c_f32_bf16 v4, v195, v195
  v_dot2c_f32_bf16 v1, 0x3f803f80, v196
  v_dot2c_f32_bf16 v3, v196, v196
  v_dot2c_f32_bf16 v2, 0x3f803f80, v197
  v_dot2c_f32_bf16 v4, v197, v197
  v_dot2c_f32_bf16 v1, 0x3f803f80, v198
  v_dot2c_f32_bf16 v3, v198, v198
  v_dot2c_f32_bf16 v2, 0x3f803f80, v199
  v_dot2c_f32_bf16 v4, v199, v199
  s_waitcnt vmcnt(7) lgkmcnt(0)
  s_barrier
  v_mfma_f32_16x16x32_bf16 v[56:59], v[52:55], v[96:99], v[56:59]
  v_mfma_f32_32x32x16_bf16 v[112:127], v[96:99], v[208:211], v[112:127]
  ds_read_b128 v[224:227], v20 offset:49152
  ds_read_b64_tr_b16 v[80:81], v16 offset:49152
  ds_read_b64_tr_b16 v[82:83], v16 offset:49408
  v_mfma_f32_32x32x16_bf16 v[112:127], v[100:103], v[212:215], v[112:127]
  ds_read_b128 v[228:231], v21 offset:49152
  ds_read_b64_tr_b16 v[84:85], v17 offset:49152
  ds_read_b64_tr_b16 v[86:87], v17 offset:49408
  v_mfma_f32_32x32x16_bf16 v[112:127], v[104:107], v[216:219], v[112:127]
  ds_read_b128 v[232:235], v22 offset:49152
  ds_read_b64_tr_b16 v[88:89], v18 offset:49152
  ds_read_b64_tr_b16 v[90:91], v18 offset:49408
  v_mfma_f32_32x32x16_bf16 v[112:127], v[108:111], v[220:223], v[112:127]
  ds_read_b128 v[236:239], v23 offset:49152
  ds_read_b64_tr_b16 v[92:93], v19 offset:49152
  ds_read_b64_tr_b16 v[94:95], v19 offset:49408
  v_bfe_u32 v25, v7, 9, 1
  v_bfe_u32 v26, v7, 6, 2
  v_lshl_add_u32 v25, v25, 2, v26
  v_mul_u32_u24 v25, 56, v25
  v_bfe_u32 v26, v7, 8, 1
  v_lshlrev_b32 v26, 5, v26
  v_bfe_u32 v27, v7, 4, 2
  v_lshl_add_u32 v26, v27, 3, v26
  v_min_u32 v26, 48, v26
  v_add_u32 v25, v25, v26
  v_add_u32 v25, 159744, v25
  ds_read_b64_tr_b16 v[38:39], v25 offset:0
  ds_read_b64_tr_b16 v[40:41], v25 offset:448
  ds_read_b64_tr_b16 v[42:43], v25 offset:896
  ds_read_b64_tr_b16 v[44:45], v25 offset:1344
  v_dot2c_f32_bf16 v1, 0x3f803f80, v208
  v_dot2c_f32_bf16 v3, v208, v208
  v_dot2c_f32_bf16 v2, 0x3f803f80, v209
  v_dot2c_f32_bf16 v4, v209, v209
  v_dot2c_f32_bf16 v1, 0x3f803f80, v210
  v_dot2c_f32_bf16 v3, v210, v210
  v_dot2c_f32_bf16 v2, 0x3f803f80, v211
  v_dot2c_f32_bf16 v4, v211, v211
  v_dot2c_f32_bf16 v1, 0x3f803f80, v212
  v_dot2c_f32_bf16 v3, v212, v212
  v_dot2c_f32_bf16 v2, 0x3f803f80, v213
  v_dot2c_f32_bf16 v4, v213, v213
  v_dot2c_f32_bf16 v1, 0x3f803f80, v214
  v_dot2c_f32_bf16 v3, v214, v214
  v_dot2c_f32_bf16 v2, 0x3f803f80, v215
  v_dot2c_f32_bf16 v4, v215, v215
  s_waitcnt vmcnt(1) lgkmcnt(0)
  s_barrier
  v_mfma_f32_16x16x32_bf16 v[56:59], v[52:55], v[80:83], v[56:59]
  v_mfma_f32_32x32x16_bf16 v[112:127], v[80:83], v[224:227], v[112:127]
  ds_read_b128 v[240:243], v20 offset:0
  ds_read_b64_tr_b16 v[96:97], v16 offset:0
  ds_read_b64_tr_b16 v[98:99], v16 offset:256
  v_mfma_f32_32x32x16_bf16 v[112:127], v[84:87], v[228:231], v[112:127]
  ds_read_b128 v[244:247], v21 offset:0
  ds_read_b64_tr_b16 v[100:101], v17 offset:0
  ds_read_b64_tr_b16 v[102:103], v17 offset:256
  v_mfma_f32_32x32x16_bf16 v[112:127], v[88:91], v[232:235], v[112:127]
  ds_read_b128 v[248:251], v22 offset:0
  ds_read_b64_tr_b16 v[104:105], v18 offset:0
  ds_read_b64_tr_b16 v[106:107], v18 offset:256
  v_mfma_f32_32x32x16_bf16 v[112:127], v[92:95], v[236:239], v[112:127]
  ds_read_b128 v[252:255], v23 offset:0
  ds_read_b64_tr_b16 v[108:109], v19 offset:0
  ds_read_b64_tr_b16 v[110:111], v19 offset:256
  v_cndmask_b32 v44, 0, v44, s[100:101]
  v_cndmask_b32 v45, 0, v45, s[100:101]
  s_cmp_lg_u32 s74, 0
  s_cbranch_scc1 L_warm_11_0
  v_lshrrev_b32 v64, 4, v7
  s_mul_i32 s82, s2, 49
  v_min_u32 v64, 48, v64
  v_add_u32 v64, s82, v64
  v_lshlrev_b32 v64, 7, v64
  buffer_load_dword v51, v64, s[20:23], 0 offen
L_warm_11_0:
  s_cmp_lg_u32 s74, 1
  s_cbranch_scc1 L_warm_11_1
  v_lshrrev_b32 v64, 4, v7
  s_mul_i32 s82, s2, 13
  v_min_u32 v64, 12, v64
  v_add_u32 v64, s82, v64
  v_lshlrev_b32 v64, 7, v64
  buffer_load_dword v51, v64, s[24:27], 0 offen
L_warm_11_1:
  v_dot2c_f32_bf16 v1, 0x3f803f80, v224
  v_dot2c_f32_bf16 v3, v224, v224
  v_dot2c_f32_bf16 v2, 0x3f803f80, v225
  v_dot2c_f32_bf16 v4, v225, v225
  v_dot2c_f32_bf16 v1, 0x3f803f80, v226
  v_dot2c_f32_bf16 v3, v226, v226
  v_dot2c_f32_bf16 v2, 0x3f803f80, v227
  v_dot2c_f32_bf16 v4, v227, v227
  v_dot2c_f32_bf16 v1, 0x3f803f80, v228
  v_dot2c_f32_bf16 v3, v228, v228
  v_dot2c_f32_bf16 v2, 0x3f803f80, v229
  v_dot2c_f32_bf16 v4, v229, v229
  v_dot2c_f32_bf16 v1, 0x3f803f80, v230
  v_dot2c_f32_bf16 v3, v230, v230
  v_dot2c_f32_bf16 v2, 0x3f803f80, v231
  v_dot2c_f32_bf16 v4, v231, v231
  s_waitcnt lgkmcnt(0)
  s_barrier
  v_dot2c_f32_bf16 v1, 0x3f803f80, v240
  v_dot2c_f32_bf16 v3, v240, v240
  v_dot2c_f32_bf16 v2, 0x3f803f80, v241
  v_dot2c_f32_bf16 v4, v241, v241
  v_dot2c_f32_bf16 v1, 0x3f803f80, v242
  v_dot2c_f32_bf16 v3, v242, v242
  v_dot2c_f32_bf16 v2, 0x3f803f80, v243
  v_dot2c_f32_bf16 v4, v243, v243
  v_dot2c_f32_bf16 v1, 0x3f803f80, v244
  v_dot2c_f32_bf16 v3, v244, v244
  v_dot2c_f32_bf16 v2, 0x3f803f80, v245
  v_dot2c_f32_bf16 v4, v245, v245
  v_dot2c_f32_bf16 v1, 0x3f803f80, v246
  v_dot2c_f32_bf16 v3, v246, v246
  v_dot2c_f32_bf16 v2, 0x3f803f80, v247
  v_dot2c_f32_bf16 v4, v247, v247
  v_mfma_f32_16x16x32_bf16 v[56:59], v[52:55], v[96:99], v[56:59]
  v_mfma_f32_32x32x16_bf16 v[112:127], v[96:99], v[240:243], v[112:127]
  ds_read_b64_tr_b16 v[64:65], v28 offset:24576
  ds_read_b64_tr_b16 v[66:67], v28 offset:25088
  v_mfma_f32_32x32x16_bf16 v[112:127], v[100:103], v[244:247], v[112:127]
  ds_read_b64_tr_b16 v[68:69], v29 offset:24576
  ds_read_b64_tr_b16 v[70:71], v29 offset:25088
  v_add_f32 v2, v1, v2
  v_add_f32 v3, v3, v4
  v_bfe_u32 v16, v7, 4, 5
  v_mov_b32 v1, v2
  v_mov_b32 v4, v3
  s_lshl_b32 s82, s74, 8
  s_add_u32 s82, s82, 157696
  v_lshl_add_u32 v15, v16, 3, s82
  v_mfma_f32_32x32x16_bf16 v[112:127], v[104:107], v[248:251], v[112:127]
  ds_read_b64_tr_b16 v[72:73], v30 offset:24576
  ds_read_b64_tr_b16 v[74:75], v30 offset:25088
  v_permlane32_swap_b32 v2, v1
  v_permlane32_swap_b32 v3, v4
  ds_write2_b32 v10, v56, v57 offset0:128 offset1:192
  v_add_f32 v2, v2, v1
  v_add_f32 v3, v3, v4
  ds_write_b64 v15, v[2:3] offset:0
  v_mfma_f32_32x32x16_bf16 v[112:127], v[108:111], v[252:255], v[112:127]
  s_waitcnt lgkmcnt(4)
  v_mfma_f32_16x16x32_bf16 v[56:59], v[52:55], v[64:67], 0
  v_mfma_f32_32x32x16_bf16 v[80:95], v[64:67], v[144:147], 0
  ds_read_b64_tr_b16 v[76:77], v31 offset:24576
  ds_read_b64_tr_b16 v[78:79], v31 offset:25088
  v_mfma_f32_32x32x16_bf16 v[80:95], v[68:71], v[148:151], v[80:95]
  ds_read_b64_tr_b16 v[64:65], v28 offset:32768
  ds_read_b64_tr_b16 v[66:67], v28 offset:33280
  s_waitcnt lgkmcnt(4)
  s_barrier
  s_waitcnt vmcnt(0)
  v_cmp_eq_u32 vcc, 0, v6
  s_mov_b32 s87, 262144
  s_nop 1
  s_cbranch_vccz L_nonce_12_x
L_nonce_12:
  buffer_load_dword v6, v5, s[40:43], 0 offen sc1
  s_sub_u32 s87, s87, 1
  s_cbranch_scc1 L_nonce_12_y
  s_waitcnt vmcnt(0)
  v_cmp_eq_u32 vcc, 0, v6
  s_nop 4
  s_cbranch_vccnz L_nonce_12
L_nonce_12_y:
  s_waitcnt vmcnt(0)
  s_nop 4
L_nonce_12_x:
  v_readfirstlane_b32 s80, v6
  ds_read_b64 v[16:17], v15 offset:1024
  ds_read_b128 v[60:63], v9 offset:512
  s_waitcnt lgkmcnt(4)
  v_mfma_f32_32x32x16_bf16 v[80:95], v[72:75], v[152:155], v[80:95]
  ds_read_b64_tr_b16 v[68:69], v29 offset:32768
  ds_read_b64_tr_b16 v[70:71], v29 offset:33280
  v_mfma_f32_32x32x16_bf16 v[80:95], v[76:79], v[156:159], v[80:95]
  ds_read_b64_tr_b16 v[72:73], v30 offset:32768
  ds_read_b64_tr_b16 v[74:75], v30 offset:33280
  s_waitcnt lgkmcnt(2)
  v_mfma_f32_16x16x32_bf16 v[56:59], v[52:55], v[64:67], v[56:59]
  v_mfma_f32_32x32x16_bf16 v[80:95], v[64:67], v[160:163], v[80:95]
  ds_read_b64_tr_b16 v[76:77], v31 offset:32768
  ds_read_b64_tr_b16 v[78:79], v31 offset:33280
  v_add_f32 v2, v2, v16
  v_add_f32 v3, v3, v17
  v_mul_f32 v2, 0x3b124925, v2
  v_mul_f32 v3, 0x3b124925, v3
  v_mul_f32_e64 v16, -v2, v32
  v_fma_f32 v3, -v2, v2, v3
  v_cvt_pk_bf16_f32 v46, v16, v16
  v_max_f32 v3, 0, v3
  v_add_f32 v60, v60, v61
  v_add_f32 v62, v62, v63
  v_add_f32 v60, v60, v62
  v_cvt_pk_bf16_f32 v61, v60, v60
  v_lshlrev_b32 v61, 16, v61
  s_barrier
  v_mfma_f32_32x32x16_bf16 v[80:95], v[68:71], v[164:167], v[80:95]
  ds_read_b64_tr_b16 v[64:65], v28 offset:40960
  ds_read_b64_tr_b16 v[66:67], v28 offset:41472
  v_sub_f32 v62, v60, v61
  v_cvt_pk_bf16_f32 v48, v61, v62
  v_cvt_pk_bf16_f32 v3, v3, v3
  v_lshlrev_b32 v3, 16, v3
  v_mfma_f32_32x32x8_bf16 v[112:127], v[48:49], v[46:47], v[112:127]
  v_add_f32 v3, 0x3727c5ac, v3
  v_cvt_pk_bf16_f32 v3, v3, v3
  s_waitcnt lgkmcnt(2)
  v_mfma_f32_32x32x16_bf16 v[80:95], v[72:75], v[168:171], v[80:95]
  ds_read_b64_tr_b16 v[68:69], v29 offset:40960
  ds_read_b64_tr_b16 v[70:71], v29 offset:41472
  v_lshlrev_b32 v3, 16, v3
  v_sqrt_f32 v3, v3
  s_nop 0
  v_cvt_pk_bf16_f32 v3, v3, v3
  v_lshlrev_b32 v3, 16, v3
  v_rcp_f32 v34, v3
  v_mul_f32 v35, v3, v3
  v_mfma_f32_32x32x16_bf16 v[80:95], v[76:79], v[172:175], v[80:95]
  ds_read_b64_tr_b16 v[72:73], v30 offset:40960
  ds_read_b64_tr_b16 v[74:75], v30 offset:41472
  v_mul_f32 v33, 0x3fb8aa3b, v34
  v_cvt_pk_bf16_f32 v16, v112, v113
  v_cvt_pk_bf16_f32 v17, v114, v115
  v_cvt_pk_bf16_f32 v18, v116, v117
  v_cvt_pk_bf16_f32 v19, v118, v119
  v_cvt_pk_bf16_f32 v20, v120, v121
  v_cvt_pk_bf16_f32 v21, v122, v123
  v_cvt_pk_bf16_f32 v22, v124, v125
  s_waitcnt lgkmcnt(2)
  v_mfma_f32_16x16x32_bf16 v[56:59], v[52:55], v[64:67], v[56:59]
  v_mfma_f32_32x32x16_bf16 v[80:95], v[64:67], v[176:179], v[80:95]
  ds_read_b64_tr_b16 v[76:77], v31 offset:40960
  ds_read_b64_tr_b16 v[78:79], v31 offset:41472
  v_cvt_pk_bf16_f32 v23, v126, v127
  v_mfma_f32_32x32x16_bf16 v[128:143], v[38:41], v[16:19], 0
  s_nop 0
  v_mfma_f32_32x32x16_bf16 v[128:143], v[42:45], v[20:23], v[128:143]
  v_mfma_f32_32x32x16_bf16 v[80:95], v[68:71], v[180:183], v[80:95]
  ds_read_b64_tr_b16 v[64:65], v28 offset:49152
  ds_read_b64_tr_b16 v[66:67], v28 offset:49664
  s_waitcnt lgkmcnt(2)
  v_mfma_f32_32x32x16_bf16 v[80:95], v[72:75], v[184:187], v[80:95]
  ds_read_b64_tr_b16 v[68:69], v29 offset:49152
  ds_read_b64_tr_b16 v[70:71], v29 offset:49664
  v_mfma_f32_32x32x16_bf16 v[80:95], v[76:79], v[188:191], v[80:95]
  ds_read_b64_tr_b16 v[72:73], v30 offset:49152
  ds_read_b64_tr_b16 v[74:75], v30 offset:49664
  s_waitcnt lgkmcnt(2)
  v_mfma_f32_16x16x32_bf16 v[56:59], v[52:55], v[64:67], v[56:59]
  v_mfma_f32_32x32x16_bf16 v[80:95], v[64:67], v[192:195], v[80:95]
  ds_read_b64_tr_b16 v[76:77], v31 offset:49152
  ds_read_b64_tr_b16 v[78:79], v31 offset:49664
  v_max3_f32 v1, v128, v129, v130
  v_min3_f32 v2, v128, v129, v130
  v_max3_f32 v1, v1, v131, v132
  v_min3_f32 v2, v2, v131, v132
  v_max3_f32 v1, v1, v133, v134
  v_min3_f32 v2, v2, v133, v134
  v_max3_f32 v1, v1, v135, v136
  v_min3_f32 v2, v2, v135, v136
  v_max3_f32 v1, v1, v137, v138
  v_min3_f32 v2, v2, v137, v138
  v_max3_f32 v1, v1, v139, v140
  v_min3_f32 v2, v2, v139, v140
  v_max3_f32 v1, v1, v141, v142
  v_min3_f32 v2, v2, v141, v142
  v_mfma_f32_32x32x16_bf16 v[80:95], v[68:71], v[196:199], v[80:95]
  ds_read_b64_tr_b16 v[64:65], v28 offset:57344
  ds_read_b64_tr_b16 v[66:67], v28 offset:57856
  v_max_f32 v3, v1, v143
  v_min_f32 v4, v2, v143
  v_mov_b32 v1, v3
  v_mov_b32 v2, v4
  s_nop 0
  v_permlane32_swap_b32 v1, v3
  v_permlane32_swap_b32 v2, v4
  v_max_f32 v1, v1, v3
  v_min_f32 v2, v2, v4
  v_mul_f32_e64 v1, -v1, v33
  s_waitcnt lgkmcnt(2)
  v_mfma_f32_32x32x16_bf16 v[80:95], v[72:75], v[200:203], v[80:95]
  ds_read_b64_tr_b16 v[68:69], v29 offset:57344
  ds_read_b64_tr_b16 v[70:71], v29 offset:57856
  v_mul_f32 v2, v2, v33
  v_fma_f32 v112, v128, v33, v1
  v_fma_f32 v128, -v128, v33, v2
  v_fma_f32 v113, v129, v33, v1
  v_fma_f32 v129, -v129, v33, v2
  v_exp_f32 v112, v112
  v_exp_f32 v128, v128
  v_mfma_f32_32x32x16_bf16 v[80:95], v[76:79], v[204:207], v[80:95]
  ds_read_b64_tr_b16 v[72:73], v30 offset:57344
  ds_read_b64_tr_b16 v[74:75], v30 offset:57856
  v_fma_f32 v114, v130, v33, v1
  v_fma_f32 v130, -v130, v33, v2
  v_exp_f32 v113, v113
  v_exp_f32 v129, v129
  v_fma_f32 v115, v131, v33, v1
  v_fma_f32 v131, -v131, v33, v2
  v_exp_f32 v114, v114
  s_waitcnt lgkmcnt(2)
  v_mfma_f32_16x16x32_bf16 v[56:59], v[52:55], v[64:67], v[56:59]
  v_mfma_f32_32x32x16_bf16 v[80:95], v[64:67], v[208:211], v[80:95]
  ds_read_b64_tr_b16 v[76:77], v31 offset:57344
  ds_read_b64_tr_b16 v[78:79], v31 offset:57856
  v_exp_f32 v130, v130
  v_add_f32 v16, v112, v113
  v_add_f32 v17, v128, v129
  v_fma_f32 v116, v132, v33, v1
  v_fma_f32 v132, -v132, v33, v2
  v_exp_f32 v115, v115
  v_exp_f32 v131, v131
  v_mfma_f32_32x32x16_bf16 v[80:95], v[68:71], v[212:215], v[80:95]
  v_add_u32 v28, 0x10000, v28
  v_add_u32 v29, 0x10000, v29
  v_add_u32 v30, 0x10000, v30
  v_add_u32 v31, 0x10000, v31
  ds_read_b64_tr_b16 v[64:65], v28 offset:0
  ds_read_b64_tr_b16 v[66:67], v28 offset:512
  v_add_f32 v16, v16, v114
  v_add_f32 v17, v17, v130
  v_fma_f32 v117, v133, v33, v1
  v_fma_f32 v133, -v133, v33, v2
  v_exp_f32 v116, v116
  v_exp_f32 v132, v132
  s_waitcnt lgkmcnt(2)
  v_mfma_f32_32x32x16_bf16 v[80:95], v[72:75], v[216:219], v[80:95]
  ds_read_b64_tr_b16 v[68:69], v29 offset:0
  ds_read_b64_tr_b16 v[70:71], v29 offset:512
  v_add_f32 v16, v16, v115
  v_add_f32 v17, v17, v131
  v_fma_f32 v118, v134, v33, v1
  v_fma_f32 v134, -v134, v33, v2
  v_exp_f32 v117, v117
  v_exp_f32 v133, v133
  v_add_f32 v16, v16, v116
  v_mfma_f32_32x32x16_bf16 v[80:95], v[76:79], v[220:223], v[80:95]
  ds_read_b64_tr_b16 v[72:73], v30 offset:0
  ds_read_b64_tr_b16 v[74:75], v30 offset:512
  v_add_f32 v17, v17, v132
  v_fma_f32 v119, v135, v33, v1
  v_fma_f32 v135, -v135, v33, v2
  v_exp_f32 v118, v118
  v_exp_f32 v134, v134
  v_add_f32 v16, v16, v117
  v_add_f32 v17, v17, v133
  s_waitcnt lgkmcnt(2)
  v_mfma_f32_16x16x32_bf16 v[56:59], v[52:55], v[64:67], v[56:59]
  v_mfma_f32_32x32x16_bf16 v[80:95], v[64:67], v[224:227], v[80:95]
  ds_read_b64_tr_b16 v[76:77], v31 offset:0
  ds_read_b64_tr_b16 v[78:79], v31 offset:512
  v_fma_f32 v120, v136, v33, v1
  v_fma_f32 v136, -v136, v33, v2
  v_exp_f32 v119, v119
  v_exp_f32 v135, v135
  v_add_f32 v16, v16, v118
  v_add_f32 v17, v17, v134
  v_fma_f32 v121, v137, v33, v1
  v_mfma_f32_32x32x16_bf16 v[80:95], v[68:71], v[228:231], v[80:95]
  ds_read_b64_tr_b16 v[64:65], v28 offset:24576
  ds_read_b64_tr_b16 v[66:67], v28 offset:25088
  v_fma_f32 v137, -v137, v33, v2
  v_exp_f32 v120, v120
  v_exp_f32 v136, v136
  v_add_f32 v16, v16, v119
  v_add_f32 v17, v17, v135
  v_fma_f32 v122, v138, v33, v1
  v_fma_f32 v138, -v138, v33, v2
  s_waitcnt lgkmcnt(2)
  v_mfma_f32_32x32x16_bf16 v[80:95], v[72:75], v[232:235], v[80:95]
  ds_read_b64_tr_b16 v[68:69], v29 offset:24576
  ds_read_b64_tr_b16 v[70:71], v29 offset:25088
  v_exp_f32 v121, v121
  v_exp_f32 v137, v137
  v_add_f32 v16, v16, v120
  v_add_f32 v17, v17, v136
  v_fma_f32 v123, v139, v33, v1
  v_fma_f32 v139, -v139, v33, v2
  v_exp_f32 v122, v122
  v_mfma_f32_32x32x16_bf16 v[80:95], v[76:79], v[236:239], v[80:95]
  ds_read_b64_tr_b16 v[72:73], v30 offset:24576
  ds_read_b64_tr_b16 v[74:75], v30 offset:25088
  v_exp_f32 v138, v138
  v_add_f32 v16, v16, v121
  v_add_f32 v17, v17, v137
  v_fma_f32 v124, v140, v33, v1
  v_fma_f32 v140, -v140, v33, v2
  v_exp_f32 v123, v123
  v_exp_f32 v139, v139
  s_waitcnt lgkmcnt(2)
  v_mfma_f32_16x16x32_bf16 v[56:59], v[52:55], v[64:67], v[56:59]
  v_mfma_f32_32x32x16_bf16 v[80:95], v[64:67], v[240:243], v[80:95]
  ds_read_b64_tr_b16 v[76:77], v31 offset:24576
  ds_read_b64_tr_b16 v[78:79], v31 offset:25088
  v_add_f32 v16, v16, v122
  v_add_f32 v17, v17, v138
  v_fma_f32 v125, v141, v33, v1
  v_fma_f32 v141, -v141, v33, v2
  v_exp_f32 v124, v124
  v_exp_f32 v140, v140
  ds_write2_b32 v10, v56, v57 offset0:0 offset1:64
  s_waitcnt lgkmcnt(0)
  s_barrier
  v_mfma_f32_32x32x16_bf16 v[80:95], v[68:71], v[244:247], v[80:95]
  ds_read_b64_tr_b16 v[64:65], v28 offset:32768
  ds_read_b64_tr_b16 v[66:67], v28 offset:33280
  ds_read_b128 v[60:63], v9 offset:0
  v_mfma_f32_32x32x16_bf16 v[80:95], v[72:75], v[248:251], v[80:95]
  ds_read_b64_tr_b16 v[68:69], v29 offset:32768
  ds_read_b64_tr_b16 v[70:71], v29 offset:33280
  v_mfma_f32_32x32x16_bf16 v[80:95], v[76:79], v[252:255], v[80:95]
  ds_read_b64_tr_b16 v[72:73], v30 offset:32768
  ds_read_b64_tr_b16 v[74:75], v30 offset:33280
  s_waitcnt lgkmcnt(2)
  v_mfma_f32_16x16x32_bf16 v[56:59], v[52:55], v[64:67], 0
  v_mfma_f32_32x32x16_bf16 v[96:111], v[64:67], v[144:147], 0
  ds_read_b64_tr_b16 v[76:77], v31 offset:32768
  ds_read_b64_tr_b16 v[78:79], v31 offset:33280
  v_add_f32 v60, v60, v61
  v_add_f32 v62, v62, v63
  v_add_f32 v60, v60, v62
  v_cvt_pk_bf16_f32 v61, v60, v60
  v_lshlrev_b32 v61, 16, v61
  v_sub_f32 v62, v60, v61
  v_cvt_pk_bf16_f32 v48, v61, v62
  v_mfma_f32_32x32x16_bf16 v[96:111], v[68:71], v[148:151], v[96:111]
  ds_read_b64_tr_b16 v[64:65], v28 offset:40960
  ds_read_b64_tr_b16 v[66:67], v28 offset:41472
  v_mfma_f32_32x32x8_bf16 v[80:95], v[48:49], v[46:47], v[80:95]
  v_add_f32 v16, v16, v123
  v_add_f32 v17, v17, v139
  v_fma_f32 v126, v142, v33, v1
  v_fma_f32 v142, -v142, v33, v2
  v_exp_f32 v125, v125
  v_exp_f32 v141, v141
  v_fma_f32 v127, v143, v33, v1
  v_fma_f32 v143, -v143, v33, v2
  v_exp_f32 v126, v126
  v_exp_f32 v142, v142
  s_waitcnt lgkmcnt(2)
  v_mfma_f32_32x32x16_bf16 v[96:111], v[72:75], v[152:155], v[96:111]
  ds_read_b64_tr_b16 v[68:69], v29 offset:40960
  ds_read_b64_tr_b16 v[70:71], v29 offset:41472
  v_add_f32 v18, v124, v125
  v_add_f32 v19, v140, v141
  v_exp_f32 v127, v127
  v_exp_f32 v143, v143
  v_add_f32 v18, v18, v126
  v_add_f32 v19, v19, v142
  v_add_f32 v18, v18, v127
  v_add_f32 v19, v19, v143
  v_fma_f32 v16, v18, v32, v16
  v_fma_f32 v17, v19, v32, v17
  v_mfma_f32_32x32x16_bf16 v[96:111], v[76:79], v[156:159], v[96:111]
  ds_read_b64_tr_b16 v[72:73], v30 offset:40960
  ds_read_b64_tr_b16 v[74:75], v30 offset:41472
  v_mov_b32 v18, v16
  v_mov_b32 v19, v17
  v_xor_b32 v21, 16, v8
  v_permlane32_swap_b32 v16, v18
  v_permlane32_swap_b32 v17, v19
  v_add_f32 v16, v16, v18
  v_add_f32 v17, v17, v19
  v_rcp_f32 v16, v16
  v_rcp_f32 v17, v17
  v_xor_b32 v22, 32, v8
  s_waitcnt lgkmcnt(2)
  v_mfma_f32_16x16x32_bf16 v[56:59], v[52:55], v[64:67], v[56:59]
  v_mfma_f32_32x32x16_bf16 v[96:111], v[64:67], v[160:163], v[96:111]
  ds_read_b64_tr_b16 v[76:77], v31 offset:40960
  ds_read_b64_tr_b16 v[78:79], v31 offset:41472
  v_mul_f32 v18, v16, v32
  v_mul_f32 v19, v17, v32
  v_xor_b32 v23, 48, v8
  v_mul_f32 v112, v112, v16
  v_mul_f32 v113, v113, v16
  v_mul_f32 v114, v114, v16
  v_mul_f32 v115, v115, v16
  v_cvt_pk_bf16_f32 v112, v112, v113
  v_cvt_pk_bf16_f32 v113, v114, v115
  ds_write_b64 v8, v[112:113]
  v_mul_f32 v116, v116, v16
  v_mul_f32 v117, v117, v16
  v_mfma_f32_32x32x16_bf16 v[96:111], v[68:71], v[164:167], v[96:111]
  ds_read_b64_tr_b16 v[64:65], v28 offset:49152
  ds_read_b64_tr_b16 v[66:67], v28 offset:49664
  v_mul_f32 v118, v118, v16
  v_mul_f32 v119, v119, v16
  v_cvt_pk_bf16_f32 v116, v116, v117
  v_cvt_pk_bf16_f32 v117, v118, v119
  ds_write_b64 v21, v[116:117]
  v_mul_f32 v120, v120, v16
  v_mul_f32 v121, v121, v16
  v_mul_f32 v122, v122, v16
  v_mul_f32 v123, v123, v16
  v_cvt_pk_bf16_f32 v120, v120, v121
  v_cvt_pk_bf16_f32 v121, v122, v123
  ds_write_b64 v22, v[120:121]
  s_waitcnt lgkmcnt(5)
  v_mfma_f32_32x32x16_bf16 v[96:111], v[72:75], v[168:171], v[96:111]
  ds_read_b64_tr_b16 v[68:69], v29 offset:49152
  ds_read_b64_tr_b16 v[70:71], v29 offset:49664
  v_mul_f32 v124, v124, v18
  v_mul_f32 v125, v125, v18
  v_mul_f32 v126, v126, v18
  v_mul_f32 v127, v127, v18
  v_cvt_pk_bf16_f32 v124, v124, v125
  v_cvt_pk_bf16_f32 v125, v126, v127
  ds_write_b64 v23, v[124:125]
  v_mul_f32 v128, v128, v17
  v_mul_f32 v129, v129, v17
  v_mul_f32 v130, v130, v17
  v_mul_f32 v131, v131, v17
  v_xor_b32 v8, 64, v8
  v_mfma_f32_32x32x16_bf16 v[96:111], v[76:79], v[172:175], v[96:111]
  ds_read_b64_tr_b16 v[72:73], v30 offset:49152
  ds_read_b64_tr_b16 v[74:75], v30 offset:49664
  v_cvt_pk_bf16_f32 v128, v128, v129
  v_cvt_pk_bf16_f32 v129, v130, v131
  ds_write_b64 v8, v[128:129]
  v_mul_f32 v132, v132, v17
  v_mul_f32 v133, v133, v17
  v_mul_f32 v134, v134, v17
  v_mul_f32 v135, v135, v17
  v_xor_b32 v21, 64, v21
  v_cvt_pk_bf16_f32 v132, v132, v133
  v_cvt_pk_bf16_f32 v133, v134, v135
  ds_write_b64 v21, v[132:133]
  v_mul_f32 v136, v136, v17
  s_waitcnt lgkmcnt(5)
  v_mfma_f32_16x16x32_bf16 v[56:59], v[52:55], v[64:67], v[56:59]
  v_mfma_f32_32x32x16_bf16 v[96:111], v[64:67], v[176:179], v[96:111]
  ds_read_b64_tr_b16 v[76:77], v31 offset:49152
  ds_read_b64_tr_b16 v[78:79], v31 offset:49664
  v_mul_f32 v137, v137, v17
  v_mul_f32 v138, v138, v17
  v_mul_f32 v139, v139, v17
  v_xor_b32 v22, 64, v22
  v_cvt_pk_bf16_f32 v136, v136, v137
  v_cvt_pk_bf16_f32 v137, v138, v139
  ds_write_b64 v22, v[136:137]
  v_mul_f32 v140, v140, v19
  v_mul_f32 v141, v141, v19
  v_mul_f32 v142, v142, v19
  v_mul_f32 v143, v143, v19
  v_xor_b32 v23, 64, v23
  v_cvt_pk_bf16_f32 v140, v140, v141
  v_cvt_pk_bf16_f32 v141, v142, v143
  ds_write_b64 v23, v[140:141]
  s_waitcnt lgkmcnt(0)
  s_barrier
  v_mfma_f32_32x32x16_bf16 v[96:111], v[68:71], v[180:183], v[96:111]
  ds_read_b64_tr_b16 v[64:65], v28 offset:57344
  ds_read_b64_tr_b16 v[66:67], v28 offset:57856
  v_bfe_u32 v37, v7, 9, 1
  v_bfe_u32 v35, v7, 6, 2
  v_lshl_add_u32 v37, v37, 2, v35
  v_mul_u32_u24 v37, 56, v37
  v_mfma_f32_32x32x16_bf16 v[96:111], v[72:75], v[184:187], v[96:111]
  ds_read_b64_tr_b16 v[68:69], v29 offset:57344
  ds_read_b64_tr_b16 v[70:71], v29 offset:57856
  v_bfe_u32 v35, v7, 8, 1
  v_lshlrev_b32 v35, 5, v35
  v_bfe_u32 v36, v7, 4, 2
  v_lshl_add_u32 v35, v36, 3, v35
  v_min_u32 v35, 48, v35
  v_add_u32 v37, v37, v35
  v_add_u32 v37, 73728, v37
  v_mfma_f32_32x32x16_bf16 v[96:111], v[76:79], v[188:191], v[96:111]
  ds_read_b64_tr_b16 v[72:73], v30 offset:57344
  ds_read_b64_tr_b16 v[74:75], v30 offset:57856
  s_mul_i32 s82, s96, 6272
  v_add_u32 v37, s82, v37
  s_mul_i32 s98, s96, 12544
  s_sub_u32 s98, 3136, s98
  ds_read_b64_tr_b16 v[38:39], v37 offset:0
  ds_read_b64_tr_b16 v[40:41], v37 offset:448
  ds_read_b64_tr_b16 v[42:43], v37 offset:896
  s_waitcnt lgkmcnt(5)
  v_mfma_f32_16x16x32_bf16 v[56:59], v[52:55], v[64:67], v[56:59]
  v_mfma_f32_32x32x16_bf16 v[96:111], v[64:67], v[192:195], v[96:111]
  ds_read_b64_tr_b16 v[76:77], v31 offset:57344
  ds_read_b64_tr_b16 v[78:79], v31 offset:57856
  ds_read_b64_tr_b16 v[44:45], v37 offset:1344
  v_cvt_pk_bf16_f32 v16, v80, v81
  v_cvt_pk_bf16_f32 v17, v82, v83
  v_cvt_pk_bf16_f32 v18, v84, v85
  v_cvt_pk_bf16_f32 v19, v86, v87
  v_cvt_pk_bf16_f32 v20, v88, v89
  v_mfma_f32_32x32x16_bf16 v[96:111], v[68:71], v[196:199], v[96:111]
  v_add_u32 v28, 0xffff0000, v28
  v_add_u32 v29, 0xffff0000, v29
  v_add_u32 v30, 0xffff0000, v30
  v_add_u32 v31, 0xffff0000, v31
  ds_read_b64_tr_b16 v[64:65], v28 offset:0
  ds_read_b64_tr_b16 v[66:67], v28 offset:512
  v_cvt_pk_bf16_f32 v21, v90, v91
  v_cvt_pk_bf16_f32 v22, v92, v93
  v_cvt_pk_bf16_f32 v23, v94, v95
  s_waitcnt lgkmcnt(2)
  v_cndmask_b32 v44, 0, v44, s[100:101]
  v_cndmask_b32 v45, 0, v45, s[100:101]
  v_mfma_f32_32x32x16_bf16 v[80:95], v[38:41], v[16:19], 0
  v_mfma_f32_32x32x16_bf16 v[96:111], v[72:75], v[200:203], v[96:111]
  ds_read_b64_tr_b16 v[68:69], v29 offset:0
  ds_read_b64_tr_b16 v[70:71], v29 offset:512
  v_mfma_f32_32x32x16_bf16 v[80:95], v[42:45], v[20:23], v[80:95]
  v_mfma_f32_32x32x16_bf16 v[96:111], v[76:79], v[204:207], v[96:111]
  ds_read_b64_tr_b16 v[72:73], v30 offset:0
  ds_read_b64_tr_b16 v[74:75], v30 offset:512
  s_waitcnt lgkmcnt(2)
  v_mfma_f32_16x16x32_bf16 v[56:59], v[52:55], v[64:67], v[56:59]
  v_mfma_f32_32x32x16_bf16 v[96:111], v[64:67], v[208:211], v[96:111]
  ds_read_b64_tr_b16 v[76:77], v31 offset:0
  ds_read_b64_tr_b16 v[78:79], v31 offset:512
  v_mfma_f32_32x32x16_bf16 v[96:111], v[68:71], v[212:215], v[96:111]
  ds_read_b64_tr_b16 v[64:65], v28 offset:8192
  ds_read_b64_tr_b16 v[66:67], v28 offset:8704
  s_nop 0
  v_max3_f32 v1, v80, v81, v82
  v_min3_f32 v2, v80, v81, v82
  v_max3_f32 v1, v1, v83, v84
  v_min3_f32 v2, v2, v83, v84
  v_max3_f32 v1, v1, v85, v86
  v_min3_f32 v2, v2, v85, v86
  v_max3_f32 v1, v1, v87, v88
  v_min3_f32 v2, v2, v87, v88
  v_max3_f32 v1, v1, v89, v90
  v_min3_f32 v2, v2, v89, v90
  v_max3_f32 v1, v1, v91, v92
  v_min3_f32 v2, v2, v91, v92
  s_waitcnt lgkmcnt(2)
  v_mfma_f32_32x32x16_bf16 v[96:111], v[72:75], v[216:219], v[96:111]
  ds_read_b64_tr_b16 v[68:69], v29 offset:8192
  ds_read_b64_tr_b16 v[70:71], v29 offset:8704
  v_max3_f32 v1, v1, v93, v94
  v_min3_f32 v2, v2, v93, v94
  v_max_f32 v3, v1, v95
  v_min_f32 v4, v2, v95
  v_mov_b32 v1, v3
  v_mov_b32 v2, v4
  s_nop 0
  v_permlane32_swap_b32 v1, v3
  v_permlane32_swap_b32 v2, v4
  v_mfma_f32_32x32x16_bf16 v[96:111], v[76:79], v[220:223], v[96:111]
  ds_read_b64_tr_b16 v[72:73], v30 offset:8192
  ds_read_b64_tr_b16 v[74:75], v30 offset:8704
  v_max_f32 v1, v1, v3
  v_min_f32 v2, v2, v4
  v_mul_f32_e64 v1, -v1, v33
  v_mul_f32 v2, v2, v33
  v_fma_f32 v24, -v80, v33, v2
  v_fma_f32 v25, -v81, v33, v2
  v_fma_f32 v26, v80, v33, v1
  s_waitcnt lgkmcnt(2)
  v_mfma_f32_16x16x32_bf16 v[56:59], v[52:55], v[64:67], v[56:59]
  v_mfma_f32_32x32x16_bf16 v[96:111], v[64:67], v[224:227], v[96:111]
  ds_read_b64_tr_b16 v[76:77], v31 offset:8192
  ds_read_b64_tr_b16 v[78:79], v31 offset:8704
  v_fma_f32 v27, v81, v33, v1
  v_exp_f32 v24, v24
  v_exp_f32 v25, v25
  v_exp_f32 v26, v26
  v_exp_f32 v27, v27
  v_mfma_f32_32x32x16_bf16 v[96:111], v[68:71], v[228:231], v[96:111]
  ds_read_b64_tr_b16 v[64:65], v28 offset:16384
  ds_read_b64_tr_b16 v[66:67], v28 offset:16896
  v_cvt_pk_bf16_f32 v16, v24, v25
  v_cvt_pk_bf16_f32 v80, v26, v27
  v_fma_f32 v24, -v82, v33, v2
  v_fma_f32 v25, -v83, v33, v2
  v_fma_f32 v26, v82, v33, v1
  v_fma_f32 v27, v83, v33, v1
  s_waitcnt lgkmcnt(2)
  v_mfma_f32_32x32x16_bf16 v[96:111], v[72:75], v[232:235], v[96:111]
  ds_read_b64_tr_b16 v[68:69], v29 offset:16384
  ds_read_b64_tr_b16 v[70:71], v29 offset:16896
  v_exp_f32 v24, v24
  v_exp_f32 v25, v25
  v_exp_f32 v26, v26
  v_exp_f32 v27, v27
  v_mfma_f32_32x32x16_bf16 v[96:111], v[76:79], v[236:239], v[96:111]
  ds_read_b64_tr_b16 v[72:73], v30 offset:16384
  ds_read_b64_tr_b16 v[74:75], v30 offset:16896
  v_cvt_pk_bf16_f32 v17, v24, v25
  v_cvt_pk_bf16_f32 v81, v26, v27
  v_fma_f32 v24, -v84, v33, v2
  v_fma_f32 v25, -v85, v33, v2
  v_fma_f32 v26, v84, v33, v1
  v_fma_f32 v27, v85, v33, v1
  v_exp_f32 v24, v24
  s_waitcnt lgkmcnt(2)
  v_mfma_f32_16x16x32_bf16 v[56:59], v[52:55], v[64:67], v[56:59]
  v_mfma_f32_32x32x16_bf16 v[96:111], v[64:67], v[240:243], v[96:111]
  ds_read_b64_tr_b16 v[76:77], v31 offset:16384
  ds_read_b64_tr_b16 v[78:79], v31 offset:16896
  v_exp_f32 v25, v25
  v_exp_f32 v26, v26
  v_exp_f32 v27, v27
  v_cvt_pk_bf16_f32 v18, v24, v25
  s_nop 0
  ds_write2_b32 v10, v56, v57 offset0:128 offset1:192
  v_mfma_f32_32x32x16_bf16 v[96:111], v[68:71], v[244:247], v[96:111]
  ds_read_b64_tr_b16 v[64:65], v28 offset:24576
  ds_read_b64_tr_b16 v[66:67], v28 offset:25088
  v_cvt_pk_bf16_f32 v82, v26, v27
  v_fma_f32 v24, -v86, v33, v2
  v_fma_f32 v25, -v87, v33, v2
  v_fma_f32 v26, v86, v33, v1
  v_fma_f32 v27, v87, v33, v1
  v_exp_f32 v24, v24
  s_waitcnt lgkmcnt(3)
  v_mfma_f32_32x32x16_bf16 v[96:111], v[72:75], v[248:251], v[96:111]
  ds_read_b64_tr_b16 v[68:69], v29 offset:24576
  ds_read_b64_tr_b16 v[70:71], v29 offset:25088
  v_exp_f32 v25, v25
  v_exp_f32 v26, v26
  v_exp_f32 v27, v27
  v_cvt_pk_bf16_f32 v19, v24, v25
  v_cvt_pk_bf16_f32 v83, v26, v27
  v_mfma_f32_32x32x16_bf16 v[96:111], v[76:79], v[252:255], v[96:111]
  ds_read_b64_tr_b16 v[72:73], v30 offset:24576
  ds_read_b64_tr_b16 v[74:75], v30 offset:25088
  v_fma_f32 v24, -v88, v33, v2
  v_fma_f32 v25, -v89, v33, v2
  v_fma_f32 v26, v88, v33, v1
  v_fma_f32 v27, v89, v33, v1
  v_exp_f32 v24, v24
  v_exp_f32 v25, v25
  s_waitcnt lgkmcnt(2)
  v_mfma_f32_16x16x32_bf16 v[56:59], v[52:55], v[64:67], 0
  v_mfma_f32_32x32x16_bf16 v[112:127], v[64:67], v[144:147], 0
  ds_read_b64_tr_b16 v[76:77], v31 offset:24576
  ds_read_b64_tr_b16 v[78:79], v31 offset:25088
  v_exp_f32 v26, v26
  v_exp_f32 v27, v27
  v_cvt_pk_bf16_f32 v88, v24, v25
  v_cvt_pk_bf16_f32 v84, v26, v27
  v_fma_f32 v24, -v90, v33, v2
  s_barrier
  v_mfma_f32_32x32x16_bf16 v[112:127], v[68:71], v[148:151], v[112:127]
  ds_read_b64_tr_b16 v[64:65], v28 offset:32768
  ds_read_b64_tr_b16 v[66:67], v28 offset:33280
  ds_read_b128 v[60:63], v9 offset:512
  s_waitcnt lgkmcnt(3)
  v_mfma_f32_32x32x16_bf16 v[112:127], v[72:75], v[152:155], v[112:127]
  ds_read_b64_tr_b16 v[68:69], v29 offset:32768
  ds_read_b64_tr_b16 v[70:71], v29 offset:33280
  v_mfma_f32_32x32x16_bf16 v[112:127], v[76:79], v[156:159], v[112:127]
  ds_read_b64_tr_b16 v[72:73], v30 offset:32768
  ds_read_b64_tr_b16 v[74:75], v30 offset:33280
  s_waitcnt lgkmcnt(2)
  v_mfma_f32_16x16x32_bf16 v[56:59], v[52:55], v[64:67], v[56:59]
  v_mfma_f32_32x32x16_bf16 v[112:127], v[64:67], v[160:163], v[112:127]
  ds_read_b64_tr_b16 v[76:77], v31 offset:32768
  ds_read_b64_tr_b16 v[78:79], v31 offset:33280
  v_add_f32 v60, v60, v61
  v_add_f32 v62, v62, v63
  v_add_f32 v60, v60, v62
  v_cvt_pk_bf16_f32 v61, v60, v60
  v_lshlrev_b32 v61, 16, v61
  v_sub_f32 v62, v60, v61
  v_cvt_pk_bf16_f32 v48, v61, v62
  v_mfma_f32_32x32x16_bf16 v[112:127], v[68:71], v[164:167], v[112:127]
  ds_read_b64_tr_b16 v[64:65], v28 offset:40960
  ds_read_b64_tr_b16 v[66:67], v28 offset:41472
  v_mfma_f32_32x32x8_bf16 v[96:111], v[48:49], v[46:47], v[96:111]
  v_fma_f32 v25, -v91, v33, v2
  v_fma_f32 v26, v90, v33, v1
  v_fma_f32 v27, v91, v33, v1
  v_exp_f32 v24, v24
  v_exp_f32 v25, v25
  v_exp_f32 v26, v26
  v_exp_f32 v27, v27
  v_cvt_pk_bf16_f32 v89, v24, v25
  v_cvt_pk_bf16_f32 v85, v26, v27
  v_fma_f32 v24, -v92, v33, v2
  s_waitcnt lgkmcnt(2)
  v_mfma_f32_32x32x16_bf16 v[112:127], v[72:75], v[168:171], v[112:127]
  ds_read_b64_tr_b16 v[68:69], v29 offset:40960
  ds_read_b64_tr_b16 v[70:71], v29 offset:41472
  v_fma_f32 v25, -v93, v33, v2
  v_fma_f32 v26, v92, v33, v1
  v_fma_f32 v27, v93, v33, v1
  v_exp_f32 v24, v24
  v_exp_f32 v25, v25
  v_exp_f32 v26, v26
  v_exp_f32 v27, v27
  v_cvt_pk_bf16_f32 v90, v24, v25
  v_mfma_f32_32x32x16_bf16 v[112:127], v[76:79], v[172:175], v[112:127]
  ds_read_b64_tr_b16 v[72:73], v30 offset:40960
  ds_read_b64_tr_b16 v[74:75], v30 offset:41472
  v_cvt_pk_bf16_f32 v86, v26, v27
  v_fma_f32 v24, -v94, v33, v2
  v_fma_f32 v25, -v95, v33, v2
  v_fma_f32 v26, v94, v33, v1
  v_fma_f32 v27, v95, v33, v1
  v_exp_f32 v24, v24
  v_exp_f32 v25, v25
  v_exp_f32 v26, v26
  v_exp_f32 v27, v27
  s_waitcnt lgkmcnt(2)
  v_mfma_f32_16x16x32_bf16 v[56:59], v[52:55], v[64:67], v[56:59]
  v_mfma_f32_32x32x16_bf16 v[112:127], v[64:67], v[176:179], v[112:127]
  ds_read_b64_tr_b16 v[76:77], v31 offset:40960
  ds_read_b64_tr_b16 v[78:79], v31 offset:41472
  v_cvt_pk_bf16_f32 v91, v24, v25
  v_cvt_pk_bf16_f32 v87, v26, v27
  v_mov_b32 v92, v16
  v_mov_b32 v93, v17
  v_mov_b32 v94, v18
  v_mov_b32 v95, v19
  v_add_u32 v37, 3136, v37
  v_mfma_f32_32x32x16_bf16 v[112:127], v[68:71], v[180:183], v[112:127]
  ds_read_b64_tr_b16 v[64:65], v28 offset:49152
  ds_read_b64_tr_b16 v[66:67], v28 offset:49664
  ds_read_b64_tr_b16 v[38:39], v37 offset:0
  ds_read_b64_tr_b16 v[40:41], v37 offset:448
  ds_read_b64_tr_b16 v[42:43], v37 offset:896
  ds_read_b64_tr_b16 v[44:45], v37 offset:1344
  v_cvt_pk_bf16_f32 v16, v96, v97
  v_cvt_pk_bf16_f32 v17, v98, v99
  v_cvt_pk_bf16_f32 v18, v100, v101
  s_waitcnt lgkmcnt(6)
  v_mfma_f32_32x32x16_bf16 v[112:127], v[72:75], v[184:187], v[112:127]
  ds_read_b64_tr_b16 v[68:69], v29 offset:49152
  ds_read_b64_tr_b16 v[70:71], v29 offset:49664
  v_cvt_pk_bf16_f32 v19, v102, v103
  v_cvt_pk_bf16_f32 v20, v104, v105
  v_cvt_pk_bf16_f32 v21, v106, v107
  v_cvt_pk_bf16_f32 v22, v108, v109
  v_cvt_pk_bf16_f32 v23, v110, v111
  v_mfma_f32_32x32x16_bf16 v[112:127], v[76:79], v[188:191], v[112:127]
  ds_read_b64_tr_b16 v[72:73], v30 offset:49152
  ds_read_b64_tr_b16 v[74:75], v30 offset:49664
  s_waitcnt lgkmcnt(4)
  v_cndmask_b32 v44, 0, v44, s[100:101]
  v_cndmask_b32 v45, 0, v45, s[100:101]
  v_mfma_f32_32x32x16_bf16 v[96:111], v[38:41], v[16:19], 0
  s_nop 0
  v_mfma_f32_32x32x16_bf16 v[96:111], v[42:45], v[20:23], v[96:111]
  s_waitcnt lgkmcnt(2)
  v_mfma_f32_16x16x32_bf16 v[56:59], v[52:55], v[64:67], v[56:59]
  v_mfma_f32_32x32x16_bf16 v[112:127], v[64:67], v[192:195], v[112:127]
  ds_read_b64_tr_b16 v[76:77], v31 offset:49152
  ds_read_b64_tr_b16 v[78:79], v31 offset:49664
  v_mfma_f32_32x32x16_bf16 v[112:127], v[68:71], v[196:199], v[112:127]
  ds_read_b64_tr_b16 v[64:65], v28 offset:57344
  ds_read_b64_tr_b16 v[66:67], v28 offset:57856
  s_waitcnt lgkmcnt(2)
  v_mfma_f32_32x32x16_bf16 v[112:127], v[72:75], v[200:203], v[112:127]
  ds_read_b64_tr_b16 v[68:69], v29 offset:57344
  ds_read_b64_tr_b16 v[70:71], v29 offset:57856
  v_max3_f32 v1, v96, v97, v98
  v_min3_f32 v2, v96, v97, v98
  v_max3_f32 v1, v1, v99, v100
  v_min3_f32 v2, v2, v99, v100
  v_max3_f32 v1, v1, v101, v102
  v_min3_f32 v2, v2, v101, v102
  v_max3_f32 v1, v1, v103, v104
  v_min3_f32 v2, v2, v103, v104
  v_max3_f32 v1, v1, v105, v106
  v_min3_f32 v2, v2, v105, v106
  v_max3_f32 v1, v1, v107, v108
  v_min3_f32 v2, v2, v107, v108
  v_max3_f32 v1, v1, v109, v110
  v_mfma_f32_32x32x16_bf16 v[112:127], v[76:79], v[204:207], v[112:127]
  ds_read_b64_tr_b16 v[72:73], v30 offset:57344
  ds_read_b64_tr_b16 v[74:75], v30 offset:57856
  v_min3_f32 v2, v2, v109, v110
  v_max_f32 v3, v1, v111
  v_min_f32 v4, v2, v111
  v_mov_b32 v1, v3
  v_mov_b32 v2, v4
  s_nop 0
  v_permlane32_swap_b32 v1, v3
  v_permlane32_swap_b32 v2, v4
  v_max_f32 v1, v1, v3
  s_waitcnt lgkmcnt(2)
  v_mfma_f32_16x16x32_bf16 v[56:59], v[52:55], v[64:67], v[56:59]
  v_mfma_f32_32x32x16_bf16 v[112:127], v[64:67], v[208:211], v[112:127]
  ds_read_b64_tr_b16 v[76:77], v31 offset:57344
  ds_read_b64_tr_b16 v[78:79], v31 offset:57856
  v_min_f32 v2, v2, v4
  v_mul_f32_e64 v1, -v1, v33
  v_mul_f32 v2, v2, v33
  v_fma_f32 v24, -v96, v33, v2
  v_fma_f32 v25, -v97, v33, v2
  v_fma_f32 v26, v96, v33, v1
  v_fma_f32 v27, v97, v33, v1
  v_exp_f32 v24, v24
  s_barrier
  v_mfma_f32_32x32x16_bf16 v[112:127], v[68:71], v[212:215], v[112:127]
  v_add_u32 v28, 0x10000, v28
  v_add_u32 v29, 0x10000, v29
  v_add_u32 v30, 0x10000, v30
  v_add_u32 v31, 0x10000, v31
  ds_read_b64_tr_b16 v[64:65], v28 offset:0
  ds_read_b64_tr_b16 v[66:67], v28 offset:512
  v_exp_f32 v25, v25
  v_exp_f32 v26, v26
  v_exp_f32 v27, v27
  s_waitcnt lgkmcnt(2)
  v_mfma_f32_32x32x16_bf16 v[112:127], v[72:75], v[216:219], v[112:127]
  ds_read_b64_tr_b16 v[68:69], v29 offset:0
  ds_read_b64_tr_b16 v[70:71], v29 offset:512
  v_cvt_pk_bf16_f32 v16, v24, v25
  v_cvt_pk_bf16_f32 v96, v26, v27
  v_fma_f32 v24, -v98, v33, v2
  v_fma_f32 v25, -v99, v33, v2
  v_fma_f32 v26, v98, v33, v1
  v_fma_f32 v27, v99, v33, v1
  v_exp_f32 v24, v24
  v_mfma_f32_32x32x16_bf16 v[112:127], v[76:79], v[220:223], v[112:127]
  ds_read_b64_tr_b16 v[72:73], v30 offset:0
  ds_read_b64_tr_b16 v[74:75], v30 offset:512
  v_exp_f32 v25, v25
  v_exp_f32 v26, v26
  v_exp_f32 v27, v27
  v_cvt_pk_bf16_f32 v17, v24, v25
  v_cvt_pk_bf16_f32 v97, v26, v27
  s_waitcnt lgkmcnt(2)
  v_mfma_f32_16x16x32_bf16 v[56:59], v[52:55], v[64:67], v[56:59]
  v_mfma_f32_32x32x16_bf16 v[112:127], v[64:67], v[224:227], v[112:127]
  ds_read_b64_tr_b16 v[76:77], v31 offset:0
  ds_read_b64_tr_b16 v[78:79], v31 offset:512
  v_fma_f32 v24, -v100, v33, v2
  v_fma_f32 v25, -v101, v33, v2
  v_fma_f32 v26, v100, v33, v1
  v_fma_f32 v27, v101, v33, v1
  v_exp_f32 v24, v24
  v_exp_f32 v25, v25
  v_mfma_f32_32x32x16_bf16 v[112:127], v[68:71], v[228:231], v[112:127]
  v_add_u32 v28, 0xffff0000, v28
  v_add_u32 v29, 0xffff0000, v29
  v_add_u32 v30, 0xffff0000, v30
  v_add_u32 v31, 0xffff0000, v31
  ds_read_b64_tr_b16 v[64:65], v28 offset:0
  ds_read_b64_tr_b16 v[66:67], v28 offset:512
  v_exp_f32 v26, v26
  v_exp_f32 v27, v27
  v_cvt_pk_bf16_f32 v18, v24, v25
  v_cvt_pk_bf16_f32 v98, v26, v27
  v_fma_f32 v24, -v102, v33, v2
  v_fma_f32 v25, -v103, v33, v2
  s_waitcnt lgkmcnt(2)
  v_mfma_f32_32x32x16_bf16 v[112:127], v[72:75], v[232:235], v[112:127]
  ds_read_b64_tr_b16 v[68:69], v29 offset:0
  ds_read_b64_tr_b16 v[70:71], v29 offset:512
  v_fma_f32 v26, v102, v33, v1
  v_fma_f32 v27, v103, v33, v1
  v_exp_f32 v24, v24
  v_exp_f32 v25, v25
  v_exp_f32 v26, v26
  v_mfma_f32_32x32x16_bf16 v[112:127], v[76:79], v[236:239], v[112:127]
  ds_read_b64_tr_b16 v[72:73], v30 offset:0
  ds_read_b64_tr_b16 v[74:75], v30 offset:512
  v_exp_f32 v27, v27
  v_cvt_pk_bf16_f32 v19, v24, v25
  v_cvt_pk_bf16_f32 v99, v26, v27
  v_fma_f32 v24, -v104, v33, v2
  v_fma_f32 v25, -v105, v33, v2
  v_fma_f32 v26, v104, v33, v1
  v_fma_f32 v27, v105, v33, v1
  s_waitcnt lgkmcnt(2)
  v_mfma_f32_16x16x32_bf16 v[56:59], v[52:55], v[64:67], v[56:59]
  v_mfma_f32_32x32x16_bf16 v[112:127], v[64:67], v[240:243], v[112:127]
  ds_read_b64_tr_b16 v[76:77], v31 offset:0
  ds_read_b64_tr_b16 v[78:79], v31 offset:512
  v_exp_f32 v24, v24
  v_exp_f32 v25, v25
  v_exp_f32 v26, v26
  v_exp_f32 v27, v27
  s_nop 0
  ds_write2_b32 v10, v56, v57 offset0:0 offset1:64
  v_mfma_f32_32x32x16_bf16 v[112:127], v[68:71], v[244:247], v[112:127]
  ds_read_b64_tr_b16 v[64:65], v28 offset:8192
  ds_read_b64_tr_b16 v[66:67], v28 offset:8704
  v_cvt_pk_bf16_f32 v104, v24, v25
  v_cvt_pk_bf16_f32 v100, v26, v27
  v_fma_f32 v24, -v106, v33, v2
  v_fma_f32 v25, -v107, v33, v2
  v_fma_f32 v26, v106, v33, v1
  v_fma_f32 v27, v107, v33, v1
  v_exp_f32 v24, v24
  s_waitcnt lgkmcnt(3)
  v_mfma_f32_32x32x16_bf16 v[112:127], v[72:75], v[248:251], v[112:127]
  ds_read_b64_tr_b16 v[68:69], v29 offset:8192
  ds_read_b64_tr_b16 v[70:71], v29 offset:8704
  v_exp_f32 v25, v25
  v_exp_f32 v26, v26
  v_exp_f32 v27, v27
  v_cvt_pk_bf16_f32 v105, v24, v25
  v_cvt_pk_bf16_f32 v101, v26, v27
  v_mfma_f32_32x32x16_bf16 v[112:127], v[76:79], v[252:255], v[112:127]
  ds_read_b64_tr_b16 v[72:73], v30 offset:8192
  ds_read_b64_tr_b16 v[74:75], v30 offset:8704
  v_fma_f32 v24, -v108, v33, v2
  v_fma_f32 v25, -v109, v33, v2
  v_fma_f32 v26, v108, v33, v1
  v_fma_f32 v27, v109, v33, v1
  v_exp_f32 v24, v24
  v_exp_f32 v25, v25
  s_waitcnt lgkmcnt(2)
  v_mfma_f32_16x16x32_bf16 v[56:59], v[52:55], v[64:67], 0
  v_mfma_f32_32x32x16_bf16 v[128:143], v[64:67], v[144:147], 0
  ds_read_b64_tr_b16 v[76:77], v31 offset:8192
  ds_read_b64_tr_b16 v[78:79], v31 offset:8704
  v_exp_f32 v26, v26
  v_exp_f32 v27, v27
  v_cvt_pk_bf16_f32 v106, v24, v25
  v_cvt_pk_bf16_f32 v102, v26, v27
  v_fma_f32 v24, -v110, v33, v2
  v_fma_f32 v25, -v111, v33, v2
  s_barrier
  v_mfma_f32_32x32x16_bf16 v[128:143], v[68:71], v[148:151], v[128:143]
  ds_read_b64_tr_b16 v[64:65], v28 offset:16384
  ds_read_b64_tr_b16 v[66:67], v28 offset:16896
  ds_read_b128 v[60:63], v9 offset:0
  s_waitcnt lgkmcnt(3)
  v_mfma_f32_32x32x16_bf16 v[128:143], v[72:75], v[152:155], v[128:143]
  ds_read_b64_tr_b16 v[68:69], v29 offset:16384
  ds_read_b64_tr_b16 v[70:71], v29 offset:16896
  v_mfma_f32_32x32x16_bf16 v[128:143], v[76:79], v[156:159], v[128:143]
  ds_read_b64_tr_b16 v[72:73], v30 offset:16384
  ds_read_b64_tr_b16 v[74:75], v30 offset:16896
  s_waitcnt lgkmcnt(2)
  v_mfma_f32_16x16x32_bf16 v[56:59], v[52:55], v[64:67], v[56:59]
  v_mfma_f32_32x32x16_bf16 v[128:143], v[64:67], v[160:163], v[128:143]
  ds_read_b64_tr_b16 v[76:77], v31 offset:16384
  ds_read_b64_tr_b16 v[78:79], v31 offset:16896
  v_add_f32 v60, v60, v61
  v_add_f32 v62, v62, v63
  v_add_f32 v60, v60, v62
  v_cvt_pk_bf16_f32 v61, v60, v60
  v_lshlrev_b32 v61, 16, v61
  v_sub_f32 v62, v60, v61
  v_cvt_pk_bf16_f32 v48, v61, v62
  v_mfma_f32_32x32x16_bf16 v[128:143], v[68:71], v[164:167], v[128:143]
  ds_read_b64_tr_b16 v[64:65], v28 offset:24576
  ds_read_b64_tr_b16 v[66:67], v28 offset:25088
  v_mfma_f32_32x32x8_bf16 v[112:127], v[48:49], v[46:47], v[112:127]
  v_fma_f32 v26, v110, v33, v1
  v_fma_f32 v27, v111, v33, v1
  v_exp_f32 v24, v24
  v_exp_f32 v25, v25
  v_exp_f32 v26, v26
  v_exp_f32 v27, v27
  v_cvt_pk_bf16_f32 v107, v24, v25
  v_cvt_pk_bf16_f32 v103, v26, v27
  v_mov_b32 v108, v16
  v_mov_b32 v109, v17
  s_waitcnt lgkmcnt(2)
  v_mfma_f32_32x32x16_bf16 v[128:143], v[72:75], v[168:171], v[128:143]
  ds_read_b64_tr_b16 v[68:69], v29 offset:24576
  ds_read_b64_tr_b16 v[70:71], v29 offset:25088
  v_mov_b32 v110, v18
  v_mov_b32 v111, v19
  v_add_u32 v37, s98, v37
  ds_read_b64_tr_b16 v[38:39], v37 offset:0
  ds_read_b64_tr_b16 v[40:41], v37 offset:448
  ds_read_b64_tr_b16 v[42:43], v37 offset:896
  ds_read_b64_tr_b16 v[44:45], v37 offset:1344
  v_cvt_pk_bf16_f32 v16, v112, v113
  v_mfma_f32_32x32x16_bf16 v[128:143], v[76:79], v[172:175], v[128:143]
  ds_read_b64_tr_b16 v[72:73], v30 offset:24576
  ds_read_b64_tr_b16 v[74:75], v30 offset:25088
  v_cvt_pk_bf16_f32 v17, v114, v115
  v_cvt_pk_bf16_f32 v18, v116, v117
  v_cvt_pk_bf16_f32 v19, v118, v119
  v_cvt_pk_bf16_f32 v20, v120, v121
  v_cvt_pk_bf16_f32 v21, v122, v123
  v_cvt_pk_bf16_f32 v22, v124, v125
  v_cvt_pk_bf16_f32 v23, v126, v127
  s_waitcnt lgkmcnt(6)
  v_mfma_f32_16x16x32_bf16 v[56:59], v[52:55], v[64:67], v[56:59]
  v_mfma_f32_32x32x16_bf16 v[128:143], v[64:67], v[176:179], v[128:143]
  ds_read_b64_tr_b16 v[76:77], v31 offset:24576
  ds_read_b64_tr_b16 v[78:79], v31 offset:25088
  s_waitcnt lgkmcnt(4)
  v_cndmask_b32 v44, 0, v44, s[100:101]
  v_cndmask_b32 v45, 0, v45, s[100:101]
  v_mfma_f32_32x32x16_bf16 v[112:127], v[38:41], v[16:19], 0
  s_nop 0
  v_mfma_f32_32x32x16_bf16 v[112:127], v[42:45], v[20:23], v[112:127]
  v_mfma_f32_32x32x16_bf16 v[128:143], v[68:71], v[180:183], v[128:143]
  ds_read_b64_tr_b16 v[64:65], v28 offset:32768
  ds_read_b64_tr_b16 v[66:67], v28 offset:33280
  s_waitcnt lgkmcnt(2)
  v_mfma_f32_32x32x16_bf16 v[128:143], v[72:75], v[184:187], v[128:143]
  ds_read_b64_tr_b16 v[68:69], v29 offset:32768
  ds_read_b64_tr_b16 v[70:71], v29 offset:33280
  v_mfma_f32_32x32x16_bf16 v[128:143], v[76:79], v[188:191], v[128:143]
  ds_read_b64_tr_b16 v[72:73], v30 offset:32768
  ds_read_b64_tr_b16 v[74:75], v30 offset:33280
  s_waitcnt lgkmcnt(2)
  v_mfma_f32_16x16x32_bf16 v[56:59], v[52:55], v[64:67], v[56:59]
  v_mfma_f32_32x32x16_bf16 v[128:143], v[64:67], v[192:195], v[128:143]
  ds_read_b64_tr_b16 v[76:77], v31 offset:32768
  ds_read_b64_tr_b16 v[78:79], v31 offset:33280
  s_lshl_b32 s83, s79, 3
  s_add_u32 s83, s83, s73
  s_lshl_b32 s83, s83, 8
  v_lshrrev_b32 v5, 2, v7
  v_min_u32 v5, 252, v5
  v_add_u32 v5, s83, v5
  buffer_load_dword v6, v5, s[36:39], 0 offen sc1
  v_max3_f32 v1, v112, v113, v114
  v_min3_f32 v2, v112, v113, v114
  v_max3_f32 v1, v1, v115, v116
  v_min3_f32 v2, v2, v115, v116
  v_max3_f32 v1, v1, v117, v118
  v_min3_f32 v2, v2, v117, v118
  v_max3_f32 v1, v1, v119, v120
  v_min3_f32 v2, v2, v119, v120
  v_max3_f32 v1, v1, v121, v122
  v_min3_f32 v2, v2, v121, v122
  v_max3_f32 v1, v1, v123, v124
  v_min3_f32 v2, v2, v123, v124
  v_max3_f32 v1, v1, v125, v126
  v_min3_f32 v2, v2, v125, v126
  s_barrier
  v_mfma_f32_32x32x16_bf16 v[128:143], v[68:71], v[196:199], v[128:143]
  ds_read_b64_tr_b16 v[64:65], v28 offset:40960
  ds_read_b64_tr_b16 v[66:67], v28 offset:41472
  v_max_f32 v3, v1, v127
  v_min_f32 v4, v2, v127
  v_mov_b32 v1, v3
  v_mov_b32 v2, v4
  s_nop 0
  v_permlane32_swap_b32 v1, v3
  v_permlane32_swap_b32 v2, v4
  v_max_f32 v1, v1, v3
  v_min_f32 v2, v2, v4
  v_mul_f32_e64 v1, -v1, v33
  s_waitcnt lgkmcnt(2)
  v_mfma_f32_32x32x16_bf16 v[128:143], v[72:75], v[200:203], v[128:143]
  ds_read_b64_tr_b16 v[68:69], v29 offset:40960
  ds_read_b64_tr_b16 v[70:71], v29 offset:41472
  v_mul_f32 v2, v2, v33
  v_fma_f32 v24, -v112, v33, v2
  v_fma_f32 v25, -v113, v33, v2
  v_fma_f32 v26, v112, v33, v1
  v_fma_f32 v27, v113, v33, v1
  v_exp_f32 v24, v24
  v_exp_f32 v25, v25
  v_mfma_f32_32x32x16_bf16 v[128:143], v[76:79], v[204:207], v[128:143]
  ds_read_b64_tr_b16 v[72:73], v30 offset:40960
  ds_read_b64_tr_b16 v[74:75], v30 offset:41472
  v_exp_f32 v26, v26
  v_exp_f32 v27, v27
  v_cvt_pk_bf16_f32 v16, v24, v25
  v_cvt_pk_bf16_f32 v112, v26, v27
  v_fma_f32 v24, -v114, v33, v2
  v_fma_f32 v25, -v115, v33, v2
  v_fma_f32 v26, v114, v33, v1
  s_waitcnt lgkmcnt(2)
  v_mfma_f32_16x16x32_bf16 v[56:59], v[52:55], v[64:67], v[56:59]
  v_mfma_f32_32x32x16_bf16 v[128:143], v[64:67], v[208:211], v[128:143]
  ds_read_b64_tr_b16 v[76:77], v31 offset:40960
  ds_read_b64_tr_b16 v[78:79], v31 offset:41472
  s_waitcnt vmcnt(0)
  v_cmp_ne_u32 vcc, s80, v6
  s_mov_b32 s87, 262144
  s_nop 1
  s_cbranch_vccz L_poll_13_x
L_poll_13:
  buffer_load_dword v6, v5, s[36:39], 0 offen sc1
  s_sub_u32 s87, s87, 1
  s_cbranch_scc1 L_poll_13_y
  s_waitcnt vmcnt(0)
  v_cmp_ne_u32 vcc, s80, v6
  s_nop 4
  s_cbranch_vccnz L_poll_13
L_poll_13_y:
  s_waitcnt vmcnt(0)
  s_nop 4
L_poll_13_x:
  s_lshl_b32 s82, s79, 3
  s_add_u32 s82, s82, s73
  s_lshl_b32 s82, s82, 13
  s_add_u32 s86, s82, 65536
  s_lshl_b32 s83, s73, 13
  v_bfe_u32 v5, v7, 8, 2
  v_lshlrev_b32 v5, 4, v5
  v_xor_b32 v5, v5, v7
  s_add_u32 m0, s83, 90112
  v_mov_b32 v6, v5
  buffer_load_dwordx4 v6, s[36:39], s86 offen sc1 lds
  s_add_u32 m0, m0, 4096
  s_add_u32 s84, s86, 4096
  buffer_load_dwordx4 v6, s[36:39], s84 offen sc1 lds
  s_add_u32 s86, s86, 1024
  s_add_u32 m0, s83, 91136
  v_xor_b32 v6, 64, v5
  buffer_load_dwordx4 v6, s[36:39], s86 offen sc1 lds
  s_add_u32 m0, m0, 4096
  s_add_u32 s84, s86, 4096
  buffer_load_dwordx4 v6, s[36:39], s84 offen sc1 lds
  s_add_u32 s86, s86, 1024
  s_add_u32 m0, s83, 92160
  v_xor_b32 v6, 128, v5
  buffer_load_dwordx4 v6, s[36:39], s86 offen sc1 lds
  s_add_u32 m0, m0, 4096
  s_add_u32 s84, s86, 4096
  buffer_load_dwordx4 v6, s[36:39], s84 offen sc1 lds
  s_add_u32 s86, s86, 1024
  s_add_u32 m0, s83, 93184
  v_xor_b32 v6, 192, v5
  buffer_load_dwordx4 v6, s[36:39], s86 offen sc1 lds
  s_add_u32 m0, m0, 4096
  s_add_u32 s84, s86, 4096
  buffer_load_dwordx4 v6, s[36:39], s84 offen sc1 lds
  v_fma_f32 v27, v115, v33, v1
  v_exp_f32 v24, v24
  v_exp_f32 v25, v25
  v_exp_f32 v26, v26
  v_exp_f32 v27, v27
  v_mfma_f32_32x32x16_bf16 v[128:143], v[68:71], v[212:215], v[128:143]
  ds_read_b64_tr_b16 v[64:65], v28 offset:49152
  ds_read_b64_tr_b16 v[66:67], v28 offset:49664
  v_cvt_pk_bf16_f32 v17, v24, v25
  v_cvt_pk_bf16_f32 v113, v26, v27
  v_fma_f32 v24, -v116, v33, v2
  v_fma_f32 v25, -v117, v33, v2
  v_fma_f32 v26, v116, v33, v1
  v_fma_f32 v27, v117, v33, v1
  v_exp_f32 v24, v24
  v_exp_f32 v25, v25
  s_waitcnt lgkmcnt(2)
  v_mfma_f32_32x32x16_bf16 v[128:143], v[72:75], v[216:219], v[128:143]
  ds_read_b64_tr_b16 v[68:69], v29 offset:49152
  ds_read_b64_tr_b16 v[70:71], v29 offset:49664
  v_exp_f32 v26, v26
  v_exp_f32 v27, v27
  v_cvt_pk_bf16_f32 v18, v24, v25
  v_cvt_pk_bf16_f32 v114, v26, v27
  v_fma_f32 v24, -v118, v33, v2
  v_fma_f32 v25, -v119, v33, v2
  v_mfma_f32_32x32x16_bf16 v[128:143], v[76:79], v[220:223], v[128:143]
  ds_read_b64_tr_b16 v[72:73], v30 offset:49152
  ds_read_b64_tr_b16 v[74:75], v30 offset:49664
  v_fma_f32 v26, v118, v33, v1
  v_fma_f32 v27, v119, v33, v1
  v_exp_f32 v24, v24
  v_exp_f32 v25, v25
  v_exp_f32 v26, v26
  v_exp_f32 v27, v27
  s_waitcnt lgkmcnt(2)
  v_mfma_f32_16x16x32_bf16 v[56:59], v[52:55], v[64:67], v[56:59]
  v_mfma_f32_32x32x16_bf16 v[128:143], v[64:67], v[224:227], v[128:143]
  ds_read_b64_tr_b16 v[76:77], v31 offset:49152
  ds_read_b64_tr_b16 v[78:79], v31 offset:49664
  v_cvt_pk_bf16_f32 v19, v24, v25
  v_cvt_pk_bf16_f32 v115, v26, v27
  v_fma_f32 v24, -v120, v33, v2
  v_fma_f32 v25, -v121, v33, v2
  v_fma_f32 v26, v120, v33, v1
  v_fma_f32 v27, v121, v33, v1
  v_exp_f32 v24, v24
  v_mfma_f32_32x32x16_bf16 v[128:143], v[68:71], v[228:231], v[128:143]
  ds_read_b64_tr_b16 v[64:65], v28 offset:57344
  ds_read_b64_tr_b16 v[66:67], v28 offset:57856
  v_exp_f32 v25, v25
  v_exp_f32 v26, v26
  v_exp_f32 v27, v27
  v_cvt_pk_bf16_f32 v120, v24, v25
  v_cvt_pk_bf16_f32 v116, v26, v27
  v_fma_f32 v24, -v122, v33, v2
  s_waitcnt lgkmcnt(2)
  v_mfma_f32_32x32x16_bf16 v[128:143], v[72:75], v[232:235], v[128:143]
  ds_read_b64_tr_b16 v[68:69], v29 offset:57344
  ds_read_b64_tr_b16 v[70:71], v29 offset:57856
  v_fma_f32 v25, -v123, v33, v2
  v_fma_f32 v26, v122, v33, v1
  v_fma_f32 v27, v123, v33, v1
  v_exp_f32 v24, v24
  v_exp_f32 v25, v25
  v_exp_f32 v26, v26
  v_mfma_f32_32x32x16_bf16 v[128:143], v[76:79], v[236:239], v[128:143]
  ds_read_b64_tr_b16 v[72:73], v30 offset:57344
  ds_read_b64_tr_b16 v[74:75], v30 offset:57856
  v_exp_f32 v27, v27
  v_cvt_pk_bf16_f32 v121, v24, v25
  v_cvt_pk_bf16_f32 v117, v26, v27
  v_fma_f32 v24, -v124, v33, v2
  v_fma_f32 v25, -v125, v33, v2
  v_fma_f32 v26, v124, v33, v1
  v_fma_f32 v27, v125, v33, v1
  v_exp_f32 v24, v24
  s_waitcnt lgkmcnt(2)
  v_mfma_f32_16x16x32_bf16 v[56:59], v[52:55], v[64:67], v[56:59]
  v_mfma_f32_32x32x16_bf16 v[128:143], v[64:67], v[240:243], v[128:143]
  ds_read_b64_tr_b16 v[76:77], v31 offset:57344
  ds_read_b64_tr_b16 v[78:79], v31 offset:57856
  v_exp_f32 v25, v25
  v_exp_f32 v26, v26
  v_exp_f32 v27, v27
  v_cvt_pk_bf16_f32 v122, v24, v25
  s_nop 0
  ds_write2_b32 v10, v56, v57 offset0:128 offset1:192
  s_waitcnt lgkmcnt(0)
  s_barrier
  v_mfma_f32_32x32x16_bf16 v[128:143], v[68:71], v[244:247], v[128:143]
  ds_read_b128 v[60:63], v9 offset:512
  v_mfma_f32_32x32x16_bf16 v[128:143], v[72:75], v[248:251], v[128:143]
  v_mfma_f32_32x32x16_bf16 v[128:143], v[76:79], v[252:255], v[128:143]
  s_waitcnt lgkmcnt(0)
  v_add_f32 v60, v60, v61
  v_add_f32 v62, v62, v63
  v_add_f32 v60, v60, v62
  v_cvt_pk_bf16_f32 v61, v60, v60
  v_lshlrev_b32 v61, 16, v61
  v_sub_f32 v62, v60, v61
  v_cvt_pk_bf16_f32 v48, v61, v62
  s_nop 1
  v_mfma_f32_32x32x8_bf16 v[128:143], v[48:49], v[46:47], v[128:143]
  v_cvt_pk_bf16_f32 v118, v26, v27
  v_fma_f32 v24, -v126, v33, v2
  v_fma_f32 v25, -v127, v33, v2
  v_fma_f32 v26, v126, v33, v1
  v_fma_f32 v27, v127, v33, v1
  v_exp_f32 v24, v24
  v_exp_f32 v25, v25
  v_exp_f32 v26, v26
  v_exp_f32 v27, v27
  v_cvt_pk_bf16_f32 v123, v24, v25
  v_cvt_pk_bf16_f32 v119, v26, v27
  v_mov_b32 v124, v16
  v_mov_b32 v125, v17
  v_mov_b32 v126, v18
  v_mov_b32 v127, v19
  v_bfe_u32 v5, v7, 4, 5
  v_bfe_u32 v6, v7, 9, 1
  v_and_b32 v14, 15, v5
  v_xor_b32 v6, v6, v14
  v_lshlrev_b32 v6, 4, v6
  v_lshl_add_u32 v6, v5, 8, v6
  s_lshl_b32 s83, s73, 13
  s_add_u32 s83, s83, 90112
  v_add_u32 v6, s83, v6
  v_add_u32 v5, s83, v7
  s_waitcnt vmcnt(0)
  ds_read_b128 v[144:147], v6
  v_xor_b32 v14, 32, v6
  ds_read_b128 v[148:151], v14
  v_xor_b32 v14, 64, v6
  ds_read_b128 v[152:155], v14
  v_xor_b32 v14, 96, v6
  ds_read_b128 v[156:159], v14
  v_xor_b32 v14, 128, v6
  ds_read_b128 v[160:163], v14
  v_xor_b32 v14, 160, v6
  ds_read_b128 v[164:167], v14
  v_xor_b32 v14, 192, v6
  ds_read_b128 v[168:171], v14
  v_xor_b32 v14, 224, v6
  ds_read_b128 v[172:175], v14
  v_add_u32 v37, 3136, v37
  ds_read_b64_tr_b16 v[38:39], v37 offset:0
  ds_read_b64_tr_b16 v[40:41], v37 offset:448
  ds_read_b64_tr_b16 v[42:43], v37 offset:896
  ds_read_b64_tr_b16 v[44:45], v37 offset:1344
  v_cvt_pk_bf16_f32 v16, v128, v129
  v_cvt_pk_bf16_f32 v17, v130, v131
  v_cvt_pk_bf16_f32 v18, v132, v133
  v_cvt_pk_bf16_f32 v19, v134, v135
  v_cvt_pk_bf16_f32 v20, v136, v137
  v_cvt_pk_bf16_f32 v21, v138, v139
  v_cvt_pk_bf16_f32 v22, v140, v141
  v_cvt_pk_bf16_f32 v23, v142, v143
  s_waitcnt lgkmcnt(0)
  v_cndmask_b32 v44, 0, v44, s[100:101]
  v_cndmask_b32 v45, 0, v45, s[100:101]
  v_mfma_f32_32x32x16_bf16 v[128:143], v[38:41], v[16:19], 0
  s_nop 0
  v_mfma_f32_32x32x16_bf16 v[128:143], v[42:45], v[20:23], v[128:143]
  v_cvt_pk_bf16_f32 v176, v144, v145
  v_cvt_pk_bf16_f32 v177, v146, v147
  v_cvt_pk_bf16_f32 v178, v148, v149
  v_cvt_pk_bf16_f32 v179, v150, v151
  v_cvt_pk_bf16_f32 v180, v152, v153
  v_cvt_pk_bf16_f32 v181, v154, v155
  v_cvt_pk_bf16_f32 v182, v156, v157
  v_cvt_pk_bf16_f32 v183, v158, v159
  v_cvt_pk_bf16_f32 v184, v160, v161
  v_cvt_pk_bf16_f32 v185, v162, v163
  v_cvt_pk_bf16_f32 v186, v164, v165
  v_cvt_pk_bf16_f32 v187, v166, v167
  v_cvt_pk_bf16_f32 v188, v168, v169
  v_cvt_pk_bf16_f32 v189, v170, v171
  v_cvt_pk_bf16_f32 v190, v172, v173
  v_cvt_pk_bf16_f32 v191, v174, v175
  ds_write_b128 v5, v[176:179] offset:0
  ds_write_b128 v5, v[180:183] offset:1024
  ds_write_b128 v5, v[184:187] offset:2048
  ds_write_b128 v5, v[188:191] offset:3072
  v_max3_f32 v1, v128, v129, v130
  v_min3_f32 v2, v128, v129, v130
  v_max3_f32 v1, v1, v131, v132
  v_min3_f32 v2, v2, v131, v132
  v_max3_f32 v1, v1, v133, v134
  v_min3_f32 v2, v2, v133, v134
  v_max3_f32 v1, v1, v135, v136
  v_min3_f32 v2, v2, v135, v136
  v_max3_f32 v1, v1, v137, v138
  v_min3_f32 v2, v2, v137, v138
  v_max3_f32 v1, v1, v139, v140
  v_min3_f32 v2, v2, v139, v140
  v_max3_f32 v1, v1, v141, v142
  v_min3_f32 v2, v2, v141, v142
  v_max_f32 v3, v1, v143
  v_min_f32 v4, v2, v143
  v_mov_b32 v1, v3
  v_mov_b32 v2, v4
  s_nop 0
  v_permlane32_swap_b32 v1, v3
  v_permlane32_swap_b32 v2, v4
  v_max_f32 v1, v1, v3
  v_min_f32 v2, v2, v4
  v_mul_f32_e64 v1, -v1, v33
  v_mul_f32 v2, v2, v33
  v_fma_f32 v24, -v128, v33, v2
  v_fma_f32 v25, -v129, v33, v2
  v_fma_f32 v26, v128, v33, v1
  v_fma_f32 v27, v129, v33, v1
  v_exp_f32 v24, v24
  v_exp_f32 v25, v25
  v_exp_f32 v26, v26
  v_exp_f32 v27, v27
  v_cvt_pk_bf16_f32 v16, v24, v25
  v_cvt_pk_bf16_f32 v128, v26, v27
  v_fma_f32 v24, -v130, v33, v2
  v_fma_f32 v25, -v131, v33, v2
  v_fma_f32 v26, v130, v33, v1
  v_fma_f32 v27, v131, v33, v1
  v_exp_f32 v24, v24
  v_exp_f32 v25, v25
  v_exp_f32 v26, v26
  v_exp_f32 v27, v27
  v_cvt_pk_bf16_f32 v17, v24, v25
  v_cvt_pk_bf16_f32 v129, v26, v27
  v_fma_f32 v24, -v132, v33, v2
  v_fma_f32 v25, -v133, v33, v2
  v_fma_f32 v26, v132, v33, v1
  v_fma_f32 v27, v133, v33, v1
  v_exp_f32 v24, v24
  v_exp_f32 v25, v25
  v_exp_f32 v26, v26
  v_exp_f32 v27, v27
  v_cvt_pk_bf16_f32 v18, v24, v25
  v_cvt_pk_bf16_f32 v130, v26, v27
  v_fma_f32 v24, -v134, v33, v2
  v_fma_f32 v25, -v135, v33, v2
  v_fma_f32 v26, v134, v33, v1
  v_fma_f32 v27, v135, v33, v1
  v_exp_f32 v24, v24
  v_exp_f32 v25, v25
  v_exp_f32 v26, v26
  v_exp_f32 v27, v27
  v_cvt_pk_bf16_f32 v19, v24, v25
  v_cvt_pk_bf16_f32 v131, v26, v27
  v_fma_f32 v24, -v136, v33, v2
  v_fma_f32 v25, -v137, v33, v2
  v_fma_f32 v26, v136, v33, v1
  v_fma_f32 v27, v137, v33, v1
  v_exp_f32 v24, v24
  v_exp_f32 v25, v25
  v_exp_f32 v26, v26
  v_exp_f32 v27, v27
  v_cvt_pk_bf16_f32 v136, v24, v25
  v_cvt_pk_bf16_f32 v132, v26, v27
  v_fma_f32 v24, -v138, v33, v2
  v_fma_f32 v25, -v139, v33, v2
  v_fma_f32 v26, v138, v33, v1
  v_fma_f32 v27, v139, v33, v1
  v_exp_f32 v24, v24
  v_exp_f32 v25, v25
  v_exp_f32 v26, v26
  v_exp_f32 v27, v27
  v_cvt_pk_bf16_f32 v137, v24, v25
  v_cvt_pk_bf16_f32 v133, v26, v27
  v_fma_f32 v24, -v140, v33, v2
  v_fma_f32 v25, -v141, v33, v2
  v_fma_f32 v26, v140, v33, v1
  v_fma_f32 v27, v141, v33, v1
  v_exp_f32 v24, v24
  v_exp_f32 v25, v25
  v_exp_f32 v26, v26
  v_exp_f32 v27, v27
  v_cvt_pk_bf16_f32 v138, v24, v25
  v_cvt_pk_bf16_f32 v134, v26, v27
  v_fma_f32 v24, -v142, v33, v2
  v_fma_f32 v25, -v143, v33, v2
  v_fma_f32 v26, v142, v33, v1
  v_fma_f32 v27, v143, v33, v1
  v_exp_f32 v24, v24
  v_exp_f32 v25, v25
  v_exp_f32 v26, v26
  v_exp_f32 v27, v27
  v_cvt_pk_bf16_f32 v139, v24, v25
  v_cvt_pk_bf16_f32 v135, v26, v27
  v_mov_b32 v140, v16
  v_mov_b32 v141, v17
  v_mov_b32 v142, v18
  v_mov_b32 v143, v19
  s_lshl_b32 s82, s96, 15
  s_add_u32 s83, s82, 90112
  v_add_u32 v14, s83, v7
  s_sub_u32 s83, 122880, s82
  v_add_u32 v15, s83, v7
  s_lshl_b32 s84, s96, 13
  v_mov_b32 v13, 0x358637bd
  s_waitcnt lgkmcnt(0)
  s_barrier
  ds_read_b128 v[38:41], v14 offset:0
  ds_read_b128 v[42:45], v14 offset:1024
  ds_read_b128 v[46:49], v14 offset:2048
  ds_read_b128 v[50:53], v14 offset:3072
  ds_read_b128 v[54:57], v14 offset:16384
  ds_read_b128 v[58:61], v14 offset:17408
  ds_read_b128 v[16:19], v14 offset:18432
  ds_read_b128 v[20:23], v14 offset:19456
  s_waitcnt lgkmcnt(7)
  v_mfma_f32_32x32x16_bf16 v[144:159], v[38:41], v[80:83], 0
  s_waitcnt lgkmcnt(5)
  v_mfma_f32_32x32x16_bf16 v[160:175], v[46:49], v[92:95], 0
  v_mfma_f32_32x32x16_bf16 v[144:159], v[42:45], v[84:87], v[144:159]
  s_waitcnt lgkmcnt(4)
  v_mfma_f32_32x32x16_bf16 v[160:175], v[50:53], v[88:91], v[160:175]
  ds_read_b128 v[38:41], v15 offset:0
  ds_read_b128 v[42:45], v15 offset:1024
  ds_read_b128 v[46:49], v15 offset:2048
  ds_read_b128 v[50:53], v15 offset:3072
  s_waitcnt lgkmcnt(7)
  v_mfma_f32_32x32x16_bf16 v[176:191], v[54:57], v[96:99], 0
  s_waitcnt lgkmcnt(5)
  v_mfma_f32_32x32x16_bf16 v[192:207], v[16:19], v[108:111], 0
  v_mfma_f32_32x32x16_bf16 v[176:191], v[58:61], v[100:103], v[176:191]
  s_nop 0
  v_rcp_f32 v1, v157
  s_nop 0
  v_rcp_f32 v2, v173
  v_fma_f32 v3, v156, v1, v13
  v_fma_f32 v3, v172, v2, v3
  v_rcp_f32 v3, v3
  s_xor_b32 s86, s84, 0
  s_waitcnt lgkmcnt(4)
  v_mfma_f32_32x32x16_bf16 v[192:207], v[20:23], v[104:107], v[192:207]
  v_mul_f32 v1, v1, v3
  v_mul_f32 v2, v2, v3
  v_mov_b32 v3, v1
  v_mov_b32 v4, v2
  s_nop 0
  v_permlane32_swap_b32 v3, v1
  v_permlane32_swap_b32 v4, v2
  v_mul_f32 v3, v1, v32
  v_mul_f32 v4, v2, v32
  v_mul_f32 v144, v144, v1
  ds_read_b128 v[54:57], v15 offset:16384
  ds_read_b128 v[58:61], v15 offset:17408
  ds_read_b128 v[16:19], v15 offset:18432
  ds_read_b128 v[20:23], v15 offset:19456
  s_waitcnt lgkmcnt(7)
  v_mfma_f32_32x32x16_bf16 v[208:223], v[38:41], v[112:115], 0
  v_mul_f32 v145, v145, v1
  v_fma_f32 v144, v160, v2, v144
  v_fma_f32 v145, v161, v2, v145
  v_mul_f32 v146, v146, v1
  v_mul_f32 v147, v147, v1
  v_fma_f32 v146, v162, v2, v146
  v_fma_f32 v147, v163, v2, v147
  v_cvt_pk_bf16_f32 v80, v144, v145
  v_mul_f32 v148, v148, v1
  s_waitcnt lgkmcnt(5)
  v_mfma_f32_32x32x16_bf16 v[224:239], v[46:49], v[124:127], 0
  v_mul_f32 v149, v149, v1
  v_fma_f32 v148, v164, v2, v148
  v_fma_f32 v149, v165, v2, v149
  v_cvt_pk_bf16_f32 v81, v146, v147
  v_mul_f32 v150, v150, v1
  v_mul_f32 v151, v151, v1
  v_fma_f32 v150, v166, v2, v150
  v_fma_f32 v151, v167, v2, v151
  v_cvt_pk_bf16_f32 v82, v148, v149
  v_mfma_f32_32x32x16_bf16 v[208:223], v[42:45], v[116:119], v[208:223]
  v_mul_f32 v152, v152, v1
  v_mul_f32 v153, v153, v1
  v_fma_f32 v152, v168, v2, v152
  v_fma_f32 v153, v169, v2, v153
  v_cvt_pk_bf16_f32 v83, v150, v151
  v_mul_f32 v154, v154, v1
  v_mul_f32 v155, v155, v1
  v_fma_f32 v154, v170, v2, v154
  v_fma_f32 v155, v171, v2, v155
  s_waitcnt lgkmcnt(4)
  v_mfma_f32_32x32x16_bf16 v[224:239], v[50:53], v[120:123], v[224:239]
  v_cvt_pk_bf16_f32 v84, v152, v153
  v_mul_f32 v156, v156, v3
  v_mul_f32 v157, v157, v3
  v_fma_f32 v156, v172, v4, v156
  v_fma_f32 v157, v173, v4, v157
  v_cvt_pk_bf16_f32 v85, v154, v155
  v_mul_f32 v158, v158, v3
  v_mul_f32 v159, v159, v3
  v_fma_f32 v158, v174, v4, v158
  s_waitcnt lgkmcnt(3)
  v_mfma_f32_32x32x16_bf16 v[240:255], v[54:57], v[128:131], 0
  v_fma_f32 v159, v175, v4, v159
  v_cvt_pk_bf16_f32 v86, v156, v157
  v_cvt_pk_bf16_f32 v87, v158, v159
  buffer_store_dwordx4 v[80:83], v11, s[36:39], s86 offen sc1
  buffer_store_dwordx4 v[84:87], v11, s[36:39], s86 offen offset:1024 sc1
  s_waitcnt lgkmcnt(1)
  v_mfma_f32_32x32x16_bf16 v[64:79], v[16:19], v[140:143], 0
  v_rcp_f32 v24, v189
  v_rcp_f32 v25, v205
  v_fma_f32 v26, v188, v24, v13
  v_fma_f32 v26, v204, v25, v26
  v_rcp_f32 v26, v26
  s_xor_b32 s86, s84, 4096
  v_mfma_f32_32x32x16_bf16 v[240:255], v[58:61], v[132:135], v[240:255]
  v_mul_f32 v24, v24, v26
  v_mul_f32 v25, v25, v26
  v_mov_b32 v26, v24
  v_mov_b32 v27, v25
  s_nop 0
  v_permlane32_swap_b32 v26, v24
  v_permlane32_swap_b32 v27, v25
  v_mul_f32 v26, v24, v32
  v_mul_f32 v27, v25, v32
  v_mul_f32 v176, v176, v24
  s_waitcnt lgkmcnt(0)
  v_mfma_f32_32x32x16_bf16 v[64:79], v[20:23], v[136:139], v[64:79]
  v_mul_f32 v177, v177, v24
  v_fma_f32 v176, v192, v25, v176
  v_fma_f32 v177, v193, v25, v177
  v_mul_f32 v178, v178, v24
  v_mul_f32 v179, v179, v24
  v_fma_f32 v178, v194, v25, v178
  v_fma_f32 v179, v195, v25, v179
  v_cvt_pk_bf16_f32 v96, v176, v177
  v_mul_f32 v180, v180, v24
  v_mul_f32 v181, v181, v24
  v_fma_f32 v180, v196, v25, v180
  v_fma_f32 v181, v197, v25, v181
  v_cvt_pk_bf16_f32 v97, v178, v179
  v_mul_f32 v182, v182, v24
  v_mul_f32 v183, v183, v24
  v_fma_f32 v182, v198, v25, v182
  v_fma_f32 v183, v199, v25, v183
  v_cvt_pk_bf16_f32 v98, v180, v181
  v_mul_f32 v184, v184, v24
  v_mul_f32 v185, v185, v24
  v_fma_f32 v184, v200, v25, v184
  v_fma_f32 v185, v201, v25, v185
  v_cvt_pk_bf16_f32 v99, v182, v183
  v_mul_f32 v186, v186, v24
  v_mul_f32 v187, v187, v24
  v_fma_f32 v186, v202, v25, v186
  v_fma_f32 v187, v203, v25, v187
  v_cvt_pk_bf16_f32 v100, v184, v185
  v_mul_f32 v188, v188, v26
  v_mul_f32 v189, v189, v26
  v_fma_f32 v188, v204, v27, v188
  v_fma_f32 v189, v205, v27, v189
  v_cvt_pk_bf16_f32 v101, v186, v187
  v_mul_f32 v190, v190, v26
  v_mul_f32 v191, v191, v26
  v_fma_f32 v190, v206, v27, v190
  v_fma_f32 v191, v207, v27, v191
  v_cvt_pk_bf16_f32 v102, v188, v189
  v_cvt_pk_bf16_f32 v103, v190, v191
  buffer_store_dwordx4 v[96:99], v11, s[36:39], s86 offen sc1
  buffer_store_dwordx4 v[100:103], v11, s[36:39], s86 offen offset:1024 sc1
  v_rcp_f32 v28, v221
  v_rcp_f32 v29, v237
  v_fma_f32 v30, v220, v28, v13
  v_fma_f32 v30, v236, v29, v30
  v_rcp_f32 v30, v30
  s_xor_b32 s86, s84, 8192
  v_mul_f32 v28, v28, v30
  v_mul_f32 v29, v29, v30
  v_mov_b32 v30, v28
  v_mov_b32 v31, v29
  s_nop 0
  v_permlane32_swap_b32 v30, v28
  v_permlane32_swap_b32 v31, v29
  v_mul_f32 v30, v28, v32
  v_mul_f32 v31, v29, v32
  v_mul_f32 v208, v208, v28
  v_mul_f32 v209, v209, v28
  v_fma_f32 v208, v224, v29, v208
  v_fma_f32 v209, v225, v29, v209
  v_mul_f32 v210, v210, v28
  v_mul_f32 v211, v211, v28
  v_fma_f32 v210, v226, v29, v210
  v_fma_f32 v211, v227, v29, v211
  v_cvt_pk_bf16_f32 v112, v208, v209
  v_mul_f32 v212, v212, v28
  v_mul_f32 v213, v213, v28
  v_fma_f32 v212, v228, v29, v212
  v_fma_f32 v213, v229, v29, v213
  v_cvt_pk_bf16_f32 v113, v210, v211
  v_mul_f32 v214, v214, v28
  v_mul_f32 v215, v215, v28
  v_fma_f32 v214, v230, v29, v214
  v_fma_f32 v215, v231, v29, v215
  v_cvt_pk_bf16_f32 v114, v212, v213
  v_mul_f32 v216, v216, v28
  v_mul_f32 v217, v217, v28
  v_fma_f32 v216, v232, v29, v216
  v_fma_f32 v217, v233, v29, v217
  v_cvt_pk_bf16_f32 v115, v214, v215
  v_mul_f32 v218, v218, v28
  v_mul_f32 v219, v219, v28
  v_fma_f32 v218, v234, v29, v218
  v_fma_f32 v219, v235, v29, v219
  v_cvt_pk_bf16_f32 v116, v216, v217
  v_mul_f32 v220, v220, v30
  v_mul_f32 v221, v221, v30
  v_fma_f32 v220, v236, v31, v220
  v_fma_f32 v221, v237, v31, v221
  v_cvt_pk_bf16_f32 v117, v218, v219
  v_mul_f32 v222, v222, v30
  v_mul_f32 v223, v223, v30
  v_fma_f32 v222, v238, v31, v222
  v_fma_f32 v223, v239, v31, v223
  v_cvt_pk_bf16_f32 v118, v220, v221
  v_cvt_pk_bf16_f32 v119, v222, v223
  buffer_store_dwordx4 v[112:115], v11, s[36:39], s86 offen sc1
  buffer_store_dwordx4 v[116:119], v11, s[36:39], s86 offen offset:1024 sc1
  v_rcp_f32 v33, v253
  v_rcp_f32 v34, v77
  v_fma_f32 v35, v252, v33, v13
  v_fma_f32 v35, v76, v34, v35
  v_rcp_f32 v35, v35
  s_xor_b32 s86, s84, 12288
  v_mul_f32 v33, v33, v35
  v_mul_f32 v34, v34, v35
  v_mov_b32 v35, v33
  v_mov_b32 v36, v34
  s_nop 0
  v_permlane32_swap_b32 v35, v33
  v_permlane32_swap_b32 v36, v34
  v_mul_f32 v35, v33, v32
  v_mul_f32 v36, v34, v32
  v_mul_f32 v240, v240, v33
  v_mul_f32 v241, v241, v33
  v_fma_f32 v240, v64, v34, v240
  v_fma_f32 v241, v65, v34, v241
  v_mul_f32 v242, v242, v33
  v_mul_f32 v243, v243, v33
  v_fma_f32 v242, v66, v34, v242
  v_fma_f32 v243, v67, v34, v243
  v_cvt_pk_bf16_f32 v128, v240, v241
  v_mul_f32 v244, v244, v33
  v_mul_f32 v245, v245, v33
  v_fma_f32 v244, v68, v34, v244
  v_fma_f32 v245, v69, v34, v245
  v_cvt_pk_bf16_f32 v129, v242, v243
  v_mul_f32 v246, v246, v33
  v_mul_f32 v247, v247, v33
  v_fma_f32 v246, v70, v34, v246
  v_fma_f32 v247, v71, v34, v247
  v_cvt_pk_bf16_f32 v130, v244, v245
  v_mul_f32 v248, v248, v33
  v_mul_f32 v249, v249, v33
  v_fma_f32 v248, v72, v34, v248
  v_fma_f32 v249, v73, v34, v249
  v_cvt_pk_bf16_f32 v131, v246, v247
  v_mul_f32 v250, v250, v33
  v_mul_f32 v251, v251, v33
  v_fma_f32 v250, v74, v34, v250
  v_fma_f32 v251, v75, v34, v251
  v_cvt_pk_bf16_f32 v132, v248, v249
  v_mul_f32 v252, v252, v35
  v_mul_f32 v253, v253, v35
  v_fma_f32 v252, v76, v36, v252
  v_fma_f32 v253, v77, v36, v253
  v_cvt_pk_bf16_f32 v133, v250, v251
  v_mul_f32 v254, v254, v35
  v_mul_f32 v255, v255, v35
  v_fma_f32 v254, v78, v36, v254
  v_fma_f32 v255, v79, v36, v255
  v_cvt_pk_bf16_f32 v134, v252, v253
  v_cvt_pk_bf16_f32 v135, v254, v255
  buffer_store_dwordx4 v[128:131], v11, s[36:39], s86 offen sc1
  buffer_store_dwordx4 v[132:135], v11, s[36:39], s86 offen offset:1024 sc1
  s_waitcnt vmcnt(0)
  s_barrier
  s_cmp_lg_u32 s74, 0
  s_cbranch_scc1 L_flag_14
  s_lshl_b32 s83, s70, 7
  s_lshl_b32 s82, s79, 2
  s_add_u32 s83, s83, s82
  s_add_u32 s83, s83, 21504
  v_mov_b32 v5, s80
  v_lshlrev_b32 v6, 24, v7
  buffer_store_dword v5, v6, s[36:39], s83 offen sc1
L_flag_14:
  s_endpgm
L_p3:
  s_and_b32 s82, s2, 7
  s_lshr_b32 s83, s2, 3
  s_and_b32 s84, s82, 3
  s_lshl_b32 s84, s84, 2
  s_add_u32 s84, s84, s83
  s_sub_u32 s84, s84, 28
  s_lshr_b32 s79, s84, 3
  s_and_b32 s84, s84, 7
  s_lshr_b32 s70, s82, 2
  s_lshl_b32 s70, s70, 3
  s_add_u32 s70, s70, s84
  s_add_u32 s71, s79, 14
  s_mov_b32 s96, 0x76543210
  s_mov_b32 s97, 0xfedcba98
  s_lshl_b32 s82, s71, 2
  s_lshr_b64 s[96:97], s[96:97], s82
  s_and_b32 s72, s96, 15
  s_and_b32 s82, s71, 1
  s_mul_i32 s82, s82, 4
  s_and_b32 s84, s84, 7
  s_mul_i32 s84, s84, 1
  s_add_u32 s82, s82, s84
  s_mov_b32 s96, 0
  s_mul_i32 s85, s82, 37
  s_lshr_b32 s85, s85, 8
  s_mul_i32 s85, s85, 7
  s_sub_u32 s82, s82, s85
  s_mov_b32 s84, 0x06543210
  s_mov_b32 s85, 0x00654321
  s_lshl_b32 s82, s82, 2
  s_lshr_b64 s[84:85], s[84:85], s82
  s_mov_b32 s95, s84
  s_and_b32 s74, s73, 3
  s_lshr_b32 s75, s73, 2
  s_lshl_b32 s3, s74, 10
  s_lshl_b32 s94, s74, 11
  v_lshrrev_b32 v1, 3, v0
  v_and_b32 v2, 7, v0
  v_lshrrev_b32 v4, 1, v1
  v_xor_b32 v4, v4, v2
  s_lshl_b32 s83, s70, 3
  s_add_u32 s83, s83, s74
  s_lshl_b32 s83, s83, 4
  v_add_u32 v5, s83, v1
  v_mul_u32_u24 v5, 896, v5
  v_lshl_add_u32 v15, v4, 4, v5
  v_xor_b32 v4, 4, v4
  v_lshl_add_u32 v24, v4, 4, v5
  v_add_u32 v24, 6144, v24
  v_lshrrev_b32 v4, 2, v0
  s_lshl_b32 s82, s74, 4
  v_add_u32 v4, s82, v4
  v_mul_u32_u24 v4, 2688, v4
  s_mul_i32 s82, s72, 56
  s_and_b32 s99, s82, 8
  s_and_b32 s82, s82, 0xfff0
  s_add_u32 s82, s82, 896
  v_and_b32 v5, 3, v0
  v_lshlrev_b32 v5, 4, v5
  v_add3_u32 v14, v4, v5, s82
  s_mov_b32 s6, 1835008
  s_mov_b32 s7, 0x20000
  s_mov_b32 s10, 1204224
  s_mov_b32 s11, 0x20000
  s_mov_b32 s30, 25088
  s_mov_b32 s31, 0x20000
  s_mov_b32 s26, 401408
  s_mov_b32 s27, 0x20000
  s_mov_b32 s14, 1605632
  s_mov_b32 s15, 0x20000
  s_mov_b32 s18, 1605632
  s_mov_b32 s19, 0x20000
  s_mov_b32 s22, 1605632
  s_mov_b32 s23, 0x20000
  s_mov_b32 s34, 1835008
  s_mov_b32 s35, 0x20000
  s_mov_b32 s42, 256
  s_mov_b32 s43, 0x20000
  s_mov_b32 s38, 20971520
  s_mov_b32 s39, 0x20000
  s_waitcnt lgkmcnt(0)
  s_mov_b64 s[4:5], s[48:49]
  s_mov_b64 s[8:9], s[50:51]
  v_lshrrev_b32 v1, 4, v0
  v_and_b32 v2, 15, v0
  v_lshrrev_b32 v3, 5, v0
  v_and_b32 v4, 31, v0
  s_lshl_b32 s82, s75, 1
  s_add_u32 s82, s82, s74
  v_and_b32 v52, 1, v1
  v_lshlrev_b32 v5, 5, v52
  v_and_b32 v6, 3, v2
  v_lshl_add_u32 v5, v6, 3, v5
  v_cmp_eq_u32 vcc, v52, v2
  v_lshrrev_b32 v6, 2, v2
  v_lshl_add_u32 v6, v3, 3, v6
  v_mov_b32 v1, 0x3f803f80
  v_min_u32 v26, 48, v5
  v_lshl_add_u32 v26, v6, 6, v26
  s_lshl_b32 s83, s75, 12
  s_add_u32 s83, s83, s99
  v_add_u32 v26, s83, v26
  v_cndmask_b32 v52, 0, v1, vcc
  s_lshl_b32 s83, s74, 5
  v_add_u32 v4, s83, v4
  v_bfe_u32 v6, v4, 1, 3
  v_xor_b32 v6, v6, v3
  v_lshlrev_b32 v6, 4, v6
  v_lshl_add_u32 v6, v4, 7, v6
  s_add_u32 s83, s82, 0
  s_and_b32 s83, s83, 3
  s_lshl_b32 s84, s83, 5
  v_xor_b32 v20, s84, v6
  v_lshl_add_u32 v16, s83, 10, v26
  s_add_u32 s83, s82, 1
  s_and_b32 s83, s83, 3
  s_lshl_b32 s84, s83, 5
  v_xor_b32 v21, s84, v6
  v_lshl_add_u32 v17, s83, 10, v26
  s_add_u32 s83, s82, 2
  s_and_b32 s83, s83, 3
  s_lshl_b32 s84, s83, 5
  v_xor_b32 v22, s84, v6
  v_lshl_add_u32 v18, s83, 10, v26
  s_add_u32 s83, s82, 3
  s_and_b32 s83, s83, 3
  s_lshl_b32 s84, s83, 5
  v_xor_b32 v23, s84, v6
  v_lshl_add_u32 v19, s83, 10, v26
  v_mov_b32 v53, v52
  v_mov_b32 v54, v52
  v_mov_b32 v55, v52
  v_mov_b32 v1, 0
  v_mov_b32 v2, 0
  v_mov_b32 v3, 0
  v_mov_b32 v4, 0
  s_mov_b64 s[28:29], s[52:53]
  s_mov_b64 s[24:25], s[54:55]
  s_mov_b64 s[12:13], s[58:59]
  s_mov_b64 s[16:17], s[60:61]
  s_mov_b64 s[20:21], s[62:63]
  s_mov_b64 s[32:33], s[64:65]
  s_mov_b64 s[40:41], s[66:67]
  s_mov_b64 s[36:37], s[68:69]
  v_bfe_u32 v65, v7, 4, 4
  v_bfe_u32 v66, v7, 9, 1
  v_bfe_u32 v67, v7, 4, 5
  v_bfe_u32 v68, v7, 8, 1
  v_lshlrev_b32 v68, 5, v68
  v_and_b32 v70, 3, v65
  v_lshl_add_u32 v68, v70, 3, v68
  s_lshl_b32 s83, s74, 5
  v_add_u32 v69, s83, v67
  s_lshl_b32 s78, s70, 1
  s_add_u32 s78, s78, s79
  s_bfe_u32 s44, s95, 0x40000
  s_mul_i32 s44, s44, 172032
  s_bfe_u32 s45, s95, 0x40004
  s_mul_i32 s45, s45, 172032
  s_bfe_u32 s46, s95, 0x40008
  s_mul_i32 s46, s46, 172032
  s_bfe_u32 s47, s95, 0x4000c
  s_mul_i32 s47, s47, 172032
  s_bfe_u32 s48, s95, 0x40010
  s_mul_i32 s48, s48, 172032
  s_bfe_u32 s49, s95, 0x40014
  s_mul_i32 s49, s49, 172032
  s_bfe_u32 s50, s95, 0x40018
  s_mul_i32 s50, s50, 172032
  v_lshrrev_b32 v70, 7, v7
  v_bfe_u32 v71, v7, 4, 3
  v_and_b32 v72, 2, v70
  v_lshlrev_b32 v72, 1, v72
  v_xor_b32 v71, v71, v72
  s_lshl_b32 s82, s74, 4
  v_add_u32 v70, s82, v70
  v_min_u32 v71, 6, v71
  s_mul_i32 s82, s79, 448
  s_mul_i32 s83, s96, 224
  s_add_u32 s82, s82, s83
  s_mul_i32 s97, s96, 448
  s_sub_u32 s97, 112, s97
  v_mul_u32_u24 v72, 2688, v70
  v_lshl_add_u32 v72, v71, 4, v72
  v_add_u32 v13, s82, v72
  v_add_u32 v0, 20480, v13
  v_bfe_u32 v70, v7, 4, 3
  v_cmp_ne_u32 vcc, 7, v70
  v_mov_b32 v71, 1.0
  v_bfe_u32 v70, v7, 8, 2
  v_cndmask_b32 v76, 0, v71, vcc
  s_lshl_b32 s82, s70, 1
  v_add_u32 v70, s82, v70
  v_cmp_eq_u32 vcc, 29, v70
  v_lshrrev_b32 v75, 9, v7
  v_or_b32 v75, s74, v75
  v_cndmask_b32 v76, 0, v76, vcc
  v_lshl_add_u32 v75, v75, 28, v7
  v_mov_b32 v77, v76
  v_mov_b32 v78, v76
  v_mov_b32 v79, v76
  v_min_u32 v70, 48, v68
  v_add_u32 v70, 56, v70
  v_and_b32 v71, 8, v65
  v_lshlrev_b32 v71, 3, v71
  v_xor_b32 v70, v70, v71
  v_lshrrev_b32 v72, 2, v65
  v_lshl_add_u32 v64, v66, 3, v72
  v_lshl_add_u32 v70, v64, 7, v70
  s_add_u32 s83, s74, 2
  s_and_b32 s83, s83, 3
  v_lshl_add_u32 v28, s83, 11, v70
  s_add_u32 s83, s74, 3
  s_and_b32 s83, s83, 3
  v_lshl_add_u32 v29, s83, 11, v70
  s_add_u32 s83, s74, 4
  s_and_b32 s83, s83, 3
  v_lshl_add_u32 v30, s83, 11, v70
  s_add_u32 s83, s74, 5
  s_and_b32 s83, s83, 3
  v_lshl_add_u32 v31, s83, 11, v70
  s_lshl_b32 s84, s74, 2
  s_add_u32 s84, s84, 156672
  v_add_u32 v70, s84, v7
  v_mov_b32 v10, 161792
  v_cmp_gt_u32 vcc, 256, v7
  v_lshlrev_b32 v9, 4, v67
  v_add_u32 v9, 156672, v9
  v_cndmask_b32 v10, v10, v70, vcc
  v_cmp_eq_u32 vcc, 0, v66
  v_mov_b32 v70, 1.0
  v_mov_b32 v49, 0
  v_cndmask_b32 v32, 0, v70, vcc
  v_mov_b32 v47, 0
  s_mov_b32 s100, -1
  s_mov_b32 s101, 0
  s_lshl_b32 s83, s70, 2
  s_add_u32 s83, s83, s74
  s_mul_i32 s83, s83, 144
  s_lshl_b32 s84, s79, 4
  s_add_u32 s83, s83, s84
  s_add_u32 s83, s83, 114
  s_lshl_b32 s83, s83, 10
  s_add_u32 s83, s83, 3145728
  v_add_u32 v11, s83, v7
  v_bfe_u32 v70, v67, 2, 1
  v_bfe_u32 v71, v67, 3, 1
  v_lshl_or_b32 v70, v71, 1, v70
  v_lshlrev_b32 v70, 4, v70
  v_lshl_add_u32 v70, v69, 6, v70
  v_lshl_add_u32 v70, v66, 3, v70
  v_add_u32 v8, 147456, v70
  s_setprio 1
  s_barrier
  ds_read_b128 v[144:147], v20 offset:0
  ds_read_b64_tr_b16 v[96:97], v16 offset:16384
  ds_read_b64_tr_b16 v[98:99], v16 offset:16640
  ds_read_b128 v[148:151], v21 offset:0
  ds_read_b64_tr_b16 v[100:101], v17 offset:16384
  ds_read_b64_tr_b16 v[102:103], v17 offset:16640
  ds_read_b128 v[152:155], v22 offset:0
  ds_read_b64_tr_b16 v[104:105], v18 offset:16384
  ds_read_b64_tr_b16 v[106:107], v18 offset:16640
  ds_read_b128 v[156:159], v23 offset:0
  ds_read_b64_tr_b16 v[108:109], v19 offset:16384
  ds_read_b64_tr_b16 v[110:111], v19 offset:16640
  s_bfe_u32 s86, s95, 0x40008
  s_add_u32 m0, s94, 49152
  s_lshl_b32 s86, s86, 7
  buffer_load_dwordx4 v15, s[4:7], s86 offen lds
  buffer_load_dwordx4 v24, s[4:7], s86 offen offset:1024 lds
  s_add_u32 m0, s94, 57344
  s_add_u32 s86, s86, 57344
  buffer_load_dwordx4 v15, s[4:7], s86 offen lds
  buffer_load_dwordx4 v24, s[4:7], s86 offen offset:1024 lds
  s_bfe_u32 s86, s95, 0x40008
  s_add_u32 m0, s3, 65536
  s_mul_i32 s86, s86, 172032
  buffer_load_dwordx4 v14, s[8:11], s86 offen lds
  s_add_u32 m0, s3, 68736
  s_nop 0
  buffer_load_dwordx4 v14, s[8:11], s86 offen offset:896 lds
  s_waitcnt lgkmcnt(0)
  s_barrier
  v_dot2c_f32_bf16 v1, 0x3f803f80, v144
  v_dot2c_f32_bf16 v3, v144, v144
  v_dot2c_f32_bf16 v2, 0x3f803f80, v145
  v_dot2c_f32_bf16 v4, v145, v145
  v_dot2c_f32_bf16 v1, 0x3f803f80, v146
  v_dot2c_f32_bf16 v3, v146, v146
  v_dot2c_f32_bf16 v2, 0x3f803f80, v147
  v_dot2c_f32_bf16 v4, v147, v147
  v_dot2c_f32_bf16 v1, 0x3f803f80, v148
  v_dot2c_f32_bf16 v3, v148, v148
  v_dot2c_f32_bf16 v2, 0x3f803f80, v149
  v_dot2c_f32_bf16 v4, v149, v149
  v_dot2c_f32_bf16 v1, 0x3f803f80, v150
  v_dot2c_f32_bf16 v3, v150, v150
  v_dot2c_f32_bf16 v2, 0x3f803f80, v151
  v_dot2c_f32_bf16 v4, v151, v151
  v_mfma_f32_16x16x32_bf16 v[56:59], v[52:55], v[96:99], 0
  v_mfma_f32_32x32x16_bf16 v[112:127], v[96:99], v[144:147], 0
  ds_read_b128 v[160:163], v20 offset:24576
  ds_read_b64_tr_b16 v[80:81], v16 offset:40960
  ds_read_b64_tr_b16 v[82:83], v16 offset:41216
  s_bfe_u32 s86, s95, 0x4000c
  s_add_u32 m0, s94, 0
  s_lshl_b32 s86, s86, 7
  buffer_load_dwordx4 v15, s[4:7], s86 offen lds
  buffer_load_dwordx4 v24, s[4:7], s86 offen offset:1024 lds
  v_mfma_f32_32x32x16_bf16 v[112:127], v[100:103], v[148:151], v[112:127]
  ds_read_b128 v[164:167], v21 offset:24576
  ds_read_b64_tr_b16 v[84:85], v17 offset:40960
  ds_read_b64_tr_b16 v[86:87], v17 offset:41216
  s_add_u32 m0, s94, 8192
  s_add_u32 s86, s86, 57344
  buffer_load_dwordx4 v15, s[4:7], s86 offen lds
  buffer_load_dwordx4 v24, s[4:7], s86 offen offset:1024 lds
  v_mfma_f32_32x32x16_bf16 v[112:127], v[104:107], v[152:155], v[112:127]
  ds_read_b128 v[168:171], v22 offset:24576
  ds_read_b64_tr_b16 v[88:89], v18 offset:40960
  ds_read_b64_tr_b16 v[90:91], v18 offset:41216
  s_bfe_u32 s86, s95, 0x4000c
  s_add_u32 m0, s3, 16384
  s_mul_i32 s86, s86, 172032
  buffer_load_dwordx4 v14, s[8:11], s86 offen lds
  s_add_u32 m0, s3, 19584
  s_nop 0
  buffer_load_dwordx4 v14, s[8:11], s86 offen offset:896 lds
  v_mfma_f32_32x32x16_bf16 v[112:127], v[108:111], v[156:159], v[112:127]
  ds_read_b128 v[172:175], v23 offset:24576
  ds_read_b64_tr_b16 v[92:93], v19 offset:40960
  ds_read_b64_tr_b16 v[94:95], v19 offset:41216
  s_waitcnt vmcnt(6) lgkmcnt(0)
  s_barrier
  v_dot2c_f32_bf16 v1, 0x3f803f80, v160
  v_dot2c_f32_bf16 v3, v160, v160
  v_dot2c_f32_bf16 v2, 0x3f803f80, v161
  v_dot2c_f32_bf16 v4, v161, v161
  v_dot2c_f32_bf16 v1, 0x3f803f80, v162
  v_dot2c_f32_bf16 v3, v162, v162
  v_dot2c_f32_bf16 v2, 0x3f803f80, v163
  v_dot2c_f32_bf16 v4, v163, v163
  v_dot2c_f32_bf16 v1, 0x3f803f80, v164
  v_dot2c_f32_bf16 v3, v164, v164
  v_dot2c_f32_bf16 v2, 0x3f803f80, v165
  v_dot2c_f32_bf16 v4, v165, v165
  v_dot2c_f32_bf16 v1, 0x3f803f80, v166
  v_dot2c_f32_bf16 v3, v166, v166
  v_dot2c_f32_bf16 v2, 0x3f803f80, v167
  v_dot2c_f32_bf16 v4, v167, v167
  v_mfma_f32_16x16x32_bf16 v[56:59], v[52:55], v[80:83], v[56:59]
  v_mfma_f32_32x32x16_bf16 v[112:127], v[80:83], v[160:163], v[112:127]
  v_add_u32 v16, 0x10000, v16
  v_add_u32 v17, 0x10000, v17
  v_add_u32 v18, 0x10000, v18
  v_add_u32 v19, 0x10000, v19
  ds_read_b128 v[176:179], v20 offset:49152
  ds_read_b64_tr_b16 v[96:97], v16 offset:0
  ds_read_b64_tr_b16 v[98:99], v16 offset:256
  v_mfma_f32_32x32x16_bf16 v[112:127], v[84:87], v[164:167], v[112:127]
  ds_read_b128 v[180:183], v21 offset:49152
  ds_read_b64_tr_b16 v[100:101], v17 offset:0
  ds_read_b64_tr_b16 v[102:103], v17 offset:256
  v_mfma_f32_32x32x16_bf16 v[112:127], v[88:91], v[168:171], v[112:127]
  ds_read_b128 v[184:187], v22 offset:49152
  ds_read_b64_tr_b16 v[104:105], v18 offset:0
  ds_read_b64_tr_b16 v[106:107], v18 offset:256
  v_mfma_f32_32x32x16_bf16 v[112:127], v[92:95], v[172:175], v[112:127]
  ds_read_b128 v[188:191], v23 offset:49152
  ds_read_b64_tr_b16 v[108:109], v19 offset:0
  ds_read_b64_tr_b16 v[110:111], v19 offset:256
  s_mul_i32 s82, s72, 1568
  s_lshl_b32 s83, s73, 8
  s_add_u32 s82, s82, s83
  s_add_u32 m0, s83, 159744
  v_lshrrev_b32 v74, 2, v7
  buffer_load_dword v74, s[28:31], s82 offen lds
  s_lshl_b32 s82, s72, 4
  s_add_u32 s82, s82, s70
  s_lshl_b32 s82, s82, 9
  s_add_u32 s82, s82, 65536
  buffer_store_dwordx4 v[76:79], v75, s[36:39], s82 offen sc1
  s_waitcnt vmcnt(2) lgkmcnt(0)
  s_barrier
  v_dot2c_f32_bf16 v1, 0x3f803f80, v176
  v_dot2c_f32_bf16 v3, v176, v176
  v_dot2c_f32_bf16 v2, 0x3f803f80, v177
  v_dot2c_f32_bf16 v4, v177, v177
  v_dot2c_f32_bf16 v1, 0x3f803f80, v178
  v_dot2c_f32_bf16 v3, v178, v178
  v_dot2c_f32_bf16 v2, 0x3f803f80, v179
  v_dot2c_f32_bf16 v4, v179, v179
  v_dot2c_f32_bf16 v1, 0x3f803f80, v180
  v_dot2c_f32_bf16 v3, v180, v180
  v_dot2c_f32_bf16 v2, 0x3f803f80, v181
  v_dot2c_f32_bf16 v4, v181, v181
  v_dot2c_f32_bf16 v1, 0x3f803f80, v182
  v_dot2c_f32_bf16 v3, v182, v182
  v_dot2c_f32_bf16 v2, 0x3f803f80, v183
  v_dot2c_f32_bf16 v4, v183, v183
  v_mfma_f32_16x16x32_bf16 v[56:59], v[52:55], v[96:99], v[56:59]
  v_mfma_f32_32x32x16_bf16 v[112:127], v[96:99], v[176:179], v[112:127]
  v_add_u32 v16, 0xffff4000, v16
  v_add_u32 v17, 0xffff4000, v17
  v_add_u32 v18, 0xffff4000, v18
  v_add_u32 v19, 0xffff4000, v19
  ds_read_b128 v[192:195], v20 offset:0
  ds_read_b64_tr_b16 v[80:81], v16 offset:0
  ds_read_b64_tr_b16 v[82:83], v16 offset:256
  s_bfe_u32 s86, s95, 0x40014
  s_add_u32 m0, s94, 49152
  s_lshl_b32 s86, s86, 7
  buffer_load_dwordx4 v15, s[4:7], s86 offen lds
  buffer_load_dwordx4 v24, s[4:7], s86 offen offset:1024 lds
  v_mfma_f32_32x32x16_bf16 v[112:127], v[100:103], v[180:183], v[112:127]
  ds_read_b128 v[196:199], v21 offset:0
  ds_read_b64_tr_b16 v[84:85], v17 offset:0
  ds_read_b64_tr_b16 v[86:87], v17 offset:256
  s_add_u32 m0, s94, 57344
  s_add_u32 s86, s86, 57344
  buffer_load_dwordx4 v15, s[4:7], s86 offen lds
  buffer_load_dwordx4 v24, s[4:7], s86 offen offset:1024 lds
  v_mfma_f32_32x32x16_bf16 v[112:127], v[104:107], v[184:187], v[112:127]
  ds_read_b128 v[200:203], v22 offset:0
  ds_read_b64_tr_b16 v[88:89], v18 offset:0
  ds_read_b64_tr_b16 v[90:91], v18 offset:256
  s_bfe_u32 s86, s95, 0x40014
  s_add_u32 m0, s3, 65536
  s_mul_i32 s86, s86, 172032
  buffer_load_dwordx4 v14, s[8:11], s86 offen lds
  s_add_u32 m0, s3, 68736
  s_nop 0
  buffer_load_dwordx4 v14, s[8:11], s86 offen offset:896 lds
  v_mfma_f32_32x32x16_bf16 v[112:127], v[108:111], v[188:191], v[112:127]
  ds_read_b128 v[204:207], v23 offset:0
  ds_read_b64_tr_b16 v[92:93], v19 offset:0
  ds_read_b64_tr_b16 v[94:95], v19 offset:256
  s_waitcnt lgkmcnt(0)
  s_barrier
  v_dot2c_f32_bf16 v1, 0x3f803f80, v192
  v_dot2c_f32_bf16 v3, v192, v192
  v_dot2c_f32_bf16 v2, 0x3f803f80, v193
  v_dot2c_f32_bf16 v4, v193, v193
  v_dot2c_f32_bf16 v1, 0x3f803f80, v194
  v_dot2c_f32_bf16 v3, v194, v194
  v_dot2c_f32_bf16 v2, 0x3f803f80, v195
  v_dot2c_f32_bf16 v4, v195, v195
  v_dot2c_f32_bf16 v1, 0x3f803f80, v196
  v_dot2c_f32_bf16 v3, v196, v196
  v_dot2c_f32_bf16 v2, 0x3f803f80, v197
  v_dot2c_f32_bf16 v4, v197, v197
  v_dot2c_f32_bf16 v1, 0x3f803f80, v198
  v_dot2c_f32_bf16 v3, v198, v198
  v_dot2c_f32_bf16 v2, 0x3f803f80, v199
  v_dot2c_f32_bf16 v4, v199, v199
  v_mfma_f32_16x16x32_bf16 v[56:59], v[52:55], v[80:83], v[56:59]
  v_mfma_f32_32x32x16_bf16 v[112:127], v[80:83], v[192:195], v[112:127]
  ds_read_b128 v[208:211], v20 offset:24576
  ds_read_b64_tr_b16 v[96:97], v16 offset:24576
  ds_read_b64_tr_b16 v[98:99], v16 offset:24832
  v_mfma_f32_32x32x16_bf16 v[112:127], v[84:87], v[196:199], v[112:127]
  ds_read_b128 v[212:215], v21 offset:24576
  ds_read_b64_tr_b16 v[100:101], v17 offset:24576
  ds_read_b64_tr_b16 v[102:103], v17 offset:24832
  v_mfma_f32_32x32x16_bf16 v[112:127], v[88:91], v[200:203], v[112:127]
  ds_read_b128 v[216:219], v22 offset:24576
  ds_read_b64_tr_b16 v[104:105], v18 offset:24576
  ds_read_b64_tr_b16 v[106:107], v18 offset:24832
  v_mfma_f32_32x32x16_bf16 v[112:127], v[92:95], v[204:207], v[112:127]
  ds_read_b128 v[220:223], v23 offset:24576
  ds_read_b64_tr_b16 v[108:109], v19 offset:24576
  ds_read_b64_tr_b16 v[110:111], v19 offset:24832
  v_mov_b32 v5, 0
  buffer_load_dword v6, v5, s[40:43], 0 offen sc1
  s_waitcnt vmcnt(1) lgkmcnt(0)
  s_barrier
  v_dot2c_f32_bf16 v1, 0x3f803f80, v208
  v_dot2c_f32_bf16 v3, v208, v208
  v_dot2c_f32_bf16 v2, 0x3f803f80, v209
  v_dot2c_f32_bf16 v4, v209, v209
  v_dot2c_f32_bf16 v1, 0x3f803f80, v210
  v_dot2c_f32_bf16 v3, v210, v210
  v_dot2c_f32_bf16 v2, 0x3f803f80, v211
  v_dot2c_f32_bf16 v4, v211, v211
  v_dot2c_f32_bf16 v1, 0x3f803f80, v212
  v_dot2c_f32_bf16 v3, v212, v212
  v_dot2c_f32_bf16 v2, 0x3f803f80, v213
  v_dot2c_f32_bf16 v4, v213, v213
  v_dot2c_f32_bf16 v1, 0x3f803f80, v214
  v_dot2c_f32_bf16 v3, v214, v214
  v_dot2c_f32_bf16 v2, 0x3f803f80, v215
  v_dot2c_f32_bf16 v4, v215, v215
  v_mfma_f32_16x16x32_bf16 v[56:59], v[52:55], v[96:99], v[56:59]
  v_mfma_f32_32x32x16_bf16 v[112:127], v[96:99], v[208:211], v[112:127]
  ds_read_b128 v[224:227], v20 offset:49152
  ds_read_b64_tr_b16 v[80:81], v16 offset:49152
  ds_read_b64_tr_b16 v[82:83], v16 offset:49408
  s_add_u32 m0, s94, 24576
  s_nop 0
  buffer_load_dwordx4 v13, s[8:11], s44 offen lds
  buffer_load_dwordx4 v0, s[8:11], s44 offen offset:1024 lds
  v_mfma_f32_32x32x16_bf16 v[112:127], v[100:103], v[212:215], v[112:127]
  ds_read_b128 v[228:231], v21 offset:49152
  ds_read_b64_tr_b16 v[84:85], v17 offset:49152
  ds_read_b64_tr_b16 v[86:87], v17 offset:49408
  s_add_u32 m0, s94, 32768
  s_nop 0
  buffer_load_dwordx4 v13, s[8:11], s45 offen lds
  buffer_load_dwordx4 v0, s[8:11], s45 offen offset:1024 lds
  v_mfma_f32_32x32x16_bf16 v[112:127], v[104:107], v[216:219], v[112:127]
  ds_read_b128 v[232:235], v22 offset:49152
  ds_read_b64_tr_b16 v[88:89], v18 offset:49152
  ds_read_b64_tr_b16 v[90:91], v18 offset:49408
  s_add_u32 m0, s94, 40960
  s_nop 0
  buffer_load_dwordx4 v13, s[8:11], s46 offen lds
  buffer_load_dwordx4 v0, s[8:11], s46 offen offset:1024 lds
  v_mfma_f32_32x32x16_bf16 v[112:127], v[108:111], v[220:223], v[112:127]
  ds_read_b128 v[236:239], v23 offset:49152
  ds_read_b64_tr_b16 v[92:93], v19 offset:49152
  ds_read_b64_tr_b16 v[94:95], v19 offset:49408
  s_waitcnt lgkmcnt(0)
  s_barrier
  v_dot2c_f32_bf16 v1, 0x3f803f80, v224
  v_dot2c_f32_bf16 v3, v224, v224
  v_dot2c_f32_bf16 v2, 0x3f803f80, v225
  v_dot2c_f32_bf16 v4, v225, v225
  v_dot2c_f32_bf16 v1, 0x3f803f80, v226
  v_dot2c_f32_bf16 v3, v226, v226
  v_dot2c_f32_bf16 v2, 0x3f803f80, v227
  v_dot2c_f32_bf16 v4, v227, v227
  v_dot2c_f32_bf16 v1, 0x3f803f80, v228
  v_dot2c_f32_bf16 v3, v228, v228
  v_dot2c_f32_bf16 v2, 0x3f803f80, v229
  v_dot2c_f32_bf16 v4, v229, v229
  v_dot2c_f32_bf16 v1, 0x3f803f80, v230
  v_dot2c_f32_bf16 v3, v230, v230
  v_dot2c_f32_bf16 v2, 0x3f803f80, v231
  v_dot2c_f32_bf16 v4, v231, v231
  v_mfma_f32_16x16x32_bf16 v[56:59], v[52:55], v[80:83], v[56:59]
  v_mfma_f32_32x32x16_bf16 v[112:127], v[80:83], v[224:227], v[112:127]
  ds_read_b128 v[240:243], v20 offset:0
  ds_read_b64_tr_b16 v[96:97], v16 offset:0
  ds_read_b64_tr_b16 v[98:99], v16 offset:256
  s_add_u32 m0, s94, 49152
  s_nop 0
  buffer_load_dwordx4 v13, s[8:11], s47 offen lds
  buffer_load_dwordx4 v0, s[8:11], s47 offen offset:1024 lds
  v_mfma_f32_32x32x16_bf16 v[112:127], v[84:87], v[228:231], v[112:127]
  ds_read_b128 v[244:247], v21 offset:0
  ds_read_b64_tr_b16 v[100:101], v17 offset:0
  ds_read_b64_tr_b16 v[102:103], v17 offset:256
  s_add_u32 m0, s94, 57344
  s_nop 0
  buffer_load_dwordx4 v13, s[8:11], s48 offen lds
  buffer_load_dwordx4 v0, s[8:11], s48 offen offset:1024 lds
  v_mfma_f32_32x32x16_bf16 v[112:127], v[88:91], v[232:235], v[112:127]
  ds_read_b128 v[248:251], v22 offset:0
  ds_read_b64_tr_b16 v[104:105], v18 offset:0
  ds_read_b64_tr_b16 v[106:107], v18 offset:256
  s_add_u32 m0, s94, 65536
  s_nop 0
  buffer_load_dwordx4 v13, s[8:11], s49 offen lds
  buffer_load_dwordx4 v0, s[8:11], s49 offen offset:1024 lds
  v_mfma_f32_32x32x16_bf16 v[112:127], v[92:95], v[236:239], v[112:127]
  ds_read_b128 v[252:255], v23 offset:0
  ds_read_b64_tr_b16 v[108:109], v19 offset:0
  ds_read_b64_tr_b16 v[110:111], v19 offset:256
  s_waitcnt vmcnt(8) lgkmcnt(0)
  s_barrier
  v_dot2c_f32_bf16 v1, 0x3f803f80, v240
  v_dot2c_f32_bf16 v3, v240, v240
  v_dot2c_f32_bf16 v2, 0x3f803f80, v241
  v_dot2c_f32_bf16 v4, v241, v241
  v_dot2c_f32_bf16 v1, 0x3f803f80, v242
  v_dot2c_f32_bf16 v3, v242, v242
  v_dot2c_f32_bf16 v2, 0x3f803f80, v243
  v_dot2c_f32_bf16 v4, v243, v243
  v_dot2c_f32_bf16 v1, 0x3f803f80, v244
  v_dot2c_f32_bf16 v3, v244, v244
  v_dot2c_f32_bf16 v2, 0x3f803f80, v245
  v_dot2c_f32_bf16 v4, v245, v245
  v_dot2c_f32_bf16 v1, 0x3f803f80, v246
  v_dot2c_f32_bf16 v3, v246, v246
  v_dot2c_f32_bf16 v2, 0x3f803f80, v247
  v_dot2c_f32_bf16 v4, v247, v247
  v_mfma_f32_16x16x32_bf16 v[56:59], v[52:55], v[96:99], v[56:59]
  v_mfma_f32_32x32x16_bf16 v[112:127], v[96:99], v[240:243], v[112:127]
  ds_read_b64_tr_b16 v[64:65], v28 offset:24576
  ds_read_b64_tr_b16 v[66:67], v28 offset:25088
  s_add_u32 m0, s94, 90112
  s_nop 0
  buffer_load_dwordx4 v13, s[8:11], s50 offen lds
  buffer_load_dwordx4 v0, s[8:11], s50 offen offset:1024 lds
  v_mfma_f32_32x32x16_bf16 v[112:127], v[100:103], v[244:247], v[112:127]
  ds_read_b64_tr_b16 v[68:69], v29 offset:24576
  ds_read_b64_tr_b16 v[70:71], v29 offset:25088
  v_add_f32 v2, v1, v2
  v_add_f32 v3, v3, v4
  v_bfe_u32 v16, v7, 4, 5
  v_mov_b32 v1, v2
  v_mov_b32 v4, v3
  s_lshl_b32 s82, s74, 8
  s_add_u32 s82, s82, 157696
  v_lshl_add_u32 v15, v16, 3, s82
  s_add_u32 m0, s94, 98304
  v_add_u32 v13, 112, v13
  v_add_u32 v0, 112, v0
  buffer_load_dwordx4 v13, s[8:11], s44 offen lds
  buffer_load_dwordx4 v0, s[8:11], s44 offen offset:1024 lds
  v_mfma_f32_32x32x16_bf16 v[112:127], v[104:107], v[248:251], v[112:127]
  ds_read_b64_tr_b16 v[72:73], v30 offset:24576
  ds_read_b64_tr_b16 v[74:75], v30 offset:25088
  v_permlane32_swap_b32 v2, v1
  v_permlane32_swap_b32 v3, v4
  ds_write2_b32 v10, v56, v57 offset0:128 offset1:192
  v_add_f32 v2, v2, v1
  v_add_f32 v3, v3, v4
  ds_write_b64 v15, v[2:3] offset:1024
  v_mfma_f32_32x32x16_bf16 v[112:127], v[108:111], v[252:255], v[112:127]
  s_waitcnt lgkmcnt(4)
  v_mfma_f32_16x16x32_bf16 v[56:59], v[52:55], v[64:67], 0
  v_mfma_f32_32x32x16_bf16 v[80:95], v[64:67], v[144:147], 0
  ds_read_b64_tr_b16 v[76:77], v31 offset:24576
  ds_read_b64_tr_b16 v[78:79], v31 offset:25088
  v_mfma_f32_32x32x16_bf16 v[80:95], v[68:71], v[148:151], v[80:95]
  ds_read_b64_tr_b16 v[64:65], v28 offset:32768
  ds_read_b64_tr_b16 v[66:67], v28 offset:33280
  s_waitcnt lgkmcnt(4)
  s_barrier
  v_cmp_eq_u32 vcc, 0, v6
  s_mov_b32 s87, 262144
  s_nop 1
  s_cbranch_vccz L_nonce_15_x
L_nonce_15:
  buffer_load_dword v6, v5, s[40:43], 0 offen sc1
  s_sub_u32 s87, s87, 1
  s_cbranch_scc1 L_nonce_15_y
  s_waitcnt vmcnt(0)
  v_cmp_eq_u32 vcc, 0, v6
  s_nop 4
  s_cbranch_vccnz L_nonce_15
L_nonce_15_y:
  s_waitcnt vmcnt(0)
  s_nop 4
L_nonce_15_x:
  v_readfirstlane_b32 s80, v6
  s_cmp_lg_u32 s74, 0
  s_cbranch_scc1 L_flag_16
  s_lshl_b32 s83, s72, 6
  s_lshl_b32 s82, s70, 2
  s_add_u32 s83, s83, s82
  s_add_u32 s83, s83, 4096
  v_mov_b32 v5, s80
  v_lshlrev_b32 v6, 24, v7
  buffer_store_dword v5, v6, s[36:39], s83 offen sc1
L_flag_16:
  s_setprio 0
  ds_read_b64 v[16:17], v15 offset:0
  ds_read_b128 v[60:63], v9 offset:512
  s_waitcnt lgkmcnt(4)
  v_mfma_f32_32x32x16_bf16 v[80:95], v[72:75], v[152:155], v[80:95]
  ds_read_b64_tr_b16 v[68:69], v29 offset:32768
  ds_read_b64_tr_b16 v[70:71], v29 offset:33280
  v_mfma_f32_32x32x16_bf16 v[80:95], v[76:79], v[156:159], v[80:95]
  ds_read_b64_tr_b16 v[72:73], v30 offset:32768
  ds_read_b64_tr_b16 v[74:75], v30 offset:33280
  s_waitcnt lgkmcnt(2)
  v_mfma_f32_16x16x32_bf16 v[56:59], v[52:55], v[64:67], v[56:59]
  v_mfma_f32_32x32x16_bf16 v[80:95], v[64:67], v[160:163], v[80:95]
  ds_read_b64_tr_b16 v[76:77], v31 offset:32768
  ds_read_b64_tr_b16 v[78:79], v31 offset:33280
  v_add_f32 v2, v2, v16
  v_add_f32 v3, v3, v17
  v_mul_f32 v2, 0x3b124925, v2
  v_mul_f32 v3, 0x3b124925, v3
  v_mul_f32_e64 v16, -v2, v32
  v_fma_f32 v3, -v2, v2, v3
  v_cvt_pk_bf16_f32 v46, v16, v16
  s_waitcnt vmcnt(2)
  s_barrier
  v_mfma_f32_32x32x16_bf16 v[80:95], v[68:71], v[164:167], v[80:95]
  ds_read_b64_tr_b16 v[64:65], v28 offset:40960
  ds_read_b64_tr_b16 v[66:67], v28 offset:41472
  s_mul_i32 s86, s79, 12544
  s_lshl_b32 s82, s74, 12
  s_add_u32 s86, s86, s82
  s_add_u32 m0, s82, 73728
  s_nop 0
  buffer_load_dwordx4 v7, s[28:31], s86 offen lds
  buffer_load_dwordx4 v7, s[28:31], s86 offen offset:1024 lds
  buffer_load_dwordx4 v7, s[28:31], s86 offen offset:2048 lds
  buffer_load_dwordx4 v7, s[28:31], s86 offen offset:3072 lds
  v_max_f32 v3, 0, v3
  v_add_f32 v60, v60, v61
  v_add_f32 v62, v62, v63
  s_waitcnt lgkmcnt(2)
  v_mfma_f32_32x32x16_bf16 v[80:95], v[72:75], v[168:171], v[80:95]
  ds_read_b64_tr_b16 v[68:69], v29 offset:40960
  ds_read_b64_tr_b16 v[70:71], v29 offset:41472
  s_add_u32 m0, s94, 106496
  s_nop 0
  buffer_load_dwordx4 v13, s[8:11], s45 offen lds
  v_add_f32 v60, v60, v62
  v_cvt_pk_bf16_f32 v61, v60, v60
  v_lshlrev_b32 v61, 16, v61
  v_mfma_f32_32x32x16_bf16 v[80:95], v[76:79], v[172:175], v[80:95]
  ds_read_b64_tr_b16 v[72:73], v30 offset:40960
  ds_read_b64_tr_b16 v[74:75], v30 offset:41472
  buffer_load_dwordx4 v0, s[8:11], s45 offen offset:1024 lds
  v_sub_f32 v62, v60, v61
  v_cvt_pk_bf16_f32 v48, v61, v62
  v_cvt_pk_bf16_f32 v3, v3, v3
  s_waitcnt lgkmcnt(2)
  v_mfma_f32_16x16x32_bf16 v[56:59], v[52:55], v[64:67], v[56:59]
  v_mfma_f32_32x32x16_bf16 v[80:95], v[64:67], v[176:179], v[80:95]
  ds_read_b64_tr_b16 v[76:77], v31 offset:40960
  ds_read_b64_tr_b16 v[78:79], v31 offset:41472
  s_add_u32 m0, s94, 114688
  s_nop 0
  buffer_load_dwordx4 v13, s[8:11], s46 offen lds
  v_lshlrev_b32 v3, 16, v3
  v_mfma_f32_32x32x8_bf16 v[112:127], v[48:49], v[46:47], v[112:127]
  v_mfma_f32_32x32x16_bf16 v[80:95], v[68:71], v[180:183], v[80:95]
  ds_read_b64_tr_b16 v[64:65], v28 offset:49152
  ds_read_b64_tr_b16 v[66:67], v28 offset:49664
  buffer_load_dwordx4 v0, s[8:11], s46 offen offset:1024 lds
  v_add_f32 v3, 0x3727c5ac, v3
  v_cvt_pk_bf16_f32 v3, v3, v3
  v_lshlrev_b32 v3, 16, v3
  s_waitcnt lgkmcnt(2)
  v_mfma_f32_32x32x16_bf16 v[80:95], v[72:75], v[184:187], v[80:95]
  ds_read_b64_tr_b16 v[68:69], v29 offset:49152
  ds_read_b64_tr_b16 v[70:71], v29 offset:49664
  s_add_u32 m0, s94, 122880
  s_nop 0
  buffer_load_dwordx4 v13, s[8:11], s47 offen lds
  v_sqrt_f32 v3, v3
  s_nop 0
  v_cvt_pk_bf16_f32 v3, v3, v3
  v_mfma_f32_32x32x16_bf16 v[80:95], v[76:79], v[188:191], v[80:95]
  ds_read_b64_tr_b16 v[72:73], v30 offset:49152
  ds_read_b64_tr_b16 v[74:75], v30 offset:49664
  buffer_load_dwordx4 v0, s[8:11], s47 offen offset:1024 lds
  v_lshlrev_b32 v3, 16, v3
  v_rcp_f32 v34, v3
  s_waitcnt lgkmcnt(2)
  v_mfma_f32_16x16x32_bf16 v[56:59], v[52:55], v[64:67], v[56:59]
  v_mfma_f32_32x32x16_bf16 v[80:95], v[64:67], v[192:195], v[80:95]
  ds_read_b64_tr_b16 v[76:77], v31 offset:49152
  ds_read_b64_tr_b16 v[78:79], v31 offset:49664
  s_add_u32 m0, s94, 0
  s_nop 0
  buffer_load_dwordx4 v13, s[8:11], s48 offen lds
  v_mul_f32 v35, v3, v3
  v_mul_f32 v33, 0x3fb8aa3b, v34
  v_mul_f32 v1, v34, v32
  v_mfma_f32_32x32x16_bf16 v[80:95], v[68:71], v[196:199], v[80:95]
  ds_read_b64_tr_b16 v[64:65], v28 offset:57344
  ds_read_b64_tr_b16 v[66:67], v28 offset:57856
  buffer_load_dwordx4 v0, s[8:11], s48 offen offset:1024 lds
  v_sub_f32 v2, 1.0, v32
  v_mul_f32 v112, v112, v34
  v_mul_f32 v113, v113, v34
  s_waitcnt lgkmcnt(2)
  v_mfma_f32_32x32x16_bf16 v[80:95], v[72:75], v[200:203], v[80:95]
  ds_read_b64_tr_b16 v[68:69], v29 offset:57344
  ds_read_b64_tr_b16 v[70:71], v29 offset:57856
  s_add_u32 m0, s94, 8192
  s_nop 0
  buffer_load_dwordx4 v13, s[8:11], s49 offen lds
  v_mul_f32 v114, v114, v34
  v_mul_f32 v115, v115, v34
  v_cvt_pk_bf16_f32 v112, v112, v113
  v_mfma_f32_32x32x16_bf16 v[80:95], v[76:79], v[204:207], v[80:95]
  ds_read_b64_tr_b16 v[72:73], v30 offset:57344
  ds_read_b64_tr_b16 v[74:75], v30 offset:57856
  buffer_load_dwordx4 v0, s[8:11], s49 offen offset:1024 lds
  v_cvt_pk_bf16_f32 v113, v114, v115
  ds_write_b64 v8, v[112:113]
  v_mul_f32 v116, v116, v34
  s_waitcnt lgkmcnt(3)
  v_mfma_f32_16x16x32_bf16 v[56:59], v[52:55], v[64:67], v[56:59]
  v_mfma_f32_32x32x16_bf16 v[80:95], v[64:67], v[208:211], v[80:95]
  ds_read_b64_tr_b16 v[76:77], v31 offset:57344
  ds_read_b64_tr_b16 v[78:79], v31 offset:57856
  s_add_u32 m0, s94, 16384
  s_nop 0
  buffer_load_dwordx4 v13, s[8:11], s50 offen lds
  v_mul_f32 v117, v117, v34
  v_mul_f32 v118, v118, v34
  v_mul_f32 v119, v119, v34
  v_mfma_f32_32x32x16_bf16 v[80:95], v[68:71], v[212:215], v[80:95]
  v_add_u32 v28, 0x10000, v28
  v_add_u32 v29, 0x10000, v29
  v_add_u32 v30, 0x10000, v30
  v_add_u32 v31, 0x10000, v31
  ds_read_b64_tr_b16 v[64:65], v28 offset:0
  ds_read_b64_tr_b16 v[66:67], v28 offset:512
  v_xor_b32 v21, 16, v8
  v_cvt_pk_bf16_f32 v116, v116, v117
  v_cvt_pk_bf16_f32 v117, v118, v119
  s_waitcnt lgkmcnt(2)
  v_mfma_f32_32x32x16_bf16 v[80:95], v[72:75], v[216:219], v[80:95]
  ds_read_b64_tr_b16 v[68:69], v29 offset:0
  ds_read_b64_tr_b16 v[70:71], v29 offset:512
  buffer_load_dwordx4 v0, s[8:11], s50 offen offset:1024 lds
  ds_write_b64 v21, v[116:117]
  v_mul_f32 v120, v120, v34
  v_mul_f32 v121, v121, v34
  v_mfma_f32_32x32x16_bf16 v[80:95], v[76:79], v[220:223], v[80:95]
  ds_read_b64_tr_b16 v[72:73], v30 offset:0
  ds_read_b64_tr_b16 v[74:75], v30 offset:512
  v_mul_f32 v122, v122, v34
  v_mul_f32 v123, v123, v34
  v_xor_b32 v22, 32, v8
  s_waitcnt lgkmcnt(3)
  v_mfma_f32_16x16x32_bf16 v[56:59], v[52:55], v[64:67], v[56:59]
  v_mfma_f32_32x32x16_bf16 v[80:95], v[64:67], v[224:227], v[80:95]
  ds_read_b64_tr_b16 v[76:77], v31 offset:0
  ds_read_b64_tr_b16 v[78:79], v31 offset:512
  s_add_u32 m0, s94, 24576
  v_add_u32 v13, s97, v13
  v_add_u32 v0, s97, v0
  buffer_load_dwordx4 v13, s[8:11], s44 offen lds
  v_cvt_pk_bf16_f32 v120, v120, v121
  v_cvt_pk_bf16_f32 v121, v122, v123
  ds_write_b64 v22, v[120:121]
  v_mfma_f32_32x32x16_bf16 v[80:95], v[68:71], v[228:231], v[80:95]
  ds_read_b64_tr_b16 v[64:65], v28 offset:24576
  ds_read_b64_tr_b16 v[66:67], v28 offset:25088
  v_fma_f32 v124, v124, v1, v2
  v_mul_f32 v125, v125, v1
  v_mul_f32 v126, v126, v1
  s_waitcnt lgkmcnt(3)
  v_mfma_f32_32x32x16_bf16 v[80:95], v[72:75], v[232:235], v[80:95]
  ds_read_b64_tr_b16 v[68:69], v29 offset:24576
  ds_read_b64_tr_b16 v[70:71], v29 offset:25088
  buffer_load_dwordx4 v0, s[8:11], s44 offen offset:1024 lds
  v_mul_f32 v127, v127, v1
  v_xor_b32 v23, 48, v8
  v_cvt_pk_bf16_f32 v124, v124, v125
  v_mfma_f32_32x32x16_bf16 v[80:95], v[76:79], v[236:239], v[80:95]
  ds_read_b64_tr_b16 v[72:73], v30 offset:24576
  ds_read_b64_tr_b16 v[74:75], v30 offset:25088
  v_cvt_pk_bf16_f32 v125, v126, v127
  ds_write_b64 v23, v[124:125]
  v_bfe_u32 v1, v7, 8, 2
  s_waitcnt lgkmcnt(3)
  v_mfma_f32_16x16x32_bf16 v[56:59], v[52:55], v[64:67], v[56:59]
  v_mfma_f32_32x32x16_bf16 v[80:95], v[64:67], v[240:243], v[80:95]
  ds_read_b64_tr_b16 v[76:77], v31 offset:24576
  ds_read_b64_tr_b16 v[78:79], v31 offset:25088
  v_bfe_u32 v2, v7, 6, 2
  v_lshl_add_u32 v1, v1, 3, v2
  v_bfe_u32 v2, v7, 5, 1
  s_nop 1
  ds_write2_b32 v10, v56, v57 offset0:0 offset1:64
  s_waitcnt vmcnt(10) lgkmcnt(0)
  s_barrier
  v_mfma_f32_32x32x16_bf16 v[80:95], v[68:71], v[244:247], v[80:95]
  ds_read_b64_tr_b16 v[64:65], v28 offset:32768
  ds_read_b64_tr_b16 v[66:67], v28 offset:33280
  s_add_u32 m0, s94, 32768
  s_nop 0
  buffer_load_dwordx4 v13, s[8:11], s45 offen lds
  ds_read_b128 v[60:63], v9 offset:0
  v_mfma_f32_32x32x16_bf16 v[80:95], v[72:75], v[248:251], v[80:95]
  ds_read_b64_tr_b16 v[68:69], v29 offset:32768
  ds_read_b64_tr_b16 v[70:71], v29 offset:33280
  buffer_load_dwordx4 v0, s[8:11], s45 offen offset:1024 lds
  v_mfma_f32_32x32x16_bf16 v[80:95], v[76:79], v[252:255], v[80:95]
  ds_read_b64_tr_b16 v[72:73], v30 offset:32768
  ds_read_b64_tr_b16 v[74:75], v30 offset:33280
  s_add_u32 m0, s94, 40960
  s_nop 0
  buffer_load_dwordx4 v13, s[8:11], s46 offen lds
  s_waitcnt lgkmcnt(2)
  v_mfma_f32_16x16x32_bf16 v[56:59], v[52:55], v[64:67], 0
  v_mfma_f32_32x32x16_bf16 v[96:111], v[64:67], v[144:147], 0
  ds_read_b64_tr_b16 v[76:77], v31 offset:32768
  ds_read_b64_tr_b16 v[78:79], v31 offset:33280
  buffer_load_dwordx4 v0, s[8:11], s46 offen offset:1024 lds
  v_add_f32 v60, v60, v61
  v_add_f32 v62, v62, v63
  v_add_f32 v60, v60, v62
  v_cvt_pk_bf16_f32 v61, v60, v60
  v_lshlrev_b32 v61, 16, v61
  v_sub_f32 v62, v60, v61
  v_cvt_pk_bf16_f32 v48, v61, v62
  v_mfma_f32_32x32x16_bf16 v[96:111], v[68:71], v[148:151], v[96:111]
  ds_read_b64_tr_b16 v[64:65], v28 offset:40960
  ds_read_b64_tr_b16 v[66:67], v28 offset:41472
  s_add_u32 m0, s94, 49152
  s_nop 0
  buffer_load_dwordx4 v13, s[8:11], s47 offen lds
  v_mfma_f32_32x32x8_bf16 v[80:95], v[48:49], v[46:47], v[80:95]
  v_bfe_u32 v3, v7, 4, 1
  v_lshlrev_b32 v3, 3, v3
  v_bfe_u32 v4, v1, 3, 1
  v_and_b32 v50, 2, v1
  v_lshl_or_b32 v50, v4, 2, v50
  v_lshl_or_b32 v51, s74, 1, v2
  v_xor_b32 v50, v50, v51
  v_lshl_add_u32 v50, v50, 4, v3
  s_waitcnt lgkmcnt(2)
  v_mfma_f32_32x32x16_bf16 v[96:111], v[72:75], v[152:155], v[96:111]
  ds_read_b64_tr_b16 v[68:69], v29 offset:40960
  ds_read_b64_tr_b16 v[70:71], v29 offset:41472
  buffer_load_dwordx4 v0, s[8:11], s47 offen offset:1024 lds
  v_lshl_add_u32 v50, v1, 7, v50
  v_add_u32 v50, 131072, v50
  v_xor_b32 v51, 16, v50
  v_lshlrev_b32 v8, 1, v4
  v_xor_b32 v8, v8, v2
  v_lshl_add_u32 v8, v8, 4, v3
  v_mfma_f32_32x32x16_bf16 v[96:111], v[76:79], v[156:159], v[96:111]
  ds_read_b64_tr_b16 v[72:73], v30 offset:40960
  ds_read_b64_tr_b16 v[74:75], v30 offset:41472
  s_lshl_b32 s83, s72, 6
  s_add_u32 s83, s83, 4096
  v_lshrrev_b32 v5, 2, v7
  v_min_u32 v5, 60, v5
  v_add_u32 v5, s83, v5
  buffer_load_dword v6, v5, s[36:39], 0 offen sc1
  s_add_u32 m0, s94, 57344
  s_nop 0
  buffer_load_dwordx4 v13, s[8:11], s48 offen lds
  v_lshl_add_u32 v8, v1, 6, v8
  v_add_u32 v8, 147456, v8
  v_xor_b32 v12, 16, v8
  v_xor_b32 v14, 32, v8
  v_xor_b32 v15, 48, v8
  s_waitcnt lgkmcnt(2)
  v_mfma_f32_16x16x32_bf16 v[56:59], v[52:55], v[64:67], v[56:59]
  v_mfma_f32_32x32x16_bf16 v[96:111], v[64:67], v[160:163], v[96:111]
  ds_read_b64_tr_b16 v[76:77], v31 offset:40960
  ds_read_b64_tr_b16 v[78:79], v31 offset:41472
  buffer_load_dwordx4 v0, s[8:11], s48 offen offset:1024 lds
  v_bfe_u32 v37, v7, 9, 1
  v_bfe_u32 v35, v7, 6, 2
  v_lshl_add_u32 v37, v37, 2, v35
  v_mul_u32_u24 v37, 56, v37
  v_bfe_u32 v35, v7, 8, 1
  v_lshlrev_b32 v35, 5, v35
  v_mfma_f32_32x32x16_bf16 v[96:111], v[68:71], v[164:167], v[96:111]
  ds_read_b64_tr_b16 v[64:65], v28 offset:49152
  ds_read_b64_tr_b16 v[66:67], v28 offset:49664
  s_add_u32 m0, s94, 65536
  s_nop 0
  buffer_load_dwordx4 v13, s[8:11], s49 offen lds
  v_bfe_u32 v36, v7, 4, 2
  v_lshl_add_u32 v35, v36, 3, v35
  v_min_u32 v35, 48, v35
  v_add_u32 v37, v37, v35
  v_add_u32 v37, 75296, v37
  s_waitcnt lgkmcnt(2)
  v_mfma_f32_32x32x16_bf16 v[96:111], v[72:75], v[168:171], v[96:111]
  ds_read_b64_tr_b16 v[68:69], v29 offset:49152
  ds_read_b64_tr_b16 v[70:71], v29 offset:49664
  buffer_load_dwordx4 v0, s[8:11], s49 offen offset:1024 lds
  s_mul_i32 s82, s96, 6272
  v_add_u32 v37, s82, v37
  s_mul_i32 s98, s96, 12544
  s_sub_u32 s98, 3136, s98
  ds_read_b64_tr_b16 v[38:39], v37 offset:0
  ds_read_b64_tr_b16 v[40:41], v37 offset:448
  v_mfma_f32_32x32x16_bf16 v[96:111], v[76:79], v[172:175], v[96:111]
  ds_read_b64_tr_b16 v[72:73], v30 offset:49152
  ds_read_b64_tr_b16 v[74:75], v30 offset:49664
  ds_read_b64_tr_b16 v[42:43], v37 offset:896
  ds_read_b64_tr_b16 v[44:45], v37 offset:1344
  v_cvt_pk_bf16_f32 v16, v80, v81
  v_cvt_pk_bf16_f32 v17, v82, v83
  v_cvt_pk_bf16_f32 v18, v84, v85
  v_cvt_pk_bf16_f32 v19, v86, v87
  s_waitcnt lgkmcnt(6)
  v_mfma_f32_16x16x32_bf16 v[56:59], v[52:55], v[64:67], v[56:59]
  v_mfma_f32_32x32x16_bf16 v[96:111], v[64:67], v[176:179], v[96:111]
  ds_read_b64_tr_b16 v[76:77], v31 offset:49152
  ds_read_b64_tr_b16 v[78:79], v31 offset:49664
  v_cvt_pk_bf16_f32 v20, v88, v89
  v_cvt_pk_bf16_f32 v21, v90, v91
  v_cvt_pk_bf16_f32 v22, v92, v93
  v_cvt_pk_bf16_f32 v23, v94, v95
  s_waitcnt vmcnt(11)
  s_barrier
  v_mfma_f32_32x32x16_bf16 v[96:111], v[68:71], v[180:183], v[96:111]
  ds_read_b64_tr_b16 v[64:65], v28 offset:57344
  ds_read_b64_tr_b16 v[66:67], v28 offset:57856
  s_setprio 1
  ds_read_b64_tr_b16 v[112:113], v50 offset:0
  ds_read_b64_tr_b16 v[114:115], v51 offset:512
  ds_read_b64_tr_b16 v[116:117], v8 offset:0
  ds_read_b64_tr_b16 v[118:119], v12 offset:256
  ds_read_b64_tr_b16 v[120:121], v14 offset:0
  ds_read_b64_tr_b16 v[122:123], v15 offset:256
  ds_read_b64_tr_b16 v[124:125], v50 offset:4096
  ds_read_b64_tr_b16 v[126:127], v51 offset:4608
  ds_read_b64_tr_b16 v[128:129], v8 offset:2048
  ds_read_b64_tr_b16 v[130:131], v12 offset:2304
  s_waitcnt lgkmcnt(12)
  v_mfma_f32_32x32x16_bf16 v[96:111], v[72:75], v[184:187], v[96:111]
  ds_read_b64_tr_b16 v[68:69], v29 offset:57344
  ds_read_b64_tr_b16 v[70:71], v29 offset:57856
  ds_read_b64_tr_b16 v[132:133], v14 offset:2048
  ds_read_b64_tr_b16 v[134:135], v15 offset:2304
  s_lshl_b32 s99, s72, 7
  s_add_u32 s99, s99, s74
  s_lshl_b32 s99, s99, 6
  s_add_u32 s99, s99, 65536
  s_waitcnt lgkmcnt(10)
  v_mfma_f32_16x16x32_bf16 v[136:139], v[116:119], v[112:115], 0
  v_mfma_f32_32x32x16_bf16 v[96:111], v[76:79], v[188:191], v[96:111]
  ds_read_b64_tr_b16 v[72:73], v30 offset:57344
  ds_read_b64_tr_b16 v[74:75], v30 offset:57856
  s_waitcnt lgkmcnt(10)
  v_mfma_f32_16x16x32_bf16 v[140:143], v[120:123], v[112:115], 0
  ds_read_b64_tr_b16 v[112:113], v50 offset:8192
  ds_read_b64_tr_b16 v[114:115], v51 offset:8704
  ds_read_b64_tr_b16 v[116:117], v8 offset:4096
  ds_read_b64_tr_b16 v[118:119], v12 offset:4352
  ds_read_b64_tr_b16 v[120:121], v14 offset:4096
  ds_read_b64_tr_b16 v[122:123], v15 offset:4352
  s_waitcnt lgkmcnt(10)
  v_mfma_f32_16x16x32_bf16 v[56:59], v[52:55], v[64:67], v[56:59]
  v_mfma_f32_32x32x16_bf16 v[96:111], v[64:67], v[192:195], v[96:111]
  ds_read_b64_tr_b16 v[76:77], v31 offset:57344
  ds_read_b64_tr_b16 v[78:79], v31 offset:57856
  v_mfma_f32_16x16x32_bf16 v[136:139], v[128:131], v[124:127], v[136:139]
  s_waitcnt lgkmcnt(10)
  v_mfma_f32_16x16x32_bf16 v[140:143], v[132:135], v[124:127], v[140:143]
  ds_read_b64_tr_b16 v[124:125], v50 offset:12288
  ds_read_b64_tr_b16 v[126:127], v51 offset:12800
  ds_read_b64_tr_b16 v[128:129], v8 offset:6144
  ds_read_b64_tr_b16 v[130:131], v12 offset:6400
  v_mfma_f32_32x32x16_bf16 v[96:111], v[68:71], v[196:199], v[96:111]
  v_add_u32 v28, 0xffff0000, v28
  v_add_u32 v29, 0xffff0000, v29
  v_add_u32 v30, 0xffff0000, v30
  v_add_u32 v31, 0xffff0000, v31
  ds_read_b64_tr_b16 v[64:65], v28 offset:0
  ds_read_b64_tr_b16 v[66:67], v28 offset:512
  ds_read_b64_tr_b16 v[132:133], v14 offset:6144
  ds_read_b64_tr_b16 v[134:135], v15 offset:6400
  s_waitcnt lgkmcnt(12)
  v_mfma_f32_16x16x32_bf16 v[136:139], v[116:119], v[112:115], v[136:139]
  s_waitcnt lgkmcnt(10)
  v_mfma_f32_16x16x32_bf16 v[140:143], v[120:123], v[112:115], v[140:143]
  s_waitcnt lgkmcnt(8)
  v_mfma_f32_32x32x16_bf16 v[96:111], v[72:75], v[200:203], v[96:111]
  ds_read_b64_tr_b16 v[68:69], v29 offset:0
  ds_read_b64_tr_b16 v[70:71], v29 offset:512
  s_waitcnt lgkmcnt(6)
  v_mfma_f32_16x16x32_bf16 v[136:139], v[128:131], v[124:127], v[136:139]
  v_mfma_f32_32x32x16_bf16 v[96:111], v[76:79], v[204:207], v[96:111]
  ds_read_b64_tr_b16 v[72:73], v30 offset:0
  ds_read_b64_tr_b16 v[74:75], v30 offset:512
  s_waitcnt lgkmcnt(2)
  v_mfma_f32_16x16x32_bf16 v[56:59], v[52:55], v[64:67], v[56:59]
  v_mfma_f32_32x32x16_bf16 v[96:111], v[64:67], v[208:211], v[96:111]
  ds_read_b64_tr_b16 v[76:77], v31 offset:0
  ds_read_b64_tr_b16 v[78:79], v31 offset:512
  v_mfma_f32_16x16x32_bf16 v[140:143], v[132:135], v[124:127], v[140:143]
  v_bfe_u32 v51, v7, 8, 2
  v_bfe_u32 v50, v7, 2, 6
  v_lshl_add_u32 v51, v51, 10, v50
  s_waitcnt vmcnt(4)
  v_cmp_ne_u32 vcc, s80, v6
  s_mov_b32 s87, 262144
  s_nop 1
  s_cbranch_vccz L_poll_17_x
L_poll_17:
  buffer_load_dword v6, v5, s[36:39], 0 offen sc1
  s_sub_u32 s87, s87, 1
  s_cbranch_scc1 L_poll_17_y
  s_waitcnt vmcnt(0)
  v_cmp_ne_u32 vcc, s80, v6
  s_nop 4
  s_cbranch_vccnz L_poll_17
L_poll_17_y:
  s_waitcnt vmcnt(0)
  s_nop 4
L_poll_17_x:
  buffer_atomic_add_f32 v136, v51, s[36:39], s99 offen offset:0
  buffer_atomic_add_f32 v137, v51, s[36:39], s99 offen offset:256
  buffer_atomic_add_f32 v138, v51, s[36:39], s99 offen offset:512
  buffer_atomic_add_f32 v139, v51, s[36:39], s99 offen offset:768
  s_add_u32 s99, s99, 4096
  buffer_atomic_add_f32 v140, v51, s[36:39], s99 offen offset:0
  buffer_atomic_add_f32 v141, v51, s[36:39], s99 offen offset:256
  buffer_atomic_add_f32 v142, v51, s[36:39], s99 offen offset:512
  v_mfma_f32_32x32x16_bf16 v[96:111], v[68:71], v[212:215], v[96:111]
  ds_read_b64_tr_b16 v[64:65], v28 offset:8192
  ds_read_b64_tr_b16 v[66:67], v28 offset:8704
  buffer_atomic_add_f32 v143, v51, s[36:39], s99 offen offset:768
  v_cndmask_b32 v44, 0, v44, s[100:101]
  v_cndmask_b32 v45, 0, v45, s[100:101]
  v_mfma_f32_32x32x16_bf16 v[80:95], v[38:41], v[16:19], 0
  s_nop 0
  v_mfma_f32_32x32x16_bf16 v[80:95], v[42:45], v[20:23], v[80:95]
  s_waitcnt lgkmcnt(2)
  v_mfma_f32_32x32x16_bf16 v[96:111], v[72:75], v[216:219], v[96:111]
  ds_read_b64_tr_b16 v[68:69], v29 offset:8192
  ds_read_b64_tr_b16 v[70:71], v29 offset:8704
  v_mfma_f32_32x32x16_bf16 v[96:111], v[76:79], v[220:223], v[96:111]
  ds_read_b64_tr_b16 v[72:73], v30 offset:8192
  ds_read_b64_tr_b16 v[74:75], v30 offset:8704
  s_waitcnt lgkmcnt(2)
  v_mfma_f32_16x16x32_bf16 v[56:59], v[52:55], v[64:67], v[56:59]
  v_mfma_f32_32x32x16_bf16 v[96:111], v[64:67], v[224:227], v[96:111]
  ds_read_b64_tr_b16 v[76:77], v31 offset:8192
  ds_read_b64_tr_b16 v[78:79], v31 offset:8704
  v_max3_f32 v1, v80, v81, v82
  v_min3_f32 v2, v80, v81, v82
  v_max3_f32 v1, v1, v83, v84
  v_min3_f32 v2, v2, v83, v84
  v_max3_f32 v1, v1, v85, v86
  v_min3_f32 v2, v2, v85, v86
  v_max3_f32 v1, v1, v87, v88
  v_min3_f32 v2, v2, v87, v88
  v_max3_f32 v1, v1, v89, v90
  v_min3_f32 v2, v2, v89, v90
  v_max3_f32 v1, v1, v91, v92
  v_min3_f32 v2, v2, v91, v92
  v_max3_f32 v1, v1, v93, v94
  v_min3_f32 v2, v2, v93, v94
  v_mfma_f32_32x32x16_bf16 v[96:111], v[68:71], v[228:231], v[96:111]
  ds_read_b64_tr_b16 v[64:65], v28 offset:16384
  ds_read_b64_tr_b16 v[66:67], v28 offset:16896
  v_max_f32 v3, v1, v95
  v_min_f32 v4, v2, v95
  v_mov_b32 v1, v3
  v_mov_b32 v2, v4
  s_nop 0
  v_permlane32_swap_b32 v1, v3
  v_permlane32_swap_b32 v2, v4
  v_max_f32 v1, v1, v3
  v_min_f32 v2, v2, v4
  v_mul_f32_e64 v1, -v1, v33
  s_waitcnt lgkmcnt(2)
  v_mfma_f32_32x32x16_bf16 v[96:111], v[72:75], v[232:235], v[96:111]
  ds_read_b64_tr_b16 v[68:69], v29 offset:16384
  ds_read_b64_tr_b16 v[70:71], v29 offset:16896
  v_mul_f32 v2, v2, v33
  v_fma_f32 v24, -v80, v33, v2
  v_fma_f32 v25, -v81, v33, v2
  v_fma_f32 v26, v80, v33, v1
  v_fma_f32 v27, v81, v33, v1
  v_exp_f32 v24, v24
  v_exp_f32 v25, v25
  v_mfma_f32_32x32x16_bf16 v[96:111], v[76:79], v[236:239], v[96:111]
  ds_read_b64_tr_b16 v[72:73], v30 offset:16384
  ds_read_b64_tr_b16 v[74:75], v30 offset:16896
  v_exp_f32 v26, v26
  v_exp_f32 v27, v27
  v_cvt_pk_bf16_f32 v16, v24, v25
  v_cvt_pk_bf16_f32 v80, v26, v27
  v_fma_f32 v24, -v82, v33, v2
  v_fma_f32 v25, -v83, v33, v2
  v_fma_f32 v26, v82, v33, v1
  s_waitcnt lgkmcnt(2)
  v_mfma_f32_16x16x32_bf16 v[56:59], v[52:55], v[64:67], v[56:59]
  v_mfma_f32_32x32x16_bf16 v[96:111], v[64:67], v[240:243], v[96:111]
  ds_read_b64_tr_b16 v[76:77], v31 offset:16384
  ds_read_b64_tr_b16 v[78:79], v31 offset:16896
  v_fma_f32 v27, v83, v33, v1
  v_exp_f32 v24, v24
  v_exp_f32 v25, v25
  v_exp_f32 v26, v26
  v_exp_f32 v27, v27
  ds_write2_b32 v10, v56, v57 offset0:128 offset1:192
  v_mfma_f32_32x32x16_bf16 v[96:111], v[68:71], v[244:247], v[96:111]
  ds_read_b64_tr_b16 v[64:65], v28 offset:24576
  ds_read_b64_tr_b16 v[66:67], v28 offset:25088
  v_cvt_pk_bf16_f32 v17, v24, v25
  v_cvt_pk_bf16_f32 v81, v26, v27
  v_fma_f32 v24, -v84, v33, v2
  v_fma_f32 v25, -v85, v33, v2
  v_fma_f32 v26, v84, v33, v1
  v_fma_f32 v27, v85, v33, v1
  v_exp_f32 v24, v24
  v_exp_f32 v25, v25
  s_waitcnt lgkmcnt(3)
  v_mfma_f32_32x32x16_bf16 v[96:111], v[72:75], v[248:251], v[96:111]
  ds_read_b64_tr_b16 v[68:69], v29 offset:24576
  ds_read_b64_tr_b16 v[70:71], v29 offset:25088
  v_exp_f32 v26, v26
  v_exp_f32 v27, v27
  v_cvt_pk_bf16_f32 v18, v24, v25
  v_cvt_pk_bf16_f32 v82, v26, v27
  v_fma_f32 v24, -v86, v33, v2
  v_fma_f32 v25, -v87, v33, v2
  v_mfma_f32_32x32x16_bf16 v[96:111], v[76:79], v[252:255], v[96:111]
  ds_read_b64_tr_b16 v[72:73], v30 offset:24576
  ds_read_b64_tr_b16 v[74:75], v30 offset:25088
  v_fma_f32 v26, v86, v33, v1
  v_fma_f32 v27, v87, v33, v1
  v_exp_f32 v24, v24
  v_exp_f32 v25, v25
  v_exp_f32 v26, v26
  v_exp_f32 v27, v27
  s_waitcnt lgkmcnt(2)
  v_mfma_f32_16x16x32_bf16 v[56:59], v[52:55], v[64:67], 0
  v_mfma_f32_32x32x16_bf16 v[112:127], v[64:67], v[144:147], 0
  ds_read_b64_tr_b16 v[76:77], v31 offset:24576
  ds_read_b64_tr_b16 v[78:79], v31 offset:25088
  v_cvt_pk_bf16_f32 v19, v24, v25
  v_cvt_pk_bf16_f32 v83, v26, v27
  v_fma_f32 v24, -v88, v33, v2
  v_fma_f32 v25, -v89, v33, v2
  v_fma_f32 v26, v88, v33, v1
  v_fma_f32 v27, v89, v33, v1
  v_exp_f32 v24, v24
  s_waitcnt vmcnt(10)
  s_barrier
  v_mfma_f32_32x32x16_bf16 v[112:127], v[68:71], v[148:151], v[112:127]
  ds_read_b64_tr_b16 v[64:65], v28 offset:32768
  ds_read_b64_tr_b16 v[66:67], v28 offset:33280
  ds_read_b128 v[60:63], v9 offset:512
  s_waitcnt lgkmcnt(3)
  v_mfma_f32_32x32x16_bf16 v[112:127], v[72:75], v[152:155], v[112:127]
  ds_read_b64_tr_b16 v[68:69], v29 offset:32768
  ds_read_b64_tr_b16 v[70:71], v29 offset:33280
  s_add_u32 m0, s94, 0
  s_nop 0
  buffer_load_dwordx4 v13, s[8:11], s50 offen lds
  v_mfma_f32_32x32x16_bf16 v[112:127], v[76:79], v[156:159], v[112:127]
  ds_read_b64_tr_b16 v[72:73], v30 offset:32768
  ds_read_b64_tr_b16 v[74:75], v30 offset:33280
  s_waitcnt lgkmcnt(2)
  v_mfma_f32_16x16x32_bf16 v[56:59], v[52:55], v[64:67], v[56:59]
  v_mfma_f32_32x32x16_bf16 v[112:127], v[64:67], v[160:163], v[112:127]
  ds_read_b64_tr_b16 v[76:77], v31 offset:32768
  ds_read_b64_tr_b16 v[78:79], v31 offset:33280
  buffer_load_dwordx4 v0, s[8:11], s50 offen offset:1024 lds
  v_add_f32 v60, v60, v61
  v_add_f32 v62, v62, v63
  v_add_f32 v60, v60, v62
  v_cvt_pk_bf16_f32 v61, v60, v60
  v_lshlrev_b32 v61, 16, v61
  v_sub_f32 v62, v60, v61
  v_cvt_pk_bf16_f32 v48, v61, v62
  v_mfma_f32_32x32x16_bf16 v[112:127], v[68:71], v[164:167], v[112:127]
  ds_read_b64_tr_b16 v[64:65], v28 offset:40960
  ds_read_b64_tr_b16 v[66:67], v28 offset:41472
  v_mfma_f32_32x32x8_bf16 v[96:111], v[48:49], v[46:47], v[96:111]
  v_exp_f32 v25, v25
  v_exp_f32 v26, v26
  v_exp_f32 v27, v27
  v_cvt_pk_bf16_f32 v88, v24, v25
  v_cvt_pk_bf16_f32 v84, v26, v27
  v_fma_f32 v24, -v90, v33, v2
  v_fma_f32 v25, -v91, v33, v2
  v_fma_f32 v26, v90, v33, v1
  v_fma_f32 v27, v91, v33, v1
  v_exp_f32 v24, v24
  s_waitcnt lgkmcnt(2)
  v_mfma_f32_32x32x16_bf16 v[112:127], v[72:75], v[168:171], v[112:127]
  ds_read_b64_tr_b16 v[68:69], v29 offset:40960
  ds_read_b64_tr_b16 v[70:71], v29 offset:41472
  s_waitcnt vmcnt(2)
  s_lshl_b32 s83, s72, 2
  s_add_u32 s83, s83, s74
  s_lshl_b32 s83, s83, 4
  s_add_u32 s83, s83, s70
  s_lshl_b32 s83, s83, 2
  v_mov_b32 v5, s80
  v_lshlrev_b32 v6, 24, v7
  buffer_store_dword v5, v6, s[36:39], s83 offen sc1
  s_add_u32 m0, s94, 8192
  v_add_u32 v13, 112, v13
  v_add_u32 v0, 112, v0
  buffer_load_dwordx4 v13, s[8:11], s44 offen lds
  v_exp_f32 v25, v25
  v_exp_f32 v26, v26
  v_exp_f32 v27, v27
  v_cvt_pk_bf16_f32 v89, v24, v25
  v_cvt_pk_bf16_f32 v85, v26, v27
  v_fma_f32 v24, -v92, v33, v2
  v_fma_f32 v25, -v93, v33, v2
  v_fma_f32 v26, v92, v33, v1
  v_fma_f32 v27, v93, v33, v1
  v_mfma_f32_32x32x16_bf16 v[112:127], v[76:79], v[172:175], v[112:127]
  ds_read_b64_tr_b16 v[72:73], v30 offset:40960
  ds_read_b64_tr_b16 v[74:75], v30 offset:41472
  v_exp_f32 v24, v24
  v_exp_f32 v25, v25
  v_exp_f32 v26, v26
  v_exp_f32 v27, v27
  v_cvt_pk_bf16_f32 v90, v24, v25
  v_cvt_pk_bf16_f32 v86, v26, v27
  v_fma_f32 v24, -v94, v33, v2
  v_fma_f32 v25, -v95, v33, v2
  s_waitcnt lgkmcnt(2)
  v_mfma_f32_16x16x32_bf16 v[56:59], v[52:55], v[64:67], v[56:59]
  v_mfma_f32_32x32x16_bf16 v[112:127], v[64:67], v[176:179], v[112:127]
  ds_read_b64_tr_b16 v[76:77], v31 offset:40960
  ds_read_b64_tr_b16 v[78:79], v31 offset:41472
  buffer_load_dwordx4 v0, s[8:11], s44 offen offset:1024 lds
  v_fma_f32 v26, v94, v33, v1
  v_fma_f32 v27, v95, v33, v1
  v_exp_f32 v24, v24
  v_exp_f32 v25, v25
  v_exp_f32 v26, v26
  v_exp_f32 v27, v27
  v_cvt_pk_bf16_f32 v91, v24, v25
  v_cvt_pk_bf16_f32 v87, v26, v27
  v_mfma_f32_32x32x16_bf16 v[112:127], v[68:71], v[180:183], v[112:127]
  ds_read_b64_tr_b16 v[64:65], v28 offset:49152
  ds_read_b64_tr_b16 v[66:67], v28 offset:49664
  v_mov_b32 v92, v16
  v_mov_b32 v93, v17
  v_mov_b32 v94, v18
  v_mov_b32 v95, v19
  v_add_u32 v37, 3136, v37
  ds_read_b64_tr_b16 v[38:39], v37 offset:0
  ds_read_b64_tr_b16 v[40:41], v37 offset:448
  ds_read_b64_tr_b16 v[42:43], v37 offset:896
  s_waitcnt lgkmcnt(5)
  v_mfma_f32_32x32x16_bf16 v[112:127], v[72:75], v[184:187], v[112:127]
  ds_read_b64_tr_b16 v[68:69], v29 offset:49152
  ds_read_b64_tr_b16 v[70:71], v29 offset:49664
  s_add_u32 m0, s94, 16384
  s_nop 0
  buffer_load_dwordx4 v13, s[8:11], s45 offen lds
  ds_read_b64_tr_b16 v[44:45], v37 offset:1344
  v_cvt_pk_bf16_f32 v16, v96, v97
  v_cvt_pk_bf16_f32 v17, v98, v99
  v_cvt_pk_bf16_f32 v18, v100, v101
  v_cvt_pk_bf16_f32 v19, v102, v103
  v_cvt_pk_bf16_f32 v20, v104, v105
  v_cvt_pk_bf16_f32 v21, v106, v107
  v_mfma_f32_32x32x16_bf16 v[112:127], v[76:79], v[188:191], v[112:127]
  ds_read_b64_tr_b16 v[72:73], v30 offset:49152
  ds_read_b64_tr_b16 v[74:75], v30 offset:49664
  v_cvt_pk_bf16_f32 v22, v108, v109
  v_cvt_pk_bf16_f32 v23, v110, v111
  s_waitcnt lgkmcnt(3)
  v_mfma_f32_16x16x32_bf16 v[56:59], v[52:55], v[64:67], v[56:59]
  v_mfma_f32_32x32x16_bf16 v[112:127], v[64:67], v[192:195], v[112:127]
  ds_read_b64_tr_b16 v[76:77], v31 offset:49152
  ds_read_b64_tr_b16 v[78:79], v31 offset:49664
  buffer_load_dwordx4 v0, s[8:11], s45 offen offset:1024 lds
  s_waitcnt lgkmcnt(4)
  v_cndmask_b32 v44, 0, v44, s[100:101]
  v_cndmask_b32 v45, 0, v45, s[100:101]
  v_mfma_f32_32x32x16_bf16 v[96:111], v[38:41], v[16:19], 0
  s_nop 0
  v_mfma_f32_32x32x16_bf16 v[96:111], v[42:45], v[20:23], v[96:111]
  v_mfma_f32_32x32x16_bf16 v[112:127], v[68:71], v[196:199], v[112:127]
  ds_read_b64_tr_b16 v[64:65], v28 offset:57344
  ds_read_b64_tr_b16 v[66:67], v28 offset:57856
  s_waitcnt lgkmcnt(2)
  v_mfma_f32_32x32x16_bf16 v[112:127], v[72:75], v[200:203], v[112:127]
  ds_read_b64_tr_b16 v[68:69], v29 offset:57344
  ds_read_b64_tr_b16 v[70:71], v29 offset:57856
  v_mfma_f32_32x32x16_bf16 v[112:127], v[76:79], v[204:207], v[112:127]
  ds_read_b64_tr_b16 v[72:73], v30 offset:57344
  ds_read_b64_tr_b16 v[74:75], v30 offset:57856
  s_waitcnt lgkmcnt(2)
  v_mfma_f32_16x16x32_bf16 v[56:59], v[52:55], v[64:67], v[56:59]
  v_mfma_f32_32x32x16_bf16 v[112:127], v[64:67], v[208:211], v[112:127]
  ds_read_b64_tr_b16 v[76:77], v31 offset:57344
  ds_read_b64_tr_b16 v[78:79], v31 offset:57856
  v_max3_f32 v1, v96, v97, v98
  v_min3_f32 v2, v96, v97, v98
  v_max3_f32 v1, v1, v99, v100
  v_min3_f32 v2, v2, v99, v100
  v_max3_f32 v1, v1, v101, v102
  v_min3_f32 v2, v2, v101, v102
  v_max3_f32 v1, v1, v103, v104
  v_min3_f32 v2, v2, v103, v104
  v_max3_f32 v1, v1, v105, v106
  v_min3_f32 v2, v2, v105, v106
  v_max3_f32 v1, v1, v107, v108
  v_min3_f32 v2, v2, v107, v108
  v_max3_f32 v1, v1, v109, v110
  v_min3_f32 v2, v2, v109, v110
  s_waitcnt vmcnt(2)
  s_barrier
  v_mfma_f32_32x32x16_bf16 v[112:127], v[68:71], v[212:215], v[112:127]
  v_add_u32 v28, 0x10000, v28
  v_add_u32 v29, 0x10000, v29
  v_add_u32 v30, 0x10000, v30
  v_add_u32 v31, 0x10000, v31
  ds_read_b64_tr_b16 v[64:65], v28 offset:0
  ds_read_b64_tr_b16 v[66:67], v28 offset:512
  s_add_u32 m0, s94, 24576
  s_nop 0
  buffer_load_dwordx4 v13, s[8:11], s46 offen lds
  v_max_f32 v3, v1, v111
  v_min_f32 v4, v2, v111
  v_mov_b32 v1, v3
  v_mov_b32 v2, v4
  s_nop 0
  v_permlane32_swap_b32 v1, v3
  v_permlane32_swap_b32 v2, v4
  v_max_f32 v1, v1, v3
  v_min_f32 v2, v2, v4
  v_mul_f32_e64 v1, -v1, v33
  s_waitcnt lgkmcnt(2)
  v_mfma_f32_32x32x16_bf16 v[112:127], v[72:75], v[216:219], v[112:127]
  ds_read_b64_tr_b16 v[68:69], v29 offset:0
  ds_read_b64_tr_b16 v[70:71], v29 offset:512
  buffer_load_dwordx4 v0, s[8:11], s46 offen offset:1024 lds
  v_mul_f32 v2, v2, v33
  v_fma_f32 v24, -v96, v33, v2
  v_fma_f32 v25, -v97, v33, v2
  v_fma_f32 v26, v96, v33, v1
  v_fma_f32 v27, v97, v33, v1
  v_exp_f32 v24, v24
  v_exp_f32 v25, v25
  v_mfma_f32_32x32x16_bf16 v[112:127], v[76:79], v[220:223], v[112:127]
  ds_read_b64_tr_b16 v[72:73], v30 offset:0
  ds_read_b64_tr_b16 v[74:75], v30 offset:512
  s_add_u32 m0, s94, 32768
  s_nop 0
  buffer_load_dwordx4 v13, s[8:11], s47 offen lds
  v_exp_f32 v26, v26
  v_exp_f32 v27, v27
  v_cvt_pk_bf16_f32 v16, v24, v25
  v_cvt_pk_bf16_f32 v96, v26, v27
  v_fma_f32 v24, -v98, v33, v2
  v_fma_f32 v25, -v99, v33, v2
  v_fma_f32 v26, v98, v33, v1
  s_waitcnt lgkmcnt(2)
  v_mfma_f32_16x16x32_bf16 v[56:59], v[52:55], v[64:67], v[56:59]
  v_mfma_f32_32x32x16_bf16 v[112:127], v[64:67], v[224:227], v[112:127]
  ds_read_b64_tr_b16 v[76:77], v31 offset:0
  ds_read_b64_tr_b16 v[78:79], v31 offset:512
  buffer_load_dwordx4 v0, s[8:11], s47 offen offset:1024 lds
  v_fma_f32 v27, v99, v33, v1
  v_exp_f32 v24, v24
  v_exp_f32 v25, v25
  v_exp_f32 v26, v26
  v_exp_f32 v27, v27
  v_mfma_f32_32x32x16_bf16 v[112:127], v[68:71], v[228:231], v[112:127]
  v_add_u32 v28, 0xffff0000, v28
  v_add_u32 v29, 0xffff0000, v29
  v_add_u32 v30, 0xffff0000, v30
  v_add_u32 v31, 0xffff0000, v31
  ds_read_b64_tr_b16 v[64:65], v28 offset:0
  ds_read_b64_tr_b16 v[66:67], v28 offset:512
  s_add_u32 m0, s94, 40960
  s_nop 0
  buffer_load_dwordx4 v13, s[8:11], s48 offen lds
  v_cvt_pk_bf16_f32 v17, v24, v25
  v_cvt_pk_bf16_f32 v97, v26, v27
  v_fma_f32 v24, -v100, v33, v2
  v_fma_f32 v25, -v101, v33, v2
  v_fma_f32 v26, v100, v33, v1
  v_fma_f32 v27, v101, v33, v1
  v_exp_f32 v24, v24
  v_exp_f32 v25, v25
  s_waitcnt lgkmcnt(2)
  v_mfma_f32_32x32x16_bf16 v[112:127], v[72:75], v[232:235], v[112:127]
  ds_read_b64_tr_b16 v[68:69], v29 offset:0
  ds_read_b64_tr_b16 v[70:71], v29 offset:512
  buffer_load_dwordx4 v0, s[8:11], s48 offen offset:1024 lds
  v_exp_f32 v26, v26
  v_exp_f32 v27, v27
  v_cvt_pk_bf16_f32 v18, v24, v25
  v_cvt_pk_bf16_f32 v98, v26, v27
  v_fma_f32 v24, -v102, v33, v2
  v_fma_f32 v25, -v103, v33, v2
  v_mfma_f32_32x32x16_bf16 v[112:127], v[76:79], v[236:239], v[112:127]
  ds_read_b64_tr_b16 v[72:73], v30 offset:0
  ds_read_b64_tr_b16 v[74:75], v30 offset:512
  v_fma_f32 v26, v102, v33, v1
  v_fma_f32 v27, v103, v33, v1
  v_exp_f32 v24, v24
  v_exp_f32 v25, v25
  v_exp_f32 v26, v26
  v_exp_f32 v27, v27
  s_waitcnt lgkmcnt(2)
  v_mfma_f32_16x16x32_bf16 v[56:59], v[52:55], v[64:67], v[56:59]
  v_mfma_f32_32x32x16_bf16 v[112:127], v[64:67], v[240:243], v[112:127]
  ds_read_b64_tr_b16 v[76:77], v31 offset:0
  ds_read_b64_tr_b16 v[78:79], v31 offset:512
  s_add_u32 m0, s94, 49152
  s_nop 0
  buffer_load_dwordx4 v13, s[8:11], s49 offen lds
  v_cvt_pk_bf16_f32 v19, v24, v25
  v_cvt_pk_bf16_f32 v99, v26, v27
  v_fma_f32 v24, -v104, v33, v2
  v_fma_f32 v25, -v105, v33, v2
  v_fma_f32 v26, v104, v33, v1
  v_fma_f32 v27, v105, v33, v1
  v_exp_f32 v24, v24
  ds_write2_b32 v10, v56, v57 offset0:0 offset1:64
  v_mfma_f32_32x32x16_bf16 v[112:127], v[68:71], v[244:247], v[112:127]
  ds_read_b64_tr_b16 v[64:65], v28 offset:8192
  ds_read_b64_tr_b16 v[66:67], v28 offset:8704
  v_exp_f32 v25, v25
  v_exp_f32 v26, v26
  v_exp_f32 v27, v27
  v_cvt_pk_bf16_f32 v104, v24, v25
  v_cvt_pk_bf16_f32 v100, v26, v27
  v_fma_f32 v24, -v106, v33, v2
  s_waitcnt lgkmcnt(3)
  v_mfma_f32_32x32x16_bf16 v[112:127], v[72:75], v[248:251], v[112:127]
  ds_read_b64_tr_b16 v[68:69], v29 offset:8192
  ds_read_b64_tr_b16 v[70:71], v29 offset:8704
  buffer_load_dwordx4 v0, s[8:11], s49 offen offset:1024 lds
  v_fma_f32 v25, -v107, v33, v2
  v_fma_f32 v26, v106, v33, v1
  v_fma_f32 v27, v107, v33, v1
  v_exp_f32 v24, v24
  v_exp_f32 v25, v25
  v_exp_f32 v26, v26
  v_mfma_f32_32x32x16_bf16 v[112:127], v[76:79], v[252:255], v[112:127]
  ds_read_b64_tr_b16 v[72:73], v30 offset:8192
  ds_read_b64_tr_b16 v[74:75], v30 offset:8704
  v_exp_f32 v27, v27
  v_cvt_pk_bf16_f32 v105, v24, v25
  v_cvt_pk_bf16_f32 v101, v26, v27
  v_fma_f32 v24, -v108, v33, v2
  v_fma_f32 v25, -v109, v33, v2
  v_fma_f32 v26, v108, v33, v1
  v_fma_f32 v27, v109, v33, v1
  v_exp_f32 v24, v24
  s_waitcnt lgkmcnt(2)
  v_mfma_f32_16x16x32_bf16 v[56:59], v[52:55], v[64:67], 0
  v_mfma_f32_32x32x16_bf16 v[128:143], v[64:67], v[144:147], 0
  ds_read_b64_tr_b16 v[76:77], v31 offset:8192
  ds_read_b64_tr_b16 v[78:79], v31 offset:8704
  v_exp_f32 v25, v25
  v_exp_f32 v26, v26
  v_exp_f32 v27, v27
  v_cvt_pk_bf16_f32 v106, v24, v25
  s_waitcnt vmcnt(4)
  s_barrier
  v_mfma_f32_32x32x16_bf16 v[128:143], v[68:71], v[148:151], v[128:143]
  ds_read_b64_tr_b16 v[64:65], v28 offset:16384
  ds_read_b64_tr_b16 v[66:67], v28 offset:16896
  ds_read_b128 v[60:63], v9 offset:0
  s_waitcnt lgkmcnt(3)
  v_mfma_f32_32x32x16_bf16 v[128:143], v[72:75], v[152:155], v[128:143]
  ds_read_b64_tr_b16 v[68:69], v29 offset:16384
  ds_read_b64_tr_b16 v[70:71], v29 offset:16896
  s_add_u32 m0, s94, 57344
  s_nop 0
  buffer_load_dwordx4 v13, s[8:11], s50 offen lds
  v_mfma_f32_32x32x16_bf16 v[128:143], v[76:79], v[156:159], v[128:143]
  ds_read_b64_tr_b16 v[72:73], v30 offset:16384
  ds_read_b64_tr_b16 v[74:75], v30 offset:16896
  s_waitcnt lgkmcnt(2)
  v_mfma_f32_16x16x32_bf16 v[56:59], v[52:55], v[64:67], v[56:59]
  v_mfma_f32_32x32x16_bf16 v[128:143], v[64:67], v[160:163], v[128:143]
  ds_read_b64_tr_b16 v[76:77], v31 offset:16384
  ds_read_b64_tr_b16 v[78:79], v31 offset:16896
  buffer_load_dwordx4 v0, s[8:11], s50 offen offset:1024 lds
  v_add_f32 v60, v60, v61
  v_add_f32 v62, v62, v63
  v_add_f32 v60, v60, v62
  v_cvt_pk_bf16_f32 v61, v60, v60
  v_lshlrev_b32 v61, 16, v61
  v_sub_f32 v62, v60, v61
  v_cvt_pk_bf16_f32 v48, v61, v62
  v_mfma_f32_32x32x16_bf16 v[128:143], v[68:71], v[164:167], v[128:143]
  ds_read_b64_tr_b16 v[64:65], v28 offset:24576
  ds_read_b64_tr_b16 v[66:67], v28 offset:25088
  v_mfma_f32_32x32x8_bf16 v[112:127], v[48:49], v[46:47], v[112:127]
  v_cvt_pk_bf16_f32 v102, v26, v27
  v_fma_f32 v24, -v110, v33, v2
  v_fma_f32 v25, -v111, v33, v2
  v_fma_f32 v26, v110, v33, v1
  v_fma_f32 v27, v111, v33, v1
  v_exp_f32 v24, v24
  v_exp_f32 v25, v25
  v_exp_f32 v26, v26
  v_exp_f32 v27, v27
  v_cvt_pk_bf16_f32 v107, v24, v25
  s_waitcnt lgkmcnt(2)
  v_mfma_f32_32x32x16_bf16 v[128:143], v[72:75], v[168:171], v[128:143]
  ds_read_b64_tr_b16 v[68:69], v29 offset:24576
  ds_read_b64_tr_b16 v[70:71], v29 offset:25088
  v_cvt_pk_bf16_f32 v103, v26, v27
  v_mov_b32 v108, v16
  v_mov_b32 v109, v17
  v_mov_b32 v110, v18
  v_mov_b32 v111, v19
  v_add_u32 v37, s98, v37
  ds_read_b64_tr_b16 v[38:39], v37 offset:0
  ds_read_b64_tr_b16 v[40:41], v37 offset:448
  v_mfma_f32_32x32x16_bf16 v[128:143], v[76:79], v[172:175], v[128:143]
  ds_read_b64_tr_b16 v[72:73], v30 offset:24576
  ds_read_b64_tr_b16 v[74:75], v30 offset:25088
  ds_read_b64_tr_b16 v[42:43], v37 offset:896
  ds_read_b64_tr_b16 v[44:45], v37 offset:1344
  v_cvt_pk_bf16_f32 v16, v112, v113
  v_cvt_pk_bf16_f32 v17, v114, v115
  v_cvt_pk_bf16_f32 v18, v116, v117
  v_cvt_pk_bf16_f32 v19, v118, v119
  v_cvt_pk_bf16_f32 v20, v120, v121
  v_cvt_pk_bf16_f32 v21, v122, v123
  s_waitcnt lgkmcnt(6)
  v_mfma_f32_16x16x32_bf16 v[56:59], v[52:55], v[64:67], v[56:59]
  v_mfma_f32_32x32x16_bf16 v[128:143], v[64:67], v[176:179], v[128:143]
  ds_read_b64_tr_b16 v[76:77], v31 offset:24576
  ds_read_b64_tr_b16 v[78:79], v31 offset:25088
  v_cvt_pk_bf16_f32 v22, v124, v125
  v_cvt_pk_bf16_f32 v23, v126, v127
  v_mfma_f32_32x32x16_bf16 v[128:143], v[68:71], v[180:183], v[128:143]
  ds_read_b64_tr_b16 v[64:65], v28 offset:32768
  ds_read_b64_tr_b16 v[66:67], v28 offset:33280
  s_waitcnt lgkmcnt(4)
  v_cndmask_b32 v44, 0, v44, s[100:101]
  v_cndmask_b32 v45, 0, v45, s[100:101]
  v_mfma_f32_32x32x16_bf16 v[112:127], v[38:41], v[16:19], 0
  s_nop 0
  v_mfma_f32_32x32x16_bf16 v[112:127], v[42:45], v[20:23], v[112:127]
  s_waitcnt lgkmcnt(2)
  v_mfma_f32_32x32x16_bf16 v[128:143], v[72:75], v[184:187], v[128:143]
  ds_read_b64_tr_b16 v[68:69], v29 offset:32768
  ds_read_b64_tr_b16 v[70:71], v29 offset:33280
  v_mfma_f32_32x32x16_bf16 v[128:143], v[76:79], v[188:191], v[128:143]
  ds_read_b64_tr_b16 v[72:73], v30 offset:32768
  ds_read_b64_tr_b16 v[74:75], v30 offset:33280
  s_waitcnt lgkmcnt(2)
  v_mfma_f32_16x16x32_bf16 v[56:59], v[52:55], v[64:67], v[56:59]
  v_mfma_f32_32x32x16_bf16 v[128:143], v[64:67], v[192:195], v[128:143]
  ds_read_b64_tr_b16 v[76:77], v31 offset:32768
  ds_read_b64_tr_b16 v[78:79], v31 offset:33280
  s_lshl_b32 s83, s79, 3
  s_add_u32 s83, s83, s73
  s_lshl_b32 s83, s83, 8
  v_lshrrev_b32 v5, 2, v7
  v_min_u32 v5, 252, v5
  v_add_u32 v5, s83, v5
  buffer_load_dword v6, v5, s[36:39], 0 offen sc1
  v_max3_f32 v1, v112, v113, v114
  v_min3_f32 v2, v112, v113, v114
  v_max3_f32 v1, v1, v115, v116
  v_min3_f32 v2, v2, v115, v116
  v_max3_f32 v1, v1, v117, v118
  v_min3_f32 v2, v2, v117, v118
  v_max3_f32 v1, v1, v119, v120
  v_min3_f32 v2, v2, v119, v120
  v_max3_f32 v1, v1, v121, v122
  v_min3_f32 v2, v2, v121, v122
  v_max3_f32 v1, v1, v123, v124
  v_min3_f32 v2, v2, v123, v124
  v_max3_f32 v1, v1, v125, v126
  v_min3_f32 v2, v2, v125, v126
  s_waitcnt vmcnt(1)
  s_barrier
  v_mfma_f32_32x32x16_bf16 v[128:143], v[68:71], v[196:199], v[128:143]
  ds_read_b64_tr_b16 v[64:65], v28 offset:40960
  ds_read_b64_tr_b16 v[66:67], v28 offset:41472
  v_max_f32 v3, v1, v127
  v_min_f32 v4, v2, v127
  v_mov_b32 v1, v3
  v_mov_b32 v2, v4
  s_nop 0
  v_permlane32_swap_b32 v1, v3
  v_permlane32_swap_b32 v2, v4
  v_max_f32 v1, v1, v3
  v_min_f32 v2, v2, v4
  v_mul_f32_e64 v1, -v1, v33
  s_waitcnt lgkmcnt(2)
  v_mfma_f32_32x32x16_bf16 v[128:143], v[72:75], v[200:203], v[128:143]
  ds_read_b64_tr_b16 v[68:69], v29 offset:40960
  ds_read_b64_tr_b16 v[70:71], v29 offset:41472
  v_mul_f32 v2, v2, v33
  v_fma_f32 v24, -v112, v33, v2
  v_fma_f32 v25, -v113, v33, v2
  v_fma_f32 v26, v112, v33, v1
  v_fma_f32 v27, v113, v33, v1
  v_exp_f32 v24, v24
  v_exp_f32 v25, v25
  v_mfma_f32_32x32x16_bf16 v[128:143], v[76:79], v[204:207], v[128:143]
  ds_read_b64_tr_b16 v[72:73], v30 offset:40960
  ds_read_b64_tr_b16 v[74:75], v30 offset:41472
  v_exp_f32 v26, v26
  v_exp_f32 v27, v27
  v_cvt_pk_bf16_f32 v16, v24, v25
  v_cvt_pk_bf16_f32 v112, v26, v27
  v_fma_f32 v24, -v114, v33, v2
  v_fma_f32 v25, -v115, v33, v2
  v_fma_f32 v26, v114, v33, v1
  s_waitcnt lgkmcnt(2)
  v_mfma_f32_16x16x32_bf16 v[56:59], v[52:55], v[64:67], v[56:59]
  v_mfma_f32_32x32x16_bf16 v[128:143], v[64:67], v[208:211], v[128:143]
  ds_read_b64_tr_b16 v[76:77], v31 offset:40960
  ds_read_b64_tr_b16 v[78:79], v31 offset:41472
  s_waitcnt vmcnt(0)
  v_cmp_ne_u32 vcc, s80, v6
  s_mov_b32 s87, 262144
  s_nop 1
  s_cbranch_vccz L_poll_18_x
L_poll_18:
  buffer_load_dword v6, v5, s[36:39], 0 offen sc1
  s_sub_u32 s87, s87, 1
  s_cbranch_scc1 L_poll_18_y
  s_waitcnt vmcnt(0)
  v_cmp_ne_u32 vcc, s80, v6
  s_nop 4
  s_cbranch_vccnz L_poll_18
L_poll_18_y:
  s_waitcnt vmcnt(0)
  s_nop 4
L_poll_18_x:
  s_lshl_b32 s82, s79, 3
  s_add_u32 s82, s82, s73
  s_lshl_b32 s82, s82, 13
  s_add_u32 s86, s82, 65536
  s_lshl_b32 s83, s73, 13
  v_bfe_u32 v5, v7, 8, 2
  v_lshlrev_b32 v5, 4, v5
  v_xor_b32 v5, v5, v7
  s_add_u32 m0, s83, 90112
  v_mov_b32 v6, v5
  buffer_load_dwordx4 v6, s[36:39], s86 offen sc1 lds
  s_add_u32 m0, m0, 4096
  s_add_u32 s84, s86, 4096
  buffer_load_dwordx4 v6, s[36:39], s84 offen sc1 lds
  s_add_u32 s86, s86, 1024
  s_add_u32 m0, s83, 91136
  v_xor_b32 v6, 64, v5
  buffer_load_dwordx4 v6, s[36:39], s86 offen sc1 lds
  s_add_u32 m0, m0, 4096
  s_add_u32 s84, s86, 4096
  buffer_load_dwordx4 v6, s[36:39], s84 offen sc1 lds
  s_add_u32 s86, s86, 1024
  s_add_u32 m0, s83, 92160
  v_xor_b32 v6, 128, v5
  buffer_load_dwordx4 v6, s[36:39], s86 offen sc1 lds
  s_add_u32 m0, m0, 4096
  s_add_u32 s84, s86, 4096
  buffer_load_dwordx4 v6, s[36:39], s84 offen sc1 lds
  s_add_u32 s86, s86, 1024
  s_add_u32 m0, s83, 93184
  v_xor_b32 v6, 192, v5
  buffer_load_dwordx4 v6, s[36:39], s86 offen sc1 lds
  s_add_u32 m0, m0, 4096
  s_add_u32 s84, s86, 4096
  buffer_load_dwordx4 v6, s[36:39], s84 offen sc1 lds
  v_fma_f32 v27, v115, v33, v1
  v_exp_f32 v24, v24
  v_exp_f32 v25, v25
  v_exp_f32 v26, v26
  v_exp_f32 v27, v27
  v_mfma_f32_32x32x16_bf16 v[128:143], v[68:71], v[212:215], v[128:143]
  ds_read_b64_tr_b16 v[64:65], v28 offset:49152
  ds_read_b64_tr_b16 v[66:67], v28 offset:49664
  v_cvt_pk_bf16_f32 v17, v24, v25
  v_cvt_pk_bf16_f32 v113, v26, v27
  v_fma_f32 v24, -v116, v33, v2
  v_fma_f32 v25, -v117, v33, v2
  v_fma_f32 v26, v116, v33, v1
  v_fma_f32 v27, v117, v33, v1
  v_exp_f32 v24, v24
  v_exp_f32 v25, v25
  s_waitcnt lgkmcnt(2)
  v_mfma_f32_32x32x16_bf16 v[128:143], v[72:75], v[216:219], v[128:143]
  ds_read_b64_tr_b16 v[68:69], v29 offset:49152
  ds_read_b64_tr_b16 v[70:71], v29 offset:49664
  v_exp_f32 v26, v26
  v_exp_f32 v27, v27
  v_cvt_pk_bf16_f32 v18, v24, v25
  v_cvt_pk_bf16_f32 v114, v26, v27
  v_fma_f32 v24, -v118, v33, v2
  v_fma_f32 v25, -v119, v33, v2
  v_mfma_f32_32x32x16_bf16 v[128:143], v[76:79], v[220:223], v[128:143]
  ds_read_b64_tr_b16 v[72:73], v30 offset:49152
  ds_read_b64_tr_b16 v[74:75], v30 offset:49664
  v_fma_f32 v26, v118, v33, v1
  v_fma_f32 v27, v119, v33, v1
  v_exp_f32 v24, v24
  v_exp_f32 v25, v25
  v_exp_f32 v26, v26
  v_exp_f32 v27, v27
  s_waitcnt lgkmcnt(2)
  v_mfma_f32_16x16x32_bf16 v[56:59], v[52:55], v[64:67], v[56:59]
  v_mfma_f32_32x32x16_bf16 v[128:143], v[64:67], v[224:227], v[128:143]
  ds_read_b64_tr_b16 v[76:77], v31 offset:49152
  ds_read_b64_tr_b16 v[78:79], v31 offset:49664
  v_cvt_pk_bf16_f32 v19, v24, v25
  v_cvt_pk_bf16_f32 v115, v26, v27
  v_fma_f32 v24, -v120, v33, v2
  v_fma_f32 v25, -v121, v33, v2
  v_fma_f32 v26, v120, v33, v1
  v_fma_f32 v27, v121, v33, v1
  v_exp_f32 v24, v24
  v_mfma_f32_32x32x16_bf16 v[128:143], v[68:71], v[228:231], v[128:143]
  ds_read_b64_tr_b16 v[64:65], v28 offset:57344
  ds_read_b64_tr_b16 v[66:67], v28 offset:57856
  v_exp_f32 v25, v25
  v_exp_f32 v26, v26
  v_exp_f32 v27, v27
  v_cvt_pk_bf16_f32 v120, v24, v25
  v_cvt_pk_bf16_f32 v116, v26, v27
  v_fma_f32 v24, -v122, v33, v2
  s_waitcnt lgkmcnt(2)
  v_mfma_f32_32x32x16_bf16 v[128:143], v[72:75], v[232:235], v[128:143]
  ds_read_b64_tr_b16 v[68:69], v29 offset:57344
  ds_read_b64_tr_b16 v[70:71], v29 offset:57856
  v_fma_f32 v25, -v123, v33, v2
  v_fma_f32 v26, v122, v33, v1
  v_fma_f32 v27, v123, v33, v1
  v_exp_f32 v24, v24
  v_exp_f32 v25, v25
  v_exp_f32 v26, v26
  v_mfma_f32_32x32x16_bf16 v[128:143], v[76:79], v[236:239], v[128:143]
  ds_read_b64_tr_b16 v[72:73], v30 offset:57344
  ds_read_b64_tr_b16 v[74:75], v30 offset:57856
  v_exp_f32 v27, v27
  v_cvt_pk_bf16_f32 v121, v24, v25
  v_cvt_pk_bf16_f32 v117, v26, v27
  v_fma_f32 v24, -v124, v33, v2
  v_fma_f32 v25, -v125, v33, v2
  v_fma_f32 v26, v124, v33, v1
  v_fma_f32 v27, v125, v33, v1
  v_exp_f32 v24, v24
  s_waitcnt lgkmcnt(2)
  v_mfma_f32_16x16x32_bf16 v[56:59], v[52:55], v[64:67], v[56:59]
  v_mfma_f32_32x32x16_bf16 v[128:143], v[64:67], v[240:243], v[128:143]
  ds_read_b64_tr_b16 v[76:77], v31 offset:57344
  ds_read_b64_tr_b16 v[78:79], v31 offset:57856
  v_exp_f32 v25, v25
  v_exp_f32 v26, v26
  v_exp_f32 v27, v27
  v_cvt_pk_bf16_f32 v122, v24, v25
  s_nop 0
  ds_write2_b32 v10, v56, v57 offset0:128 offset1:192
  s_waitcnt lgkmcnt(0)
  s_barrier
  v_mfma_f32_32x32x16_bf16 v[128:143], v[68:71], v[244:247], v[128:143]
  ds_read_b128 v[60:63], v9 offset:512
  v_mfma_f32_32x32x16_bf16 v[128:143], v[72:75], v[248:251], v[128:143]
  v_mfma_f32_32x32x16_bf16 v[128:143], v[76:79], v[252:255], v[128:143]
  s_waitcnt lgkmcnt(0)
  v_add_f32 v60, v60, v61
  v_add_f32 v62, v62, v63
  v_add_f32 v60, v60, v62
  v_cvt_pk_bf16_f32 v61, v60, v60
  v_lshlrev_b32 v61, 16, v61
  v_sub_f32 v62, v60, v61
  v_cvt_pk_bf16_f32 v48, v61, v62
  s_nop 1
  v_mfma_f32_32x32x8_bf16 v[128:143], v[48:49], v[46:47], v[128:143]
  v_cvt_pk_bf16_f32 v118, v26, v27
  v_fma_f32 v24, -v126, v33, v2
  v_fma_f32 v25, -v127, v33, v2
  v_fma_f32 v26, v126, v33, v1
  v_fma_f32 v27, v127, v33, v1
  v_exp_f32 v24, v24
  v_exp_f32 v25, v25
  v_exp_f32 v26, v26
  v_exp_f32 v27, v27
  v_cvt_pk_bf16_f32 v123, v24, v25
  v_cvt_pk_bf16_f32 v119, v26, v27
  v_mov_b32 v124, v16
  v_mov_b32 v125, v17
  v_mov_b32 v126, v18
  v_mov_b32 v127, v19
  v_bfe_u32 v5, v7, 4, 5
  v_bfe_u32 v6, v7, 9, 1
  v_and_b32 v14, 15, v5
  v_xor_b32 v6, v6, v14
  v_lshlrev_b32 v6, 4, v6
  v_lshl_add_u32 v6, v5, 8, v6
  s_lshl_b32 s83, s73, 13
  s_add_u32 s83, s83, 90112
  v_add_u32 v6, s83, v6
  v_add_u32 v5, s83, v7
  s_waitcnt vmcnt(0)
  ds_read_b128 v[144:147], v6
  v_xor_b32 v14, 32, v6
  ds_read_b128 v[148:151], v14
  v_xor_b32 v14, 64, v6
  ds_read_b128 v[152:155], v14
  v_xor_b32 v14, 96, v6
  ds_read_b128 v[156:159], v14
  v_xor_b32 v14, 128, v6
  ds_read_b128 v[160:163], v14
  v_xor_b32 v14, 160, v6
  ds_read_b128 v[164:167], v14
  v_xor_b32 v14, 192, v6
  ds_read_b128 v[168:171], v14
  v_xor_b32 v14, 224, v6
  ds_read_b128 v[172:175], v14
  v_add_u32 v37, 3136, v37
  ds_read_b64_tr_b16 v[38:39], v37 offset:0
  ds_read_b64_tr_b16 v[40:41], v37 offset:448
  ds_read_b64_tr_b16 v[42:43], v37 offset:896
  ds_read_b64_tr_b16 v[44:45], v37 offset:1344
  v_cvt_pk_bf16_f32 v16, v128, v129
  v_cvt_pk_bf16_f32 v17, v130, v131
  v_cvt_pk_bf16_f32 v18, v132, v133
  v_cvt_pk_bf16_f32 v19, v134, v135
  v_cvt_pk_bf16_f32 v20, v136, v137
  v_cvt_pk_bf16_f32 v21, v138, v139
  v_cvt_pk_bf16_f32 v22, v140, v141
  v_cvt_pk_bf16_f32 v23, v142, v143
  s_waitcnt lgkmcnt(0)
  v_cndmask_b32 v44, 0, v44, s[100:101]
  v_cndmask_b32 v45, 0, v45, s[100:101]
  v_mfma_f32_32x32x16_bf16 v[128:143], v[38:41], v[16:19], 0
  s_nop 0
  v_mfma_f32_32x32x16_bf16 v[128:143], v[42:45], v[20:23], v[128:143]
  v_cvt_pk_bf16_f32 v176, v144, v145
  v_cvt_pk_bf16_f32 v177, v146, v147
  v_cvt_pk_bf16_f32 v178, v148, v149
  v_cvt_pk_bf16_f32 v179, v150, v151
  v_cvt_pk_bf16_f32 v180, v152, v153
  v_cvt_pk_bf16_f32 v181, v154, v155
  v_cvt_pk_bf16_f32 v182, v156, v157
  v_cvt_pk_bf16_f32 v183, v158, v159
  v_cvt_pk_bf16_f32 v184, v160, v161
  v_cvt_pk_bf16_f32 v185, v162, v163
  v_cvt_pk_bf16_f32 v186, v164, v165
  v_cvt_pk_bf16_f32 v187, v166, v167
  v_cvt_pk_bf16_f32 v188, v168, v169
  v_cvt_pk_bf16_f32 v189, v170, v171
  v_cvt_pk_bf16_f32 v190, v172, v173
  v_cvt_pk_bf16_f32 v191, v174, v175
  ds_write_b128 v5, v[176:179] offset:0
  ds_write_b128 v5, v[180:183] offset:1024
  ds_write_b128 v5, v[184:187] offset:2048
  ds_write_b128 v5, v[188:191] offset:3072
  v_max3_f32 v1, v128, v129, v130
  v_min3_f32 v2, v128, v129, v130
  v_max3_f32 v1, v1, v131, v132
  v_min3_f32 v2, v2, v131, v132
  v_max3_f32 v1, v1, v133, v134
  v_min3_f32 v2, v2, v133, v134
  v_max3_f32 v1, v1, v135, v136
  v_min3_f32 v2, v2, v135, v136
  v_max3_f32 v1, v1, v137, v138
  v_min3_f32 v2, v2, v137, v138
  v_max3_f32 v1, v1, v139, v140
  v_min3_f32 v2, v2, v139, v140
  v_max3_f32 v1, v1, v141, v142
  v_min3_f32 v2, v2, v141, v142
  v_max_f32 v3, v1, v143
  v_min_f32 v4, v2, v143
  v_mov_b32 v1, v3
  v_mov_b32 v2, v4
  s_nop 0
  v_permlane32_swap_b32 v1, v3
  v_permlane32_swap_b32 v2, v4
  v_max_f32 v1, v1, v3
  v_min_f32 v2, v2, v4
  v_mul_f32_e64 v1, -v1, v33
  v_mul_f32 v2, v2, v33
  v_fma_f32 v24, -v128, v33, v2
  v_fma_f32 v25, -v129, v33, v2
  v_fma_f32 v26, v128, v33, v1
  v_fma_f32 v27, v129, v33, v1
  v_exp_f32 v24, v24
  v_exp_f32 v25, v25
  v_exp_f32 v26, v26
  v_exp_f32 v27, v27
  v_cvt_pk_bf16_f32 v16, v24, v25
  v_cvt_pk_bf16_f32 v128, v26, v27
  v_fma_f32 v24, -v130, v33, v2
  v_fma_f32 v25, -v131, v33, v2
  v_fma_f32 v26, v130, v33, v1
  v_fma_f32 v27, v131, v33, v1
  v_exp_f32 v24, v24
  v_exp_f32 v25, v25
  v_exp_f32 v26, v26
  v_exp_f32 v27, v27
  v_cvt_pk_bf16_f32 v17, v24, v25
  v_cvt_pk_bf16_f32 v129, v26, v27
  v_fma_f32 v24, -v132, v33, v2
  v_fma_f32 v25, -v133, v33, v2
  v_fma_f32 v26, v132, v33, v1
  v_fma_f32 v27, v133, v33, v1
  v_exp_f32 v24, v24
  v_exp_f32 v25, v25
  v_exp_f32 v26, v26
  v_exp_f32 v27, v27
  v_cvt_pk_bf16_f32 v18, v24, v25
  v_cvt_pk_bf16_f32 v130, v26, v27
  v_fma_f32 v24, -v134, v33, v2
  v_fma_f32 v25, -v135, v33, v2
  v_fma_f32 v26, v134, v33, v1
  v_fma_f32 v27, v135, v33, v1
  v_exp_f32 v24, v24
  v_exp_f32 v25, v25
  v_exp_f32 v26, v26
  v_exp_f32 v27, v27
  v_cvt_pk_bf16_f32 v19, v24, v25
  v_cvt_pk_bf16_f32 v131, v26, v27
  v_fma_f32 v24, -v136, v33, v2
  v_fma_f32 v25, -v137, v33, v2
  v_fma_f32 v26, v136, v33, v1
  v_fma_f32 v27, v137, v33, v1
  v_exp_f32 v24, v24
  v_exp_f32 v25, v25
  v_exp_f32 v26, v26
  v_exp_f32 v27, v27
  v_cvt_pk_bf16_f32 v136, v24, v25
  v_cvt_pk_bf16_f32 v132, v26, v27
  v_fma_f32 v24, -v138, v33, v2
  v_fma_f32 v25, -v139, v33, v2
  v_fma_f32 v26, v138, v33, v1
  v_fma_f32 v27, v139, v33, v1
  v_exp_f32 v24, v24
  v_exp_f32 v25, v25
  v_exp_f32 v26, v26
  v_exp_f32 v27, v27
  v_cvt_pk_bf16_f32 v137, v24, v25
  v_cvt_pk_bf16_f32 v133, v26, v27
  v_fma_f32 v24, -v140, v33, v2
  v_fma_f32 v25, -v141, v33, v2
  v_fma_f32 v26, v140, v33, v1
  v_fma_f32 v27, v141, v33, v1
  v_exp_f32 v24, v24
  v_exp_f32 v25, v25
  v_exp_f32 v26, v26
  v_exp_f32 v27, v27
  v_cvt_pk_bf16_f32 v138, v24, v25
  v_cvt_pk_bf16_f32 v134, v26, v27
  v_fma_f32 v24, -v142, v33, v2
  v_fma_f32 v25, -v143, v33, v2
  v_fma_f32 v26, v142, v33, v1
  v_fma_f32 v27, v143, v33, v1
  v_exp_f32 v24, v24
  v_exp_f32 v25, v25
  v_exp_f32 v26, v26
  v_exp_f32 v27, v27
  v_cvt_pk_bf16_f32 v139, v24, v25
  v_cvt_pk_bf16_f32 v135, v26, v27
  v_mov_b32 v140, v16
  v_mov_b32 v141, v17
  v_mov_b32 v142, v18
  v_mov_b32 v143, v19
  s_lshl_b32 s82, s96, 15
  s_add_u32 s83, s82, 98304
  v_add_u32 v14, s83, v7
  s_sub_u32 s83, 131072, s82
  v_add_u32 v15, s83, v7
  s_lshl_b32 s84, s96, 13
  v_mov_b32 v13, 0x358637bd
  s_waitcnt lgkmcnt(0)
  s_barrier
  ds_read_b128 v[38:41], v14 offset:0
  ds_read_b128 v[42:45], v14 offset:1024
  ds_read_b128 v[46:49], v14 offset:2048
  ds_read_b128 v[50:53], v14 offset:3072
  ds_read_b128 v[54:57], v14 offset:16384
  ds_read_b128 v[58:61], v14 offset:17408
  ds_read_b128 v[16:19], v14 offset:18432
  ds_read_b128 v[20:23], v14 offset:19456
  s_waitcnt lgkmcnt(7)
  v_mfma_f32_32x32x16_bf16 v[144:159], v[38:41], v[80:83], 0
  s_waitcnt lgkmcnt(5)
  v_mfma_f32_32x32x16_bf16 v[160:175], v[46:49], v[92:95], 0
  v_mfma_f32_32x32x16_bf16 v[144:159], v[42:45], v[84:87], v[144:159]
  s_waitcnt lgkmcnt(4)
  v_mfma_f32_32x32x16_bf16 v[160:175], v[50:53], v[88:91], v[160:175]
  ds_read_b128 v[38:41], v15 offset:0
  ds_read_b128 v[42:45], v15 offset:1024
  ds_read_b128 v[46:49], v15 offset:2048
  ds_read_b128 v[50:53], v15 offset:3072
  s_waitcnt lgkmcnt(7)
  v_mfma_f32_32x32x16_bf16 v[176:191], v[54:57], v[96:99], 0
  s_waitcnt lgkmcnt(5)
  v_mfma_f32_32x32x16_bf16 v[192:207], v[16:19], v[108:111], 0
  v_mfma_f32_32x32x16_bf16 v[176:191], v[58:61], v[100:103], v[176:191]
  s_nop 0
  v_rcp_f32 v1, v157
  s_nop 0
  v_rcp_f32 v2, v173
  v_fma_f32 v3, v156, v1, v13
  v_fma_f32 v3, v172, v2, v3
  v_rcp_f32 v3, v3
  s_xor_b32 s86, s84, 0
  s_waitcnt lgkmcnt(4)
  v_mfma_f32_32x32x16_bf16 v[192:207], v[20:23], v[104:107], v[192:207]
  v_mul_f32 v1, v1, v3
  v_mul_f32 v2, v2, v3
  v_mov_b32 v3, v1
  v_mov_b32 v4, v2
  s_nop 0
  v_permlane32_swap_b32 v3, v1
  v_permlane32_swap_b32 v4, v2
  v_mul_f32 v3, v1, v32
  v_mul_f32 v4, v2, v32
  v_mul_f32 v144, v144, v1
  ds_read_b128 v[54:57], v15 offset:16384
  ds_read_b128 v[58:61], v15 offset:17408
  ds_read_b128 v[16:19], v15 offset:18432
  ds_read_b128 v[20:23], v15 offset:19456
  s_waitcnt lgkmcnt(7)
  v_mfma_f32_32x32x16_bf16 v[208:223], v[38:41], v[112:115], 0
  v_mul_f32 v145, v145, v1
  v_fma_f32 v144, v160, v2, v144
  v_fma_f32 v145, v161, v2, v145
  v_mul_f32 v146, v146, v1
  v_mul_f32 v147, v147, v1
  v_fma_f32 v146, v162, v2, v146
  v_fma_f32 v147, v163, v2, v147
  v_cvt_pk_bf16_f32 v80, v144, v145
  v_mul_f32 v148, v148, v1
  s_waitcnt lgkmcnt(5)
  v_mfma_f32_32x32x16_bf16 v[224:239], v[46:49], v[124:127], 0
  v_mul_f32 v149, v149, v1
  v_fma_f32 v148, v164, v2, v148
  v_fma_f32 v149, v165, v2, v149
  v_cvt_pk_bf16_f32 v81, v146, v147
  v_mul_f32 v150, v150, v1
  v_mul_f32 v151, v151, v1
  v_fma_f32 v150, v166, v2, v150
  v_fma_f32 v151, v167, v2, v151
  v_cvt_pk_bf16_f32 v82, v148, v149
  v_mfma_f32_32x32x16_bf16 v[208:223], v[42:45], v[116:119], v[208:223]
  v_mul_f32 v152, v152, v1
  v_mul_f32 v153, v153, v1
  v_fma_f32 v152, v168, v2, v152
  v_fma_f32 v153, v169, v2, v153
  v_cvt_pk_bf16_f32 v83, v150, v151
  v_mul_f32 v154, v154, v1
  v_mul_f32 v155, v155, v1
  v_fma_f32 v154, v170, v2, v154
  v_fma_f32 v155, v171, v2, v155
  s_waitcnt lgkmcnt(4)
  v_mfma_f32_32x32x16_bf16 v[224:239], v[50:53], v[120:123], v[224:239]
  v_cvt_pk_bf16_f32 v84, v152, v153
  v_mul_f32 v156, v156, v3
  v_mul_f32 v157, v157, v3
  v_fma_f32 v156, v172, v4, v156
  v_fma_f32 v157, v173, v4, v157
  v_cvt_pk_bf16_f32 v85, v154, v155
  v_mul_f32 v158, v158, v3
  v_mul_f32 v159, v159, v3
  v_fma_f32 v158, v174, v4, v158
  s_waitcnt lgkmcnt(3)
  v_mfma_f32_32x32x16_bf16 v[240:255], v[54:57], v[128:131], 0
  v_fma_f32 v159, v175, v4, v159
  v_cvt_pk_bf16_f32 v86, v156, v157
  v_cvt_pk_bf16_f32 v87, v158, v159
  buffer_store_dwordx4 v[80:83], v11, s[36:39], s86 offen sc1
  buffer_store_dwordx4 v[84:87], v11, s[36:39], s86 offen offset:1024 sc1
  s_waitcnt lgkmcnt(1)
  v_mfma_f32_32x32x16_bf16 v[64:79], v[16:19], v[140:143], 0
  v_rcp_f32 v24, v189
  v_rcp_f32 v25, v205
  v_fma_f32 v26, v188, v24, v13
  v_fma_f32 v26, v204, v25, v26
  v_rcp_f32 v26, v26
  s_xor_b32 s86, s84, 4096
  v_mfma_f32_32x32x16_bf16 v[240:255], v[58:61], v[132:135], v[240:255]
  v_mul_f32 v24, v24, v26
  v_mul_f32 v25, v25, v26
  v_mov_b32 v26, v24
  v_mov_b32 v27, v25
  s_nop 0
  v_permlane32_swap_b32 v26, v24
  v_permlane32_swap_b32 v27, v25
  v_mul_f32 v26, v24, v32
  v_mul_f32 v27, v25, v32
  v_mul_f32 v176, v176, v24
  s_waitcnt lgkmcnt(0)
  v_mfma_f32_32x32x16_bf16 v[64:79], v[20:23], v[136:139], v[64:79]
  v_mul_f32 v177, v177, v24
  v_fma_f32 v176, v192, v25, v176
  v_fma_f32 v177, v193, v25, v177
  v_mul_f32 v178, v178, v24
  v_mul_f32 v179, v179, v24
  v_fma_f32 v178, v194, v25, v178
  v_fma_f32 v179, v195, v25, v179
  v_cvt_pk_bf16_f32 v96, v176, v177
  v_mul_f32 v180, v180, v24
  v_mul_f32 v181, v181, v24
  v_fma_f32 v180, v196, v25, v180
  v_fma_f32 v181, v197, v25, v181
  v_cvt_pk_bf16_f32 v97, v178, v179
  v_mul_f32 v182, v182, v24
  v_mul_f32 v183, v183, v24
  v_fma_f32 v182, v198, v25, v182
  v_fma_f32 v183, v199, v25, v183
  v_cvt_pk_bf16_f32 v98, v180, v181
  v_mul_f32 v184, v184, v24
  v_mul_f32 v185, v185, v24
  v_fma_f32 v184, v200, v25, v184
  v_fma_f32 v185, v201, v25, v185
  v_cvt_pk_bf16_f32 v99, v182, v183
  v_mul_f32 v186, v186, v24
  v_mul_f32 v187, v187, v24
  v_fma_f32 v186, v202, v25, v186
  v_fma_f32 v187, v203, v25, v187
  v_cvt_pk_bf16_f32 v100, v184, v185
  v_mul_f32 v188, v188, v26
  v_mul_f32 v189, v189, v26
  v_fma_f32 v188, v204, v27, v188
  v_fma_f32 v189, v205, v27, v189
  v_cvt_pk_bf16_f32 v101, v186, v187
  v_mul_f32 v190, v190, v26
  v_mul_f32 v191, v191, v26
  v_fma_f32 v190, v206, v27, v190
  v_fma_f32 v191, v207, v27, v191
  v_cvt_pk_bf16_f32 v102, v188, v189
  v_cvt_pk_bf16_f32 v103, v190, v191
  buffer_store_dwordx4 v[96:99], v11, s[36:39], s86 offen sc1
  buffer_store_dwordx4 v[100:103], v11, s[36:39], s86 offen offset:1024 sc1
  v_rcp_f32 v28, v221
  v_rcp_f32 v29, v237
  v_fma_f32 v30, v220, v28, v13
  v_fma_f32 v30, v236, v29, v30
  v_rcp_f32 v30, v30
  s_xor_b32 s86, s84, 8192
  v_mul_f32 v28, v28, v30
  v_mul_f32 v29, v29, v30
  v_mov_b32 v30, v28
  v_mov_b32 v31, v29
  s_nop 0
  v_permlane32_swap_b32 v30, v28
  v_permlane32_swap_b32 v31, v29
  v_mul_f32 v30, v28, v32
  v_mul_f32 v31, v29, v32
  v_mul_f32 v208, v208, v28
  v_mul_f32 v209, v209, v28
  v_fma_f32 v208, v224, v29, v208
  v_fma_f32 v209, v225, v29, v209
  v_mul_f32 v210, v210, v28
  v_mul_f32 v211, v211, v28
  v_fma_f32 v210, v226, v29, v210
  v_fma_f32 v211, v227, v29, v211
  v_cvt_pk_bf16_f32 v112, v208, v209
  v_mul_f32 v212, v212, v28
  v_mul_f32 v213, v213, v28
  v_fma_f32 v212, v228, v29, v212
  v_fma_f32 v213, v229, v29, v213
  v_cvt_pk_bf16_f32 v113, v210, v211
  v_mul_f32 v214, v214, v28
  v_mul_f32 v215, v215, v28
  v_fma_f32 v214, v230, v29, v214
  v_fma_f32 v215, v231, v29, v215
  v_cvt_pk_bf16_f32 v114, v212, v213
  v_mul_f32 v216, v216, v28
  v_mul_f32 v217, v217, v28
  v_fma_f32 v216, v232, v29, v216
  v_fma_f32 v217, v233, v29, v217
  v_cvt_pk_bf16_f32 v115, v214, v215
  v_mul_f32 v218, v218, v28
  v_mul_f32 v219, v219, v28
  v_fma_f32 v218, v234, v29, v218
  v_fma_f32 v219, v235, v29, v219
  v_cvt_pk_bf16_f32 v116, v216, v217
  v_mul_f32 v220, v220, v30
  v_mul_f32 v221, v221, v30
  v_fma_f32 v220, v236, v31, v220
  v_fma_f32 v221, v237, v31, v221
  v_cvt_pk_bf16_f32 v117, v218, v219
  v_mul_f32 v222, v222, v30
  v_mul_f32 v223, v223, v30
  v_fma_f32 v222, v238, v31, v222
  v_fma_f32 v223, v239, v31, v223
  v_cvt_pk_bf16_f32 v118, v220, v221
  v_cvt_pk_bf16_f32 v119, v222, v223
  buffer_store_dwordx4 v[112:115], v11, s[36:39], s86 offen sc1
  buffer_store_dwordx4 v[116:119], v11, s[36:39], s86 offen offset:1024 sc1
  v_rcp_f32 v33, v253
  v_rcp_f32 v34, v77
  v_fma_f32 v35, v252, v33, v13
  v_fma_f32 v35, v76, v34, v35
  v_rcp_f32 v35, v35
  s_xor_b32 s86, s84, 12288
  v_mul_f32 v33, v33, v35
  v_mul_f32 v34, v34, v35
  v_mov_b32 v35, v33
  v_mov_b32 v36, v34
  s_nop 0
  v_permlane32_swap_b32 v35, v33
  v_permlane32_swap_b32 v36, v34
  v_mul_f32 v35, v33, v32
  v_mul_f32 v36, v34, v32
  v_mul_f32 v240, v240, v33
  v_mul_f32 v241, v241, v33
  v_fma_f32 v240, v64, v34, v240
  v_fma_f32 v241, v65, v34, v241
  v_mul_f32 v242, v242, v33
  v_mul_f32 v243, v243, v33
  v_fma_f32 v242, v66, v34, v242
  v_fma_f32 v243, v67, v34, v243
  v_cvt_pk_bf16_f32 v128, v240, v241
  v_mul_f32 v244, v244, v33
  v_mul_f32 v245, v245, v33
  v_fma_f32 v244, v68, v34, v244
  v_fma_f32 v245, v69, v34, v245
  v_cvt_pk_bf16_f32 v129, v242, v243
  v_mul_f32 v246, v246, v33
  v_mul_f32 v247, v247, v33
  v_fma_f32 v246, v70, v34, v246
  v_fma_f32 v247, v71, v34, v247
  v_cvt_pk_bf16_f32 v130, v244, v245
  v_mul_f32 v248, v248, v33
  v_mul_f32 v249, v249, v33
  v_fma_f32 v248, v72, v34, v248
  v_fma_f32 v249, v73, v34, v249
  v_cvt_pk_bf16_f32 v131, v246, v247
  v_mul_f32 v250, v250, v33
  v_mul_f32 v251, v251, v33
  v_fma_f32 v250, v74, v34, v250
  v_fma_f32 v251, v75, v34, v251
  v_cvt_pk_bf16_f32 v132, v248, v249
  v_mul_f32 v252, v252, v35
  v_mul_f32 v253, v253, v35
  v_fma_f32 v252, v76, v36, v252
  v_fma_f32 v253, v77, v36, v253
  v_cvt_pk_bf16_f32 v133, v250, v251
  v_mul_f32 v254, v254, v35
  v_mul_f32 v255, v255, v35
  v_fma_f32 v254, v78, v36, v254
  v_fma_f32 v255, v79, v36, v255
  v_cvt_pk_bf16_f32 v134, v252, v253
  v_cvt_pk_bf16_f32 v135, v254, v255
  buffer_store_dwordx4 v[128:131], v11, s[36:39], s86 offen sc1
  buffer_store_dwordx4 v[132:135], v11, s[36:39], s86 offen offset:1024 sc1
  s_waitcnt vmcnt(0)
  s_barrier
  s_endpgm
L_end:
  s_endpgm
.section .rodata,"a"
.p2align 6
.amdhsa_kernel recurrent_scan__linear_kernel_hedgehog__geglu_ffn__prompt_kernel
  .amdhsa_next_free_vgpr 256
  .amdhsa_next_free_sgpr 102
  .amdhsa_accum_offset 256
  .amdhsa_group_segment_fixed_size 0
  .amdhsa_kernarg_size 88
  .amdhsa_user_sgpr_count 2
  .amdhsa_user_sgpr_kernarg_segment_ptr 1
  .amdhsa_system_sgpr_workgroup_id_x 1
  .amdhsa_float_denorm_mode_32 3
.end_amdhsa_kernel
```
